```python
import torch

def _softmax(x, axis=-1):
    return torch.softmax(x, dim=axis)
def _gelu(x):
    return torch.nn.functional.gelu(x, approximate="tanh")
def _silu(x):
    return torch.nn.functional.silu(x)
def _sigmoid(x):
    return torch.sigmoid(x)
def _layernorm(x, axis=-1, eps=1e-5):
    m = x.mean(dim=axis, keepdim=True)
    v = x.var(dim=axis, keepdim=True, unbiased=False)
    return (x - m) / torch.sqrt(v + eps)
def _scatter_add(tgt, idx, src, axis=0):
    return tgt.clone().index_add_(axis, idx, src)
def _segment_sum(src, seg, n):
    out = torch.zeros((n,) + src.shape[1:], dtype=src.dtype)
    return out.index_add_(0, seg, src)
def _pad(x, pw):
    flat = tuple(v for pair in reversed(pw) for v in pair)
    return torch.nn.functional.pad(x, flat)

kernel_name = 'concat_heads__mha_block_cached__gqa_block_cached__near_ridge'

def setup_inputs():

    _w = (lambda a: (lambda t: t.to(torch.bfloat16) if t.is_floating_point() else t)(torch.as_tensor(a)))
    def _A_setup():
        B, Sq, D = 8, 112, 1024
        H, Sk, Dh = 32, 1024, 128
        return {
            "x": _w((lambda *s: torch.randn(*s, dtype=torch.bfloat16) * 0.8)(B, Sq, D)),
            "k_cache": _w((lambda *s: torch.randn(*s, dtype=torch.bfloat16) * 0.8)(B, H, Sk, Dh)),
            "v_cache": _w((lambda *s: torch.randn(*s, dtype=torch.bfloat16) * 0.05)(B, H, Sk, Dh)),
            "wq": _w((lambda *s: torch.randn(*s, dtype=torch.bfloat16) * 0.8)(D, H * Dh) * (D ** -0.5)),
            "wo": _w((lambda *s: torch.randn(*s, dtype=torch.bfloat16) * 0.05)(H * Dh, D) * ((H * Dh) ** -0.5)),
        }
    _A_in = _A_setup()

    def _B_setup():
        B, Sq, D = 8, 112, 1024
        Hq, Hkv, Sk, Dh = 32, 32, 1024, 128
        assert Hq % Hkv == 0, (Hq, Hkv)
        return {
            "x": _w((lambda *s: torch.randn(*s, dtype=torch.bfloat16) * 0.8)(B, Sq, D)),
            "k_cache": _w((lambda *s: torch.randn(*s, dtype=torch.bfloat16) * 0.8)(B, Hkv, Sk, Dh)),
            "v_cache": _w((lambda *s: torch.randn(*s, dtype=torch.bfloat16) * 0.05)(B, Hkv, Sk, Dh)),
            "wq": _w((lambda *s: torch.randn(*s, dtype=torch.bfloat16) * 0.8)(D, Hq * Dh) * (D ** -0.5)),
            "wo": _w((lambda *s: torch.randn(*s, dtype=torch.bfloat16) * 0.05)(Hq * Dh, D) * ((Hq * Dh) ** -0.5)),
        }
    _B_in = _B_setup()

    return {
        "A_x": _A_in["x"],
        "A_k_cache": _A_in["k_cache"],
        "A_v_cache": _A_in["v_cache"],
        "A_wq": _A_in["wq"],
        "A_wo": _A_in["wo"],
        "B_x": _B_in["x"],
        "B_k_cache": _B_in["k_cache"],
        "B_v_cache": _B_in["v_cache"],
        "B_wq": _B_in["wq"],
        "B_wo": _B_in["wo"],
    }

def reference(A_x, A_k_cache, A_v_cache, A_wq, A_wo, B_x, B_k_cache, B_v_cache, B_wq, B_wo):
    def _A_ref(x, k_cache, v_cache, wq, wo):
        B, Sq, D = x.shape
        H, Dh = 32, 128
        q = (lambda x, *d: x.permute(*d))((x @ wq).reshape(B, Sq, H, Dh), 0, 2, 1, 3)
        scores = torch.einsum("bhqd,bhkd->bhqk", q, k_cache) * (Dh ** -0.5)
        p = _softmax(scores, axis=-1)
        o = torch.einsum("bhqk,bhkd->bhqd", p, v_cache)
        return (lambda x, *d: x.permute(*d))(o, 0, 2, 1, 3).reshape(B, Sq, H * Dh) @ wo

    def _B_ref(x, k_cache, v_cache, wq, wo):
        B, Sq, D = x.shape
        Hq, Dh = 32, 128
        Hkv = k_cache.shape[1]
        rep = Hq // Hkv
        q = (lambda x, *d: x.permute(*d))((x @ wq).reshape(B, Sq, Hq, Dh), 0, 2, 1, 3)
        k = (lambda x, n, axis: torch.repeat_interleave(x, n, dim=axis))(k_cache, rep, axis=1)
        v = (lambda x, n, axis: torch.repeat_interleave(x, n, dim=axis))(v_cache, rep, axis=1)
        scores = torch.einsum("bhqd,bhkd->bhqk", q, k) * (Dh ** -0.5)
        p = _softmax(scores, axis=-1)
        o = torch.einsum("bhqk,bhkd->bhqd", p, v)
        return (lambda x, *d: x.permute(*d))(o, 0, 2, 1, 3).reshape(B, Sq, Hq * Dh) @ wo

    a = _A_ref(A_x, A_k_cache, A_v_cache, A_wq, A_wo)
    b = _B_ref(B_x, B_k_cache, B_v_cache, B_wq, B_wo)
    return torch.concatenate([a, b], axis=-1)
```

```asm
; @launch grid=(256,1,1) block=(256,1,1) lds=163840
.amdgcn_target "amdgcn-amd-amdhsa--gfx950"
.text
.globl concat_heads__mha_block_cached__gqa_block_cached__near_ridge_kernel
.p2align 8
.type concat_heads__mha_block_cached__gqa_block_cached__near_ridge_kernel,@function
concat_heads__mha_block_cached__gqa_block_cached__near_ridge_kernel:
s_cmp_ge_u32 s2, 256
s_cbranch_scc1 L_exit
s_bfe_u32 s33, s2, 0x10002
s_mul_i32 s44, s33, 40
s_add_u32 s36, s0, s44
s_addc_u32 s37, s1, 0
s_load_dwordx2 s[70:71], s[36:37], 24
s_load_dwordx2 s[74:75], s[36:37], 0
v_lshrrev_b32 v2, 6, v0
v_and_b32 v1, 63, v0
v_readfirstlane_b32 s32, v2
s_and_b32 s38, s2, 3
s_bfe_u32 s39, s2, 0x20003
s_bfe_u32 s34, s2, 0x30005
s_lshl_b32 s35, s38, 2
s_add_u32 s35, s35, s39
s_lshl_b32 s35, s35, 1
s_lshl_b32 s52, s32, 13
s_lshl_b32 s80, s32, 12
s_lshl_b32 s87, s39, 1
s_add_u32 s87, s87, s34
s_and_b32 s87, s87, 7
s_mov_b32 s54, 0
s_mov_b32 s55, 0
v_lshrrev_b32 v2, 3, v1
v_bfe_u32 v3, v1, 4, 1
v_lshlrev_b32 v3, 1, v3
v_and_b32 v4, 7, v1
v_xor_b32 v3, v3, v4
v_lshlrev_b32 v3, 4, v3
s_lshl_b32 s47, s32, 7
v_lshl_add_u32 v2, v2, 13, s47
v_xor_b32 v4, 0, v3
v_add_u32 v4, v4, v2
v_add_u32 v14, 0, v4
v_xor_b32 v4, 64, v3
v_add_u32 v4, v4, v2
v_add_u32 v15, 64512, v4
v_xor_b32 v4, 0, v3
v_add_u32 v4, v4, v2
v_add_u32 v16, 129024, v4
v_xor_b32 v4, 64, v3
v_add_u32 v4, v4, v2
v_add_u32 v17, 193536, v4
s_lshl_b32 s44, s35, 8
s_mul_i32 s45, s34, 229376
s_waitcnt lgkmcnt(0)
s_add_u32 s8, s70, s44
s_addc_u32 s9, s71, 0
s_mov_b32 s10, 0
s_mov_b32 s11, 0x20000
s_sub_u32 s10, 0x800000, s44
s_add_u32 s4, s74, s45
s_addc_u32 s5, s75, 0
s_mov_b32 s6, 229376
s_mov_b32 s7, 0x20000
s_add_u32 m0, s52, 0
s_add_u32 s86, s55, 262144
buffer_load_dwordx4 v14, s[8:11], s55 offen offset:0 lds
buffer_load_dwordx4 v15, s[8:11], s55 offen offset:1024 lds
buffer_load_dwordx4 v16, s[8:11], s55 offen offset:2048 lds
buffer_load_dwordx4 v17, s[8:11], s55 offen offset:3072 lds
s_add_u32 m0, s52, 4096
s_nop 0
buffer_load_dwordx4 v14, s[8:11], s86 offen offset:0 lds
buffer_load_dwordx4 v15, s[8:11], s86 offen offset:1024 lds
buffer_load_dwordx4 v16, s[8:11], s86 offen offset:2048 lds
buffer_load_dwordx4 v17, s[8:11], s86 offen offset:3072 lds
s_load_dwordx2 s[66:67], s[36:37], 8
s_load_dwordx2 s[68:69], s[36:37], 16
s_load_dwordx2 s[62:63], s[36:37], 32
s_load_dwordx2 s[72:73], s[0:1], 80
s_load_dwordx2 s[40:41], s[0:1], 88
s_load_dwordx2 s[42:43], s[0:1], 96
v_lshrrev_b32 v2, 3, v1
v_lshrrev_b32 v3, 4, v1
s_lshl_b32 s46, s32, 16
v_and_b32 v5, 7, v1
v_xor_b32 v5, v5, v3
v_lshlrev_b32 v5, 4, v5
v_lshl_add_u32 v2, v2, 11, s46
v_xor_b32 v4, 0, v5
v_add_u32 v4, v4, v2
v_add_u32 v10, 0, v4
v_xor_b32 v4, 64, v5
v_add_u32 v4, v4, v2
v_add_u32 v11, 15360, v4
v_xor_b32 v4, 0, v5
v_add_u32 v4, v4, v2
v_add_u32 v12, 30720, v4
v_xor_b32 v4, 64, v5
v_add_u32 v4, v4, v2
v_add_u32 v13, 46080, v4
s_add_u32 m0, s80, 98304
s_nop 0
buffer_load_dwordx4 v10, s[4:7], s54 offen offset:0 lds
buffer_load_dwordx4 v11, s[4:7], s54 offen offset:1024 lds
buffer_load_dwordx4 v12, s[4:7], s54 offen offset:2048 lds
buffer_load_dwordx4 v13, s[4:7], s54 offen offset:3072 lds
s_mov_b32 s96, 0x632d9510
s_mov_b32 s97, 0xc8fb74ea
s_cmp_eq_u32 s87, 1
s_cselect_b32 s96, 0x695fb730, s96
s_cselect_b32 s97, 0xc82ea1d4, s97
s_cmp_eq_u32 s87, 2
s_cselect_b32 s96, 0xa761d950, s96
s_cselect_b32 s97, 0x4c3fb82e, s97
s_cmp_eq_u32 s87, 3
s_cselect_b32 s96, 0xad93fb70, s96
s_cselect_b32 s97, 0x4c62e518, s97
s_cmp_eq_u32 s87, 4
s_cselect_b32 s96, 0xeba51d90, s96
s_cselect_b32 s97, 0x8473fc62, s97
s_cmp_eq_u32 s87, 5
s_cselect_b32 s96, 0xe1d73fb0, s96
s_cselect_b32 s97, 0x84a6295c, s97
s_cmp_eq_u32 s87, 6
s_cselect_b32 s96, 0x2fe951d0, s96
s_cselect_b32 s97, 0xc84b73a6, s97
s_cmp_eq_u32 s87, 7
s_cselect_b32 s96, 0x251b73f0, s96
s_cselect_b32 s97, 0xc84ea6d9, s97
s_mov_b64 s[98:99], s[96:97]
s_lshr_b64 s[96:97], s[96:97], 4
s_and_b32 s55, s96, 15
s_lshl_b32 s55, s55, 19
s_lshr_b64 s[98:99], s[98:99], 4
s_and_b32 s54, s98, 15
s_lshl_b32 s54, s54, 7
s_add_u32 m0, s52, 32768
s_add_u32 s86, s55, 262144
buffer_load_dwordx4 v14, s[8:11], s55 offen offset:0 lds
buffer_load_dwordx4 v15, s[8:11], s55 offen offset:1024 lds
buffer_load_dwordx4 v16, s[8:11], s55 offen offset:2048 lds
buffer_load_dwordx4 v17, s[8:11], s55 offen offset:3072 lds
s_lshr_b64 s[96:97], s[96:97], 4
s_and_b32 s55, s96, 15
s_lshl_b32 s55, s55, 19
s_add_u32 m0, s52, 36864
s_nop 0
buffer_load_dwordx4 v14, s[8:11], s86 offen offset:0 lds
buffer_load_dwordx4 v15, s[8:11], s86 offen offset:1024 lds
s_lshr_b32 s84, s32, 1
s_and_b32 s85, s32, 1
s_lshl_b32 s81, s84, 13
s_waitcnt lgkmcnt(0)
s_or_b32 s44, s2, s32
s_cmp_lg_u32 s44, 0
s_cbranch_scc1 L_notag_1
s_memrealtime s[94:95]
s_waitcnt lgkmcnt(0)
v_mov_b32 v4, s94
v_mov_b32 v5, s95
v_mov_b32 v6, 0
v_or_b32 v5, 0x80000000, v5
s_mov_b64 exec, 1
global_store_dwordx2 v6, v[4:5], s[40:41] sc1
s_mov_b64 exec, -1
L_notag_1:
v_lshlrev_b32 v36, 4, v1
v_and_b32 v2, 15, v1
v_lshrrev_b32 v3, 4, v1
v_bfe_u32 v4, v1, 1, 3
v_xor_b32 v4, v4, v3
v_lshlrev_b32 v4, 4, v4
v_lshl_add_u32 v4, v2, 7, v4
v_add_u32 v18, 98304, v4
v_xor_b32 v19, 64, v18
v_lshrrev_b32 v2, 4, v1
v_bfe_u32 v3, v1, 2, 2
v_and_b32 v4, 3, v1
v_lshlrev_b32 v4, 3, v4
v_lshl_add_u32 v4, v2, 10, v4
v_lshl_add_u32 v4, v3, 7, v4
v_lshrrev_b32 v3, 1, v3
v_lshl_add_u32 v4, v3, 5, v4
v_and_b32 v2, 1, v2
v_lshl_add_u32 v4, v2, 6, v4
v_add_u32 v4, s52, v4
v_xor_b32 v20, 0, v4
v_add_u32 v24, 0x10000, v20
v_xor_b32 v21, 32, v4
v_add_u32 v25, 0x10000, v21
v_xor_b32 v22, 64, v4
v_add_u32 v26, 0x10000, v22
v_xor_b32 v23, 96, v4
v_add_u32 v27, 0x10000, v23
s_lshl_b32 s44, s34, 5
s_add_u32 s44, s44, s35
s_add_u32 s44, s44, s84
s_lshl_b32 s44, s44, 18
s_add_u32 s12, s66, s44
s_addc_u32 s13, s67, 0
s_mov_b32 s14, 0x40000
s_mov_b32 s15, 0x20000
s_add_u32 s16, s68, s44
s_addc_u32 s17, s69, 0
s_mov_b32 s18, 0x40000
s_mov_b32 s19, 0x20000
s_mov_b32 s28, s72
s_mov_b32 s29, s73
s_mov_b32 s30, 3670016
s_mov_b32 s31, 0x20000
s_mov_b32 s24, s42
s_mov_b32 s25, s43
s_mov_b32 s26, 33554432
s_mov_b32 s27, 0x20000
s_mov_b32 s58, 0x3e0293ee
s_mov_b32 s59, 0x41000000
s_mov_b32 s82, 0
v_lshrrev_b32 v2, 4, v1
v_and_b32 v4, 15, v1
v_lshlrev_b32 v5, 8, v2
v_xor_b32 v3, v2, v4
v_lshl_add_u32 v28, v3, 4, v5
v_xor_b32 v29, 64, v28
v_xor_b32 v30, 128, v28
v_xor_b32 v31, 192, v28
v_lshlrev_b32 v3, 1, v2
v_xor_b32 v3, v3, v4
v_lshl_add_u32 v32, v3, 4, v5
v_xor_b32 v33, 128, v32
v_and_b32 v2, 15, v1
v_lshrrev_b32 v3, 4, v1
v_xor_b32 v4, v3, v2
v_lshlrev_b32 v4, 4, v4
v_lshl_add_u32 v4, v2, 8, v4
s_add_u32 s45, s81, 32768
s_add_u32 s44, s81, 49152
v_add_u32 v208, s44, v4
v_xor_b32 v209, 64, v208
v_xor_b32 v210, 128, v208
v_xor_b32 v211, 192, v208
v_add_u32 v212, 0x10000, v208
v_add_u32 v213, 0x10000, v209
v_add_u32 v214, 0x10000, v210
v_add_u32 v215, 0x10000, v211
v_bfe_u32 v5, v1, 2, 2
v_and_b32 v6, 3, v1
v_lshlrev_b32 v6, 3, v6
v_lshl_add_u32 v6, v3, 10, v6
v_lshl_add_u32 v6, v5, 8, v6
v_lshl_add_u32 v6, v5, 5, v6
v_and_b32 v3, 1, v3
v_lshl_add_u32 v6, v3, 7, v6
v_add_u32 v216, s45, v6
v_xor_b32 v217, 32, v216
v_xor_b32 v218, 64, v216
v_xor_b32 v219, 96, v216
v_xor_b32 v220, 128, v216
v_xor_b32 v221, 160, v216
v_xor_b32 v222, 192, v216
v_xor_b32 v223, 224, v216
v_add_u32 v224, 0x10000, v216
v_add_u32 v225, 0x10000, v217
v_add_u32 v226, 0x10000, v218
v_add_u32 v227, 0x10000, v219
v_add_u32 v228, 0x10000, v220
v_add_u32 v229, 0x10000, v221
v_add_u32 v230, 0x10000, v222
v_add_u32 v231, 0x10000, v223
v_accvgpr_write_b32 a0, 0
v_accvgpr_write_b32 a1, 0
v_accvgpr_write_b32 a2, 0
v_accvgpr_write_b32 a3, 0
v_accvgpr_write_b32 a4, 0
v_accvgpr_write_b32 a5, 0
v_accvgpr_write_b32 a6, 0
v_accvgpr_write_b32 a7, 0
v_accvgpr_write_b32 a8, 0
v_accvgpr_write_b32 a9, 0
v_accvgpr_write_b32 a10, 0
v_accvgpr_write_b32 a11, 0
v_accvgpr_write_b32 a12, 0
v_accvgpr_write_b32 a13, 0
v_accvgpr_write_b32 a14, 0
v_accvgpr_write_b32 a15, 0
v_accvgpr_write_b32 a16, 0
v_accvgpr_write_b32 a17, 0
v_accvgpr_write_b32 a18, 0
v_accvgpr_write_b32 a19, 0
v_accvgpr_write_b32 a20, 0
v_accvgpr_write_b32 a21, 0
v_accvgpr_write_b32 a22, 0
v_accvgpr_write_b32 a23, 0
v_accvgpr_write_b32 a24, 0
v_accvgpr_write_b32 a25, 0
v_accvgpr_write_b32 a26, 0
v_accvgpr_write_b32 a27, 0
v_accvgpr_write_b32 a28, 0
v_accvgpr_write_b32 a29, 0
v_accvgpr_write_b32 a30, 0
v_accvgpr_write_b32 a31, 0
v_accvgpr_write_b32 a32, 0
v_accvgpr_write_b32 a33, 0
v_accvgpr_write_b32 a34, 0
v_accvgpr_write_b32 a35, 0
v_accvgpr_write_b32 a36, 0
v_accvgpr_write_b32 a37, 0
v_accvgpr_write_b32 a38, 0
v_accvgpr_write_b32 a39, 0
v_accvgpr_write_b32 a40, 0
v_accvgpr_write_b32 a41, 0
v_accvgpr_write_b32 a42, 0
v_accvgpr_write_b32 a43, 0
v_accvgpr_write_b32 a44, 0
v_accvgpr_write_b32 a45, 0
v_accvgpr_write_b32 a46, 0
v_accvgpr_write_b32 a47, 0
v_accvgpr_write_b32 a48, 0
v_accvgpr_write_b32 a49, 0
v_accvgpr_write_b32 a50, 0
v_accvgpr_write_b32 a51, 0
v_accvgpr_write_b32 a52, 0
v_accvgpr_write_b32 a53, 0
v_accvgpr_write_b32 a54, 0
v_accvgpr_write_b32 a55, 0
v_accvgpr_write_b32 a56, 0
v_accvgpr_write_b32 a57, 0
v_accvgpr_write_b32 a58, 0
v_accvgpr_write_b32 a59, 0
v_accvgpr_write_b32 a60, 0
v_accvgpr_write_b32 a61, 0
v_accvgpr_write_b32 a62, 0
v_accvgpr_write_b32 a63, 0
v_accvgpr_write_b32 a64, 0
v_accvgpr_write_b32 a65, 0
v_accvgpr_write_b32 a66, 0
v_accvgpr_write_b32 a67, 0
v_accvgpr_write_b32 a68, 0
v_accvgpr_write_b32 a69, 0
v_accvgpr_write_b32 a70, 0
v_accvgpr_write_b32 a71, 0
v_accvgpr_write_b32 a72, 0
v_accvgpr_write_b32 a73, 0
v_accvgpr_write_b32 a74, 0
v_accvgpr_write_b32 a75, 0
v_accvgpr_write_b32 a76, 0
v_accvgpr_write_b32 a77, 0
v_accvgpr_write_b32 a78, 0
v_accvgpr_write_b32 a79, 0
v_accvgpr_write_b32 a80, 0
v_accvgpr_write_b32 a81, 0
v_accvgpr_write_b32 a82, 0
v_accvgpr_write_b32 a83, 0
v_accvgpr_write_b32 a84, 0
v_accvgpr_write_b32 a85, 0
v_accvgpr_write_b32 a86, 0
v_accvgpr_write_b32 a87, 0
v_accvgpr_write_b32 a88, 0
v_accvgpr_write_b32 a89, 0
v_accvgpr_write_b32 a90, 0
v_accvgpr_write_b32 a91, 0
v_accvgpr_write_b32 a92, 0
v_accvgpr_write_b32 a93, 0
v_accvgpr_write_b32 a94, 0
v_accvgpr_write_b32 a95, 0
v_accvgpr_write_b32 a96, 0
v_accvgpr_write_b32 a97, 0
v_accvgpr_write_b32 a98, 0
v_accvgpr_write_b32 a99, 0
v_accvgpr_write_b32 a100, 0
v_accvgpr_write_b32 a101, 0
v_accvgpr_write_b32 a102, 0
v_accvgpr_write_b32 a103, 0
v_accvgpr_write_b32 a104, 0
v_accvgpr_write_b32 a105, 0
v_accvgpr_write_b32 a106, 0
v_accvgpr_write_b32 a107, 0
v_accvgpr_write_b32 a108, 0
v_accvgpr_write_b32 a109, 0
v_accvgpr_write_b32 a110, 0
v_accvgpr_write_b32 a111, 0
v_accvgpr_write_b32 a112, 0
v_accvgpr_write_b32 a113, 0
v_accvgpr_write_b32 a114, 0
v_accvgpr_write_b32 a115, 0
v_accvgpr_write_b32 a116, 0
v_accvgpr_write_b32 a117, 0
v_accvgpr_write_b32 a118, 0
v_accvgpr_write_b32 a119, 0
v_accvgpr_write_b32 a120, 0
v_accvgpr_write_b32 a121, 0
v_accvgpr_write_b32 a122, 0
v_accvgpr_write_b32 a123, 0
v_accvgpr_write_b32 a124, 0
v_accvgpr_write_b32 a125, 0
v_accvgpr_write_b32 a126, 0
v_accvgpr_write_b32 a127, 0
v_mov_b32 v34, s58
v_mov_b32 v35, s58
s_lshl_b32 s45, s32, 18
s_add_u32 s45, s45, 0
v_add_u32 v232, s45, v36
s_lshl_b32 s45, s32, 18
s_add_u32 s45, s45, 0
v_add_u32 v233, s45, v36
s_lshl_b32 s45, s32, 18
s_add_u32 s45, s45, 129024
v_add_u32 v234, s45, v36
s_lshl_b32 s45, s32, 18
s_add_u32 s45, s45, 129024
v_add_u32 v235, s45, v36
v_lshrrev_b32 v2, 3, v1
v_bfe_u32 v3, v1, 4, 2
v_lshlrev_b32 v3, 1, v3
v_and_b32 v4, 7, v1
v_xor_b32 v3, v3, v4
v_lshlrev_b32 v3, 4, v3
s_lshl_b32 s47, s32, 7
v_lshl_add_u32 v2, v2, 11, s47
v_xor_b32 v4, 0, v3
v_add_u32 v4, v4, v2
v_add_u32 v236, 0, v4
v_xor_b32 v4, 0, v3
v_add_u32 v4, v4, v2
v_add_u32 v237, 15360, v4
v_xor_b32 v4, 0, v3
v_add_u32 v4, v4, v2
v_add_u32 v238, 30720, v4
v_xor_b32 v4, 0, v3
v_add_u32 v4, v4, v2
v_add_u32 v239, 46080, v4
v_add_u32 v240, 98304, v36
v_add_u32 v241, 99328, v36
v_lshrrev_b32 v2, 4, v1
v_bfe_u32 v3, v1, 2, 2
v_and_b32 v4, 3, v1
v_lshlrev_b32 v4, 3, v4
v_lshl_add_u32 v4, v2, 9, v4
v_lshl_add_u32 v4, v3, 7, v4
v_lshrrev_b32 v3, 1, v3
v_lshl_add_u32 v4, v3, 5, v4
v_and_b32 v2, 1, v2
v_lshl_add_u32 v4, v2, 6, v4
v_add_u32 v4, s52, v4
v_xor_b32 v242, 0, v4
v_add_u32 v246, 0x10000, v242
v_xor_b32 v243, 32, v4
v_add_u32 v247, 0x10000, v243
v_xor_b32 v244, 64, v4
v_add_u32 v248, 0x10000, v244
v_xor_b32 v245, 96, v4
v_add_u32 v249, 0x10000, v245
v_accvgpr_write_b32 a224, v232
v_accvgpr_write_b32 a225, v233
v_accvgpr_write_b32 a226, v234
v_accvgpr_write_b32 a227, v235
v_accvgpr_write_b32 a228, v236
v_accvgpr_write_b32 a229, v237
v_accvgpr_write_b32 a230, v238
v_accvgpr_write_b32 a231, v239
v_accvgpr_write_b32 a232, v240
v_accvgpr_write_b32 a233, v241
v_accvgpr_write_b32 a234, v242
v_accvgpr_write_b32 a235, v243
v_accvgpr_write_b32 a236, v244
v_accvgpr_write_b32 a237, v245
v_accvgpr_write_b32 a238, v246
v_accvgpr_write_b32 a239, v247
v_accvgpr_write_b32 a240, v248
v_accvgpr_write_b32 a241, v249
s_lshl_b32 s44, s84, 15
s_lshl_b32 s45, s85, 13
s_add_u32 s44, s44, s45
v_add_u32 v37, s44, v240
v_mov_b32 v232, 0
v_mov_b32 v233, 0
v_mov_b32 v234, 0
v_mov_b32 v235, 0
v_mov_b32 v236, 0
v_mov_b32 v237, 0
v_mov_b32 v238, 0
v_mov_b32 v239, 0
v_mov_b32 v240, 0
v_mov_b32 v241, 0
v_mov_b32 v242, 0
v_mov_b32 v243, 0
v_mov_b32 v244, 0
v_mov_b32 v245, 0
v_mov_b32 v246, 0
v_mov_b32 v247, 0
v_mov_b32 v248, 0
v_mov_b32 v249, 0
v_mov_b32 v250, 0
v_mov_b32 v251, 0
v_mov_b32 v252, 0
v_mov_b32 v253, 0
v_mov_b32 v254, 0
v_mov_b32 v255, 0
s_mov_b32 s60, 0x76543210
s_mov_b32 s61, 0xfedcba98
s_cmp_eq_u32 s34, 1
s_cselect_b32 s60, 0xdcba3210, s60
s_cselect_b32 s61, 0x987654fe, s61
s_cmp_eq_u32 s34, 2
s_cselect_b32 s60, 0x76543210, s60
s_cselect_b32 s61, 0xfedcba98, s61
s_cmp_eq_u32 s34, 3
s_cselect_b32 s60, 0xdcba3210, s60
s_cselect_b32 s61, 0x987654fe, s61
s_cmp_eq_u32 s34, 4
s_cselect_b32 s60, 0x76543210, s60
s_cselect_b32 s61, 0xfedcba98, s61
s_cmp_eq_u32 s34, 5
s_cselect_b32 s60, 0xdcba3210, s60
s_cselect_b32 s61, 0x987654fe, s61
s_cmp_eq_u32 s34, 6
s_cselect_b32 s60, 0x76543210, s60
s_cselect_b32 s61, 0xfedcba98, s61
s_cmp_eq_u32 s34, 7
s_cselect_b32 s60, 0xdcba3210, s60
s_cselect_b32 s61, 0x987654fe, s61
s_lshl_b32 s47, s39, 2
s_mul_i32 s44, s47, 0x11111111
s_and_b32 s45, s44, 0x77777777
s_xor_b32 s46, s60, s44
s_and_b32 s46, s46, 0x88888888
s_and_b32 s60, s60, 0x77777777
s_add_u32 s60, s60, s45
s_xor_b32 s60, s60, s46
s_xor_b32 s46, s61, s44
s_and_b32 s46, s46, 0x88888888
s_and_b32 s61, s61, 0x77777777
s_add_u32 s61, s61, s45
s_xor_b32 s61, s61, s46
s_lshl_b32 s47, s33, 3
s_add_u32 s47, s47, s34
s_mul_i32 s44, s47, 917504
s_lshl_b32 s89, s85, 19
s_add_u32 s89, s89, s44
s_add_u32 s45, s35, s84
s_lshl_b32 s45, s45, 12
s_add_u32 s89, s89, s45
s_lshl_b32 s45, s38, 15
s_add_u32 s44, s44, s45
s_add_u32 s20, s42, s44
s_addc_u32 s21, s43, 0
s_mov_b32 s22, 917504
s_mov_b32 s23, 0x20000
s_lshl_b32 s92, s47, 2
s_add_u32 s92, s92, s38
s_lshl_b32 s92, s92, 7
s_add_u32 s92, s92, 33554432
s_lshl_b32 s44, s47, 2
s_add_u32 s44, s44, s39
s_lshl_b32 s44, s44, 2
s_add_u32 s45, s44, s32
s_add_u32 s46, s44, s38
s_lshl_b32 s51, s46, 7
s_add_u32 s51, s51, 33562624
s_lshl_b32 s49, s45, 7
s_lshl_b32 s47, s38, 3
s_add_u32 s49, s49, s47
s_add_u32 s49, s49, 33562624
s_lshl_b32 s48, s45, 2
s_add_u32 s48, s48, s38
s_lshl_b32 s48, s48, 14
s_add_u32 s48, s48, 16777216
s_lshl_b32 s46, s46, 16
s_add_u32 s46, s46, s80
s_add_u32 s46, s46, 16777216
s_add_u32 s45, s38, 1
s_and_b32 s45, s45, 3
s_lshl_b32 s45, s45, 14
s_add_u32 s3, s45, s46
s_add_u32 s45, s38, 2
s_and_b32 s45, s45, 3
s_lshl_b32 s45, s45, 14
s_add_u32 s100, s45, s46
s_add_u32 s45, s38, 3
s_and_b32 s45, s45, 3
s_lshl_b32 s45, s45, 14
s_add_u32 s101, s45, s46
s_mul_i32 s93, s34, 458752
s_lshl_b32 s45, s33, 11
s_add_u32 s93, s93, s45
s_lshl_b32 s45, s39, 9
s_add_u32 s93, s93, s45
s_lshl_b32 s45, s38, 7
s_add_u32 s93, s93, s45
s_lshl_b32 s45, s32, 17
s_add_u32 s93, s93, s45
s_waitcnt vmcnt(6) lgkmcnt(0)
s_barrier
ds_read_b64_tr_b16 a[192:193], v20 offset:0
ds_read_b64_tr_b16 a[194:195], v20 offset:512
ds_read_b128 v[152:155], v18 offset:0
ds_read_b128 v[156:159], v18 offset:2048
ds_read_b128 v[160:163], v18 offset:4096
ds_read_b128 v[164:167], v18 offset:6144
ds_read_b128 v[168:171], v18 offset:8192
ds_read_b128 v[172:175], v18 offset:10240
ds_read_b128 v[176:179], v18 offset:12288
ds_read_b64_tr_b16 a[196:197], v21 offset:0
ds_read_b64_tr_b16 a[198:199], v21 offset:512
s_waitcnt lgkmcnt(8)
v_mfma_f32_16x16x32_bf16 v[40:43], a[192:195], v[152:155], 0
s_waitcnt lgkmcnt(7)
v_mfma_f32_16x16x32_bf16 v[44:47], a[192:195], v[156:159], 0
buffer_load_dwordx4 v16, s[8:11], s86 offen offset:2048 lds
s_waitcnt lgkmcnt(6)
v_mfma_f32_16x16x32_bf16 v[48:51], a[192:195], v[160:163], 0
ds_read_b64_tr_b16 a[200:201], v22 offset:0
s_waitcnt lgkmcnt(6)
v_mfma_f32_16x16x32_bf16 v[52:55], a[192:195], v[164:167], 0
s_waitcnt lgkmcnt(5)
v_mfma_f32_16x16x32_bf16 v[56:59], a[192:195], v[168:171], 0
ds_read_b64_tr_b16 a[202:203], v22 offset:512
s_waitcnt lgkmcnt(2)
v_mfma_f32_16x16x32_bf16 v[60:63], a[192:195], v[172:175], 0
ds_read_b64_tr_b16 a[204:205], v23 offset:0
buffer_load_dwordx4 v17, s[8:11], s86 offen offset:3072 lds
v_mfma_f32_16x16x32_bf16 v[64:67], a[192:195], v[176:179], 0
v_mfma_f32_16x16x32_bf16 v[68:71], a[196:199], v[152:155], 0
ds_read_b64_tr_b16 a[206:207], v23 offset:512
v_mfma_f32_16x16x32_bf16 v[72:75], a[196:199], v[156:159], 0
ds_read_b64_tr_b16 a[208:209], v20 offset:4096
v_mfma_f32_16x16x32_bf16 v[76:79], a[196:199], v[160:163], 0
s_add_u32 m0, s80, 114688
s_nop 0
buffer_load_dwordx4 v10, s[4:7], s54 offen offset:0 lds
v_mfma_f32_16x16x32_bf16 v[80:83], a[196:199], v[164:167], 0
ds_read_b64_tr_b16 a[210:211], v20 offset:4608
v_mfma_f32_16x16x32_bf16 v[84:87], a[196:199], v[168:171], 0
ds_read_b128 v[180:183], v19 offset:0
v_mfma_f32_16x16x32_bf16 v[88:91], a[196:199], v[172:175], 0
v_mfma_f32_16x16x32_bf16 v[92:95], a[196:199], v[176:179], 0
ds_read_b128 v[184:187], v19 offset:2048
buffer_load_dwordx4 v11, s[4:7], s54 offen offset:1024 lds
s_waitcnt lgkmcnt(4)
v_mfma_f32_16x16x32_bf16 v[96:99], a[200:203], v[152:155], 0
ds_read_b128 v[188:191], v19 offset:4096
v_mfma_f32_16x16x32_bf16 v[100:103], a[200:203], v[156:159], 0
v_mfma_f32_16x16x32_bf16 v[104:107], a[200:203], v[160:163], 0
ds_read_b128 v[192:195], v19 offset:6144
v_mfma_f32_16x16x32_bf16 v[108:111], a[200:203], v[164:167], 0
ds_read_b128 v[196:199], v19 offset:8192
buffer_load_dwordx4 v12, s[4:7], s54 offen offset:2048 lds
v_mfma_f32_16x16x32_bf16 v[112:115], a[200:203], v[168:171], 0
ds_read_b128 v[200:203], v19 offset:10240
v_mfma_f32_16x16x32_bf16 v[116:119], a[200:203], v[172:175], 0
v_mfma_f32_16x16x32_bf16 v[120:123], a[200:203], v[176:179], 0
ds_read_b128 v[204:207], v19 offset:12288
buffer_load_dwordx4 v13, s[4:7], s54 offen offset:3072 lds
s_lshr_b64 s[98:99], s[98:99], 4
s_and_b32 s54, s98, 15
s_lshl_b32 s54, s54, 7
v_mfma_f32_16x16x32_bf16 v[124:127], a[204:207], v[152:155], 0
ds_read_b64_tr_b16 a[212:213], v21 offset:4096
v_mfma_f32_16x16x32_bf16 v[128:131], a[204:207], v[156:159], 0
v_mfma_f32_16x16x32_bf16 v[132:135], a[204:207], v[160:163], 0
ds_read_b64_tr_b16 a[214:215], v21 offset:4608
v_mfma_f32_16x16x32_bf16 v[136:139], a[204:207], v[164:167], 0
ds_read_b64_tr_b16 a[216:217], v22 offset:4096
s_add_u32 m0, s52, 65536
s_add_u32 s86, s55, 262144
buffer_load_dwordx4 v14, s[8:11], s55 offen offset:0 lds
v_mfma_f32_16x16x32_bf16 v[140:143], a[204:207], v[168:171], 0
v_mfma_f32_16x16x32_bf16 v[144:147], a[204:207], v[172:175], 0
ds_read_b64_tr_b16 a[218:219], v22 offset:4608
v_mfma_f32_16x16x32_bf16 v[148:151], a[204:207], v[176:179], 0
ds_read_b64_tr_b16 a[220:221], v23 offset:4096
s_waitcnt lgkmcnt(5)
v_mfma_f32_16x16x32_bf16 v[40:43], a[208:211], v[180:183], v[40:43]
buffer_load_dwordx4 v15, s[8:11], s55 offen offset:1024 lds
v_mfma_f32_16x16x32_bf16 v[44:47], a[208:211], v[184:187], v[44:47]
ds_read_b64_tr_b16 a[222:223], v23 offset:4608
v_mfma_f32_16x16x32_bf16 v[48:51], a[208:211], v[188:191], v[48:51]
v_mfma_f32_16x16x32_bf16 v[52:55], a[208:211], v[192:195], v[52:55]
v_mfma_f32_16x16x32_bf16 v[56:59], a[208:211], v[196:199], v[56:59]
buffer_load_dwordx4 v16, s[8:11], s55 offen offset:2048 lds
v_mfma_f32_16x16x32_bf16 v[60:63], a[208:211], v[200:203], v[60:63]
v_mfma_f32_16x16x32_bf16 v[64:67], a[208:211], v[204:207], v[64:67]
s_waitcnt lgkmcnt(0)
v_mfma_f32_16x16x32_bf16 v[68:71], a[212:215], v[180:183], v[68:71]
v_mfma_f32_16x16x32_bf16 v[72:75], a[212:215], v[184:187], v[72:75]
buffer_load_dwordx4 v17, s[8:11], s55 offen offset:3072 lds
s_lshr_b64 s[96:97], s[96:97], 4
s_and_b32 s55, s96, 15
s_lshl_b32 s55, s55, 19
v_mfma_f32_16x16x32_bf16 v[76:79], a[212:215], v[188:191], v[76:79]
v_mfma_f32_16x16x32_bf16 v[80:83], a[212:215], v[192:195], v[80:83]
v_mfma_f32_16x16x32_bf16 v[84:87], a[212:215], v[196:199], v[84:87]
v_mfma_f32_16x16x32_bf16 v[88:91], a[212:215], v[200:203], v[88:91]
s_waitcnt vmcnt(4) lgkmcnt(0)
s_barrier
ds_read_b64_tr_b16 a[192:193], v20 offset:32768
v_mfma_f32_16x16x32_bf16 v[92:95], a[212:215], v[204:207], v[92:95]
ds_read_b64_tr_b16 a[194:195], v20 offset:33280
v_mfma_f32_16x16x32_bf16 v[96:99], a[216:219], v[180:183], v[96:99]
ds_read_b128 v[152:155], v18 offset:16384
s_add_u32 m0, s52, 69632
s_nop 0
buffer_load_dwordx4 v14, s[8:11], s86 offen offset:0 lds
v_mfma_f32_16x16x32_bf16 v[100:103], a[216:219], v[184:187], v[100:103]
v_mfma_f32_16x16x32_bf16 v[104:107], a[216:219], v[188:191], v[104:107]
ds_read_b128 v[156:159], v18 offset:18432
buffer_load_dwordx4 v15, s[8:11], s86 offen offset:1024 lds
v_mfma_f32_16x16x32_bf16 v[108:111], a[216:219], v[192:195], v[108:111]
ds_read_b128 v[160:163], v18 offset:20480
v_mfma_f32_16x16x32_bf16 v[112:115], a[216:219], v[196:199], v[112:115]
ds_read_b128 v[164:167], v18 offset:22528
v_mfma_f32_16x16x32_bf16 v[116:119], a[216:219], v[200:203], v[116:119]
ds_read_b128 v[168:171], v18 offset:24576
buffer_load_dwordx4 v16, s[8:11], s86 offen offset:2048 lds
v_mfma_f32_16x16x32_bf16 v[120:123], a[216:219], v[204:207], v[120:123]
ds_read_b128 v[172:175], v18 offset:26624
v_mfma_f32_16x16x32_bf16 v[124:127], a[220:223], v[180:183], v[124:127]
buffer_load_dwordx4 v17, s[8:11], s86 offen offset:3072 lds
v_mfma_f32_16x16x32_bf16 v[128:131], a[220:223], v[184:187], v[128:131]
ds_read_b128 v[176:179], v18 offset:28672
v_mfma_f32_16x16x32_bf16 v[132:135], a[220:223], v[188:191], v[132:135]
ds_read_b64_tr_b16 a[196:197], v21 offset:32768
v_mfma_f32_16x16x32_bf16 v[136:139], a[220:223], v[192:195], v[136:139]
ds_read_b64_tr_b16 a[198:199], v21 offset:33280
s_add_u32 m0, s80, 131072
s_nop 0
buffer_load_dwordx4 v10, s[4:7], s54 offen offset:0 lds
v_mfma_f32_16x16x32_bf16 v[140:143], a[220:223], v[196:199], v[140:143]
v_mfma_f32_16x16x32_bf16 v[144:147], a[220:223], v[200:203], v[144:147]
buffer_load_dwordx4 v11, s[4:7], s54 offen offset:1024 lds
v_mfma_f32_16x16x32_bf16 v[148:151], a[220:223], v[204:207], v[148:151]
s_waitcnt lgkmcnt(2)
v_mfma_f32_16x16x32_bf16 v[40:43], a[192:195], v[152:155], v[40:43]
v_mfma_f32_16x16x32_bf16 v[44:47], a[192:195], v[156:159], v[44:47]
buffer_load_dwordx4 v12, s[4:7], s54 offen offset:2048 lds
v_mfma_f32_16x16x32_bf16 v[48:51], a[192:195], v[160:163], v[48:51]
ds_read_b64_tr_b16 a[200:201], v22 offset:32768
v_mfma_f32_16x16x32_bf16 v[52:55], a[192:195], v[164:167], v[52:55]
v_mfma_f32_16x16x32_bf16 v[56:59], a[192:195], v[168:171], v[56:59]
ds_read_b64_tr_b16 a[202:203], v22 offset:33280
buffer_load_dwordx4 v13, s[4:7], s54 offen offset:3072 lds
s_lshr_b64 s[98:99], s[98:99], 4
s_and_b32 s54, s98, 15
s_lshl_b32 s54, s54, 7
v_mfma_f32_16x16x32_bf16 v[60:63], a[192:195], v[172:175], v[60:63]
ds_read_b64_tr_b16 a[204:205], v23 offset:32768
v_mfma_f32_16x16x32_bf16 v[64:67], a[192:195], v[176:179], v[64:67]
s_add_u32 m0, s52, 0
s_add_u32 s86, s55, 262144
buffer_load_dwordx4 v14, s[8:11], s55 offen offset:0 lds
s_waitcnt lgkmcnt(3)
v_mfma_f32_16x16x32_bf16 v[68:71], a[196:199], v[152:155], v[68:71]
ds_read_b64_tr_b16 a[206:207], v23 offset:33280
v_mfma_f32_16x16x32_bf16 v[72:75], a[196:199], v[156:159], v[72:75]
ds_read_b64_tr_b16 a[208:209], v20 offset:36864
v_mfma_f32_16x16x32_bf16 v[76:79], a[196:199], v[160:163], v[76:79]
buffer_load_dwordx4 v15, s[8:11], s55 offen offset:1024 lds
v_mfma_f32_16x16x32_bf16 v[80:83], a[196:199], v[164:167], v[80:83]
ds_read_b64_tr_b16 a[210:211], v20 offset:37376
v_mfma_f32_16x16x32_bf16 v[84:87], a[196:199], v[168:171], v[84:87]
ds_read_b128 v[180:183], v19 offset:16384
v_mfma_f32_16x16x32_bf16 v[88:91], a[196:199], v[172:175], v[88:91]
buffer_load_dwordx4 v16, s[8:11], s55 offen offset:2048 lds
v_mfma_f32_16x16x32_bf16 v[92:95], a[196:199], v[176:179], v[92:95]
ds_read_b128 v[184:187], v19 offset:18432
s_waitcnt lgkmcnt(4)
v_mfma_f32_16x16x32_bf16 v[96:99], a[200:203], v[152:155], v[96:99]
ds_read_b128 v[188:191], v19 offset:20480
buffer_load_dwordx4 v17, s[8:11], s55 offen offset:3072 lds
s_lshr_b64 s[96:97], s[96:97], 4
s_and_b32 s55, s96, 15
s_lshl_b32 s55, s55, 19
v_mfma_f32_16x16x32_bf16 v[100:103], a[200:203], v[156:159], v[100:103]
v_mfma_f32_16x16x32_bf16 v[104:107], a[200:203], v[160:163], v[104:107]
ds_read_b128 v[192:195], v19 offset:22528
v_mfma_f32_16x16x32_bf16 v[108:111], a[200:203], v[164:167], v[108:111]
ds_read_b128 v[196:199], v19 offset:24576
s_add_u32 m0, s52, 4096
s_nop 0
buffer_load_dwordx4 v14, s[8:11], s86 offen offset:0 lds
v_mfma_f32_16x16x32_bf16 v[112:115], a[200:203], v[168:171], v[112:115]
ds_read_b128 v[200:203], v19 offset:26624
v_mfma_f32_16x16x32_bf16 v[116:119], a[200:203], v[172:175], v[116:119]
v_mfma_f32_16x16x32_bf16 v[120:123], a[200:203], v[176:179], v[120:123]
ds_read_b128 v[204:207], v19 offset:28672
buffer_load_dwordx4 v15, s[8:11], s86 offen offset:1024 lds
v_mfma_f32_16x16x32_bf16 v[124:127], a[204:207], v[152:155], v[124:127]
ds_read_b64_tr_b16 a[212:213], v21 offset:36864
v_mfma_f32_16x16x32_bf16 v[128:131], a[204:207], v[156:159], v[128:131]
v_mfma_f32_16x16x32_bf16 v[132:135], a[204:207], v[160:163], v[132:135]
ds_read_b64_tr_b16 a[214:215], v21 offset:37376
buffer_load_dwordx4 v16, s[8:11], s86 offen offset:2048 lds
v_mfma_f32_16x16x32_bf16 v[136:139], a[204:207], v[164:167], v[136:139]
ds_read_b64_tr_b16 a[216:217], v22 offset:36864
v_mfma_f32_16x16x32_bf16 v[140:143], a[204:207], v[168:171], v[140:143]
buffer_load_dwordx4 v17, s[8:11], s86 offen offset:3072 lds
v_mfma_f32_16x16x32_bf16 v[144:147], a[204:207], v[172:175], v[144:147]
ds_read_b64_tr_b16 a[218:219], v22 offset:37376
v_mfma_f32_16x16x32_bf16 v[148:151], a[204:207], v[176:179], v[148:151]
ds_read_b64_tr_b16 a[220:221], v23 offset:36864
s_waitcnt lgkmcnt(5)
v_mfma_f32_16x16x32_bf16 v[40:43], a[208:211], v[180:183], v[40:43]
s_add_u32 m0, s80, 98304
s_nop 0
buffer_load_dwordx4 v10, s[4:7], s54 offen offset:0 lds
v_mfma_f32_16x16x32_bf16 v[44:47], a[208:211], v[184:187], v[44:47]
ds_read_b64_tr_b16 a[222:223], v23 offset:37376
v_mfma_f32_16x16x32_bf16 v[48:51], a[208:211], v[188:191], v[48:51]
v_mfma_f32_16x16x32_bf16 v[52:55], a[208:211], v[192:195], v[52:55]
buffer_load_dwordx4 v11, s[4:7], s54 offen offset:1024 lds
v_mfma_f32_16x16x32_bf16 v[56:59], a[208:211], v[196:199], v[56:59]
v_mfma_f32_16x16x32_bf16 v[60:63], a[208:211], v[200:203], v[60:63]
buffer_load_dwordx4 v12, s[4:7], s54 offen offset:2048 lds
v_mfma_f32_16x16x32_bf16 v[64:67], a[208:211], v[204:207], v[64:67]
s_waitcnt lgkmcnt(0)
v_mfma_f32_16x16x32_bf16 v[68:71], a[212:215], v[180:183], v[68:71]
v_mfma_f32_16x16x32_bf16 v[72:75], a[212:215], v[184:187], v[72:75]
buffer_load_dwordx4 v13, s[4:7], s54 offen offset:3072 lds
s_lshr_b64 s[98:99], s[98:99], 4
s_and_b32 s54, s98, 15
s_lshl_b32 s54, s54, 7
v_mfma_f32_16x16x32_bf16 v[76:79], a[212:215], v[188:191], v[76:79]
v_mfma_f32_16x16x32_bf16 v[80:83], a[212:215], v[192:195], v[80:83]
v_mfma_f32_16x16x32_bf16 v[84:87], a[212:215], v[196:199], v[84:87]
v_mfma_f32_16x16x32_bf16 v[88:91], a[212:215], v[200:203], v[88:91]
s_waitcnt vmcnt(12) lgkmcnt(0)
s_barrier
ds_read_b64_tr_b16 a[192:193], v24 offset:0
v_mfma_f32_16x16x32_bf16 v[92:95], a[212:215], v[204:207], v[92:95]
ds_read_b64_tr_b16 a[194:195], v24 offset:512
v_mfma_f32_16x16x32_bf16 v[96:99], a[216:219], v[180:183], v[96:99]
ds_read_b128 v[152:155], v18 offset:32768
v_mfma_f32_16x16x32_bf16 v[100:103], a[216:219], v[184:187], v[100:103]
s_add_u32 m0, s52, 32768
s_add_u32 s86, s55, 262144
buffer_load_dwordx4 v14, s[8:11], s55 offen offset:0 lds
v_mfma_f32_16x16x32_bf16 v[104:107], a[216:219], v[188:191], v[104:107]
ds_read_b128 v[156:159], v18 offset:34816
v_mfma_f32_16x16x32_bf16 v[108:111], a[216:219], v[192:195], v[108:111]
ds_read_b128 v[160:163], v18 offset:36864
v_mfma_f32_16x16x32_bf16 v[112:115], a[216:219], v[196:199], v[112:115]
ds_read_b128 v[164:167], v18 offset:38912
v_mfma_f32_16x16x32_bf16 v[116:119], a[216:219], v[200:203], v[116:119]
ds_read_b128 v[168:171], v18 offset:40960
v_mfma_f32_16x16x32_bf16 v[120:123], a[216:219], v[204:207], v[120:123]
ds_read_b128 v[172:175], v18 offset:43008
buffer_load_dwordx4 v15, s[8:11], s55 offen offset:1024 lds
v_mfma_f32_16x16x32_bf16 v[124:127], a[220:223], v[180:183], v[124:127]
v_mfma_f32_16x16x32_bf16 v[128:131], a[220:223], v[184:187], v[128:131]
ds_read_b128 v[176:179], v18 offset:45056
v_mfma_f32_16x16x32_bf16 v[132:135], a[220:223], v[188:191], v[132:135]
ds_read_b64_tr_b16 a[196:197], v25 offset:0
v_mfma_f32_16x16x32_bf16 v[136:139], a[220:223], v[192:195], v[136:139]
ds_read_b64_tr_b16 a[198:199], v25 offset:512
v_mfma_f32_16x16x32_bf16 v[140:143], a[220:223], v[196:199], v[140:143]
buffer_load_dwordx4 v16, s[8:11], s55 offen offset:2048 lds
v_mfma_f32_16x16x32_bf16 v[144:147], a[220:223], v[200:203], v[144:147]
v_mfma_f32_16x16x32_bf16 v[148:151], a[220:223], v[204:207], v[148:151]
s_waitcnt lgkmcnt(2)
v_mfma_f32_16x16x32_bf16 v[40:43], a[192:195], v[152:155], v[40:43]
v_mfma_f32_16x16x32_bf16 v[44:47], a[192:195], v[156:159], v[44:47]
v_mfma_f32_16x16x32_bf16 v[48:51], a[192:195], v[160:163], v[48:51]
ds_read_b64_tr_b16 a[200:201], v26 offset:0
buffer_load_dwordx4 v17, s[8:11], s55 offen offset:3072 lds
s_lshr_b64 s[96:97], s[96:97], 4
s_and_b32 s55, s96, 15
s_lshl_b32 s55, s55, 19
v_mfma_f32_16x16x32_bf16 v[52:55], a[192:195], v[164:167], v[52:55]
v_mfma_f32_16x16x32_bf16 v[56:59], a[192:195], v[168:171], v[56:59]
ds_read_b64_tr_b16 a[202:203], v26 offset:512
v_mfma_f32_16x16x32_bf16 v[60:63], a[192:195], v[172:175], v[60:63]
ds_read_b64_tr_b16 a[204:205], v27 offset:0
v_mfma_f32_16x16x32_bf16 v[64:67], a[192:195], v[176:179], v[64:67]
s_add_u32 m0, s52, 36864
s_nop 0
buffer_load_dwordx4 v14, s[8:11], s86 offen offset:0 lds
s_waitcnt lgkmcnt(3)
v_mfma_f32_16x16x32_bf16 v[68:71], a[196:199], v[152:155], v[68:71]
ds_read_b64_tr_b16 a[206:207], v27 offset:512
v_mfma_f32_16x16x32_bf16 v[72:75], a[196:199], v[156:159], v[72:75]
ds_read_b64_tr_b16 a[208:209], v24 offset:4096
v_mfma_f32_16x16x32_bf16 v[76:79], a[196:199], v[160:163], v[76:79]
v_mfma_f32_16x16x32_bf16 v[80:83], a[196:199], v[164:167], v[80:83]
ds_read_b64_tr_b16 a[210:211], v24 offset:4608
buffer_load_dwordx4 v15, s[8:11], s86 offen offset:1024 lds
v_mfma_f32_16x16x32_bf16 v[84:87], a[196:199], v[168:171], v[84:87]
ds_read_b128 v[180:183], v19 offset:32768
v_mfma_f32_16x16x32_bf16 v[88:91], a[196:199], v[172:175], v[88:91]
v_mfma_f32_16x16x32_bf16 v[92:95], a[196:199], v[176:179], v[92:95]
ds_read_b128 v[184:187], v19 offset:34816
s_waitcnt lgkmcnt(4)
v_mfma_f32_16x16x32_bf16 v[96:99], a[200:203], v[152:155], v[96:99]
ds_read_b128 v[188:191], v19 offset:36864
buffer_load_dwordx4 v16, s[8:11], s86 offen offset:2048 lds
v_mfma_f32_16x16x32_bf16 v[100:103], a[200:203], v[156:159], v[100:103]
v_mfma_f32_16x16x32_bf16 v[104:107], a[200:203], v[160:163], v[104:107]
ds_read_b128 v[192:195], v19 offset:38912
v_mfma_f32_16x16x32_bf16 v[108:111], a[200:203], v[164:167], v[108:111]
ds_read_b128 v[196:199], v19 offset:40960
v_mfma_f32_16x16x32_bf16 v[112:115], a[200:203], v[168:171], v[112:115]
ds_read_b128 v[200:203], v19 offset:43008
v_mfma_f32_16x16x32_bf16 v[116:119], a[200:203], v[172:175], v[116:119]
buffer_load_dwordx4 v17, s[8:11], s86 offen offset:3072 lds
v_mfma_f32_16x16x32_bf16 v[120:123], a[200:203], v[176:179], v[120:123]
ds_read_b128 v[204:207], v19 offset:45056
v_mfma_f32_16x16x32_bf16 v[124:127], a[204:207], v[152:155], v[124:127]
ds_read_b64_tr_b16 a[212:213], v25 offset:4096
v_mfma_f32_16x16x32_bf16 v[128:131], a[204:207], v[156:159], v[128:131]
v_mfma_f32_16x16x32_bf16 v[132:135], a[204:207], v[160:163], v[132:135]
ds_read_b64_tr_b16 a[214:215], v25 offset:4608
s_add_u32 m0, s80, 114688
s_nop 0
buffer_load_dwordx4 v10, s[4:7], s54 offen offset:0 lds
v_mfma_f32_16x16x32_bf16 v[136:139], a[204:207], v[164:167], v[136:139]
ds_read_b64_tr_b16 a[216:217], v26 offset:4096
v_mfma_f32_16x16x32_bf16 v[140:143], a[204:207], v[168:171], v[140:143]
v_mfma_f32_16x16x32_bf16 v[144:147], a[204:207], v[172:175], v[144:147]
ds_read_b64_tr_b16 a[218:219], v26 offset:4608
v_mfma_f32_16x16x32_bf16 v[148:151], a[204:207], v[176:179], v[148:151]
ds_read_b64_tr_b16 a[220:221], v27 offset:4096
buffer_load_dwordx4 v11, s[4:7], s54 offen offset:1024 lds
s_waitcnt lgkmcnt(5)
v_mfma_f32_16x16x32_bf16 v[40:43], a[208:211], v[180:183], v[40:43]
v_mfma_f32_16x16x32_bf16 v[44:47], a[208:211], v[184:187], v[44:47]
ds_read_b64_tr_b16 a[222:223], v27 offset:4608
v_mfma_f32_16x16x32_bf16 v[48:51], a[208:211], v[188:191], v[48:51]
v_mfma_f32_16x16x32_bf16 v[52:55], a[208:211], v[192:195], v[52:55]
buffer_load_dwordx4 v12, s[4:7], s54 offen offset:2048 lds
v_mfma_f32_16x16x32_bf16 v[56:59], a[208:211], v[196:199], v[56:59]
v_mfma_f32_16x16x32_bf16 v[60:63], a[208:211], v[200:203], v[60:63]
v_mfma_f32_16x16x32_bf16 v[64:67], a[208:211], v[204:207], v[64:67]
s_waitcnt lgkmcnt(0)
v_mfma_f32_16x16x32_bf16 v[68:71], a[212:215], v[180:183], v[68:71]
buffer_load_dwordx4 v13, s[4:7], s54 offen offset:3072 lds
s_lshr_b64 s[98:99], s[98:99], 4
s_and_b32 s54, s98, 15
s_lshl_b32 s54, s54, 7
v_mfma_f32_16x16x32_bf16 v[72:75], a[212:215], v[184:187], v[72:75]
v_mfma_f32_16x16x32_bf16 v[76:79], a[212:215], v[188:191], v[76:79]
v_mfma_f32_16x16x32_bf16 v[80:83], a[212:215], v[192:195], v[80:83]
v_mfma_f32_16x16x32_bf16 v[84:87], a[212:215], v[196:199], v[84:87]
v_mfma_f32_16x16x32_bf16 v[88:91], a[212:215], v[200:203], v[88:91]
s_waitcnt vmcnt(12) lgkmcnt(0)
s_barrier
ds_read_b64_tr_b16 a[192:193], v20 offset:0
v_mfma_f32_16x16x32_bf16 v[92:95], a[212:215], v[204:207], v[92:95]
ds_read_b64_tr_b16 a[194:195], v20 offset:512
v_mfma_f32_16x16x32_bf16 v[96:99], a[216:219], v[180:183], v[96:99]
ds_read_b128 v[152:155], v18 offset:0
v_mfma_f32_16x16x32_bf16 v[100:103], a[216:219], v[184:187], v[100:103]
s_add_u32 m0, s52, 65536
s_add_u32 s86, s55, 262144
buffer_load_dwordx4 v14, s[8:11], s55 offen offset:0 lds
v_mfma_f32_16x16x32_bf16 v[104:107], a[216:219], v[188:191], v[104:107]
ds_read_b128 v[156:159], v18 offset:2048
v_mfma_f32_16x16x32_bf16 v[108:111], a[216:219], v[192:195], v[108:111]
ds_read_b128 v[160:163], v18 offset:4096
v_mfma_f32_16x16x32_bf16 v[112:115], a[216:219], v[196:199], v[112:115]
ds_read_b128 v[164:167], v18 offset:6144
v_mfma_f32_16x16x32_bf16 v[116:119], a[216:219], v[200:203], v[116:119]
ds_read_b128 v[168:171], v18 offset:8192
v_mfma_f32_16x16x32_bf16 v[120:123], a[216:219], v[204:207], v[120:123]
ds_read_b128 v[172:175], v18 offset:10240
buffer_load_dwordx4 v15, s[8:11], s55 offen offset:1024 lds
v_mfma_f32_16x16x32_bf16 v[124:127], a[220:223], v[180:183], v[124:127]
v_mfma_f32_16x16x32_bf16 v[128:131], a[220:223], v[184:187], v[128:131]
ds_read_b128 v[176:179], v18 offset:12288
v_mfma_f32_16x16x32_bf16 v[132:135], a[220:223], v[188:191], v[132:135]
ds_read_b64_tr_b16 a[196:197], v21 offset:0
v_mfma_f32_16x16x32_bf16 v[136:139], a[220:223], v[192:195], v[136:139]
ds_read_b64_tr_b16 a[198:199], v21 offset:512
v_mfma_f32_16x16x32_bf16 v[140:143], a[220:223], v[196:199], v[140:143]
buffer_load_dwordx4 v16, s[8:11], s55 offen offset:2048 lds
v_mfma_f32_16x16x32_bf16 v[144:147], a[220:223], v[200:203], v[144:147]
v_mfma_f32_16x16x32_bf16 v[148:151], a[220:223], v[204:207], v[148:151]
s_waitcnt lgkmcnt(2)
v_mfma_f32_16x16x32_bf16 v[40:43], a[192:195], v[152:155], v[40:43]
v_mfma_f32_16x16x32_bf16 v[44:47], a[192:195], v[156:159], v[44:47]
v_mfma_f32_16x16x32_bf16 v[48:51], a[192:195], v[160:163], v[48:51]
ds_read_b64_tr_b16 a[200:201], v22 offset:0
buffer_load_dwordx4 v17, s[8:11], s55 offen offset:3072 lds
s_lshr_b64 s[96:97], s[96:97], 4
s_and_b32 s55, s96, 15
s_lshl_b32 s55, s55, 19
v_mfma_f32_16x16x32_bf16 v[52:55], a[192:195], v[164:167], v[52:55]
v_mfma_f32_16x16x32_bf16 v[56:59], a[192:195], v[168:171], v[56:59]
ds_read_b64_tr_b16 a[202:203], v22 offset:512
v_mfma_f32_16x16x32_bf16 v[60:63], a[192:195], v[172:175], v[60:63]
ds_read_b64_tr_b16 a[204:205], v23 offset:0
v_mfma_f32_16x16x32_bf16 v[64:67], a[192:195], v[176:179], v[64:67]
s_add_u32 m0, s52, 69632
s_nop 0
buffer_load_dwordx4 v14, s[8:11], s86 offen offset:0 lds
s_waitcnt lgkmcnt(3)
v_mfma_f32_16x16x32_bf16 v[68:71], a[196:199], v[152:155], v[68:71]
ds_read_b64_tr_b16 a[206:207], v23 offset:512
v_mfma_f32_16x16x32_bf16 v[72:75], a[196:199], v[156:159], v[72:75]
ds_read_b64_tr_b16 a[208:209], v20 offset:4096
v_mfma_f32_16x16x32_bf16 v[76:79], a[196:199], v[160:163], v[76:79]
v_mfma_f32_16x16x32_bf16 v[80:83], a[196:199], v[164:167], v[80:83]
ds_read_b64_tr_b16 a[210:211], v20 offset:4608
buffer_load_dwordx4 v15, s[8:11], s86 offen offset:1024 lds
v_mfma_f32_16x16x32_bf16 v[84:87], a[196:199], v[168:171], v[84:87]
ds_read_b128 v[180:183], v19 offset:0
v_mfma_f32_16x16x32_bf16 v[88:91], a[196:199], v[172:175], v[88:91]
v_mfma_f32_16x16x32_bf16 v[92:95], a[196:199], v[176:179], v[92:95]
ds_read_b128 v[184:187], v19 offset:2048
s_waitcnt lgkmcnt(4)
v_mfma_f32_16x16x32_bf16 v[96:99], a[200:203], v[152:155], v[96:99]
ds_read_b128 v[188:191], v19 offset:4096
buffer_load_dwordx4 v16, s[8:11], s86 offen offset:2048 lds
v_mfma_f32_16x16x32_bf16 v[100:103], a[200:203], v[156:159], v[100:103]
v_mfma_f32_16x16x32_bf16 v[104:107], a[200:203], v[160:163], v[104:107]
ds_read_b128 v[192:195], v19 offset:6144
v_mfma_f32_16x16x32_bf16 v[108:111], a[200:203], v[164:167], v[108:111]
ds_read_b128 v[196:199], v19 offset:8192
v_mfma_f32_16x16x32_bf16 v[112:115], a[200:203], v[168:171], v[112:115]
ds_read_b128 v[200:203], v19 offset:10240
v_mfma_f32_16x16x32_bf16 v[116:119], a[200:203], v[172:175], v[116:119]
buffer_load_dwordx4 v17, s[8:11], s86 offen offset:3072 lds
v_mfma_f32_16x16x32_bf16 v[120:123], a[200:203], v[176:179], v[120:123]
ds_read_b128 v[204:207], v19 offset:12288
v_mfma_f32_16x16x32_bf16 v[124:127], a[204:207], v[152:155], v[124:127]
ds_read_b64_tr_b16 a[212:213], v21 offset:4096
v_mfma_f32_16x16x32_bf16 v[128:131], a[204:207], v[156:159], v[128:131]
v_mfma_f32_16x16x32_bf16 v[132:135], a[204:207], v[160:163], v[132:135]
ds_read_b64_tr_b16 a[214:215], v21 offset:4608
s_add_u32 m0, s80, 131072
s_nop 0
buffer_load_dwordx4 v10, s[4:7], s54 offen offset:0 lds
v_mfma_f32_16x16x32_bf16 v[136:139], a[204:207], v[164:167], v[136:139]
ds_read_b64_tr_b16 a[216:217], v22 offset:4096
v_mfma_f32_16x16x32_bf16 v[140:143], a[204:207], v[168:171], v[140:143]
v_mfma_f32_16x16x32_bf16 v[144:147], a[204:207], v[172:175], v[144:147]
ds_read_b64_tr_b16 a[218:219], v22 offset:4608
v_mfma_f32_16x16x32_bf16 v[148:151], a[204:207], v[176:179], v[148:151]
ds_read_b64_tr_b16 a[220:221], v23 offset:4096
buffer_load_dwordx4 v11, s[4:7], s54 offen offset:1024 lds
s_waitcnt lgkmcnt(5)
v_mfma_f32_16x16x32_bf16 v[40:43], a[208:211], v[180:183], v[40:43]
v_mfma_f32_16x16x32_bf16 v[44:47], a[208:211], v[184:187], v[44:47]
ds_read_b64_tr_b16 a[222:223], v23 offset:4608
v_mfma_f32_16x16x32_bf16 v[48:51], a[208:211], v[188:191], v[48:51]
v_mfma_f32_16x16x32_bf16 v[52:55], a[208:211], v[192:195], v[52:55]
buffer_load_dwordx4 v12, s[4:7], s54 offen offset:2048 lds
v_mfma_f32_16x16x32_bf16 v[56:59], a[208:211], v[196:199], v[56:59]
v_mfma_f32_16x16x32_bf16 v[60:63], a[208:211], v[200:203], v[60:63]
v_mfma_f32_16x16x32_bf16 v[64:67], a[208:211], v[204:207], v[64:67]
s_waitcnt lgkmcnt(0)
v_mfma_f32_16x16x32_bf16 v[68:71], a[212:215], v[180:183], v[68:71]
buffer_load_dwordx4 v13, s[4:7], s54 offen offset:3072 lds
s_lshr_b64 s[98:99], s[98:99], 4
s_and_b32 s54, s98, 15
s_lshl_b32 s54, s54, 7
v_mfma_f32_16x16x32_bf16 v[72:75], a[212:215], v[184:187], v[72:75]
v_mfma_f32_16x16x32_bf16 v[76:79], a[212:215], v[188:191], v[76:79]
v_mfma_f32_16x16x32_bf16 v[80:83], a[212:215], v[192:195], v[80:83]
v_mfma_f32_16x16x32_bf16 v[84:87], a[212:215], v[196:199], v[84:87]
v_mfma_f32_16x16x32_bf16 v[88:91], a[212:215], v[200:203], v[88:91]
s_waitcnt vmcnt(12) lgkmcnt(0)
s_barrier
ds_read_b64_tr_b16 a[192:193], v20 offset:32768
v_mfma_f32_16x16x32_bf16 v[92:95], a[212:215], v[204:207], v[92:95]
ds_read_b64_tr_b16 a[194:195], v20 offset:33280
v_mfma_f32_16x16x32_bf16 v[96:99], a[216:219], v[180:183], v[96:99]
ds_read_b128 v[152:155], v18 offset:16384
v_mfma_f32_16x16x32_bf16 v[100:103], a[216:219], v[184:187], v[100:103]
s_add_u32 m0, s52, 0
s_add_u32 s86, s55, 262144
buffer_load_dwordx4 v14, s[8:11], s55 offen offset:0 lds
v_mfma_f32_16x16x32_bf16 v[104:107], a[216:219], v[188:191], v[104:107]
ds_read_b128 v[156:159], v18 offset:18432
v_mfma_f32_16x16x32_bf16 v[108:111], a[216:219], v[192:195], v[108:111]
ds_read_b128 v[160:163], v18 offset:20480
v_mfma_f32_16x16x32_bf16 v[112:115], a[216:219], v[196:199], v[112:115]
ds_read_b128 v[164:167], v18 offset:22528
v_mfma_f32_16x16x32_bf16 v[116:119], a[216:219], v[200:203], v[116:119]
ds_read_b128 v[168:171], v18 offset:24576
v_mfma_f32_16x16x32_bf16 v[120:123], a[216:219], v[204:207], v[120:123]
ds_read_b128 v[172:175], v18 offset:26624
buffer_load_dwordx4 v15, s[8:11], s55 offen offset:1024 lds
v_mfma_f32_16x16x32_bf16 v[124:127], a[220:223], v[180:183], v[124:127]
v_mfma_f32_16x16x32_bf16 v[128:131], a[220:223], v[184:187], v[128:131]
ds_read_b128 v[176:179], v18 offset:28672
v_mfma_f32_16x16x32_bf16 v[132:135], a[220:223], v[188:191], v[132:135]
ds_read_b64_tr_b16 a[196:197], v21 offset:32768
v_mfma_f32_16x16x32_bf16 v[136:139], a[220:223], v[192:195], v[136:139]
ds_read_b64_tr_b16 a[198:199], v21 offset:33280
v_mfma_f32_16x16x32_bf16 v[140:143], a[220:223], v[196:199], v[140:143]
buffer_load_dwordx4 v16, s[8:11], s55 offen offset:2048 lds
v_mfma_f32_16x16x32_bf16 v[144:147], a[220:223], v[200:203], v[144:147]
v_mfma_f32_16x16x32_bf16 v[148:151], a[220:223], v[204:207], v[148:151]
s_mov_b32 s53, 3
L_gl_2:
s_waitcnt lgkmcnt(2)
v_mfma_f32_16x16x32_bf16 v[40:43], a[192:195], v[152:155], v[40:43]
v_mfma_f32_16x16x32_bf16 v[44:47], a[192:195], v[156:159], v[44:47]
v_mfma_f32_16x16x32_bf16 v[48:51], a[192:195], v[160:163], v[48:51]
ds_read_b64_tr_b16 a[200:201], v22 offset:32768
buffer_load_dwordx4 v17, s[8:11], s55 offen offset:3072 lds
s_lshr_b64 s[96:97], s[96:97], 4
s_and_b32 s55, s96, 15
s_lshl_b32 s55, s55, 19
v_mfma_f32_16x16x32_bf16 v[52:55], a[192:195], v[164:167], v[52:55]
v_mfma_f32_16x16x32_bf16 v[56:59], a[192:195], v[168:171], v[56:59]
ds_read_b64_tr_b16 a[202:203], v22 offset:33280
v_mfma_f32_16x16x32_bf16 v[60:63], a[192:195], v[172:175], v[60:63]
ds_read_b64_tr_b16 a[204:205], v23 offset:32768
v_mfma_f32_16x16x32_bf16 v[64:67], a[192:195], v[176:179], v[64:67]
s_add_u32 m0, s52, 4096
s_nop 0
buffer_load_dwordx4 v14, s[8:11], s86 offen offset:0 lds
s_waitcnt lgkmcnt(3)
v_mfma_f32_16x16x32_bf16 v[68:71], a[196:199], v[152:155], v[68:71]
ds_read_b64_tr_b16 a[206:207], v23 offset:33280
v_mfma_f32_16x16x32_bf16 v[72:75], a[196:199], v[156:159], v[72:75]
ds_read_b64_tr_b16 a[208:209], v20 offset:36864
v_mfma_f32_16x16x32_bf16 v[76:79], a[196:199], v[160:163], v[76:79]
v_mfma_f32_16x16x32_bf16 v[80:83], a[196:199], v[164:167], v[80:83]
ds_read_b64_tr_b16 a[210:211], v20 offset:37376
buffer_load_dwordx4 v15, s[8:11], s86 offen offset:1024 lds
v_mfma_f32_16x16x32_bf16 v[84:87], a[196:199], v[168:171], v[84:87]
ds_read_b128 v[180:183], v19 offset:16384
v_mfma_f32_16x16x32_bf16 v[88:91], a[196:199], v[172:175], v[88:91]
v_mfma_f32_16x16x32_bf16 v[92:95], a[196:199], v[176:179], v[92:95]
ds_read_b128 v[184:187], v19 offset:18432
s_waitcnt lgkmcnt(4)
v_mfma_f32_16x16x32_bf16 v[96:99], a[200:203], v[152:155], v[96:99]
ds_read_b128 v[188:191], v19 offset:20480
buffer_load_dwordx4 v16, s[8:11], s86 offen offset:2048 lds
v_mfma_f32_16x16x32_bf16 v[100:103], a[200:203], v[156:159], v[100:103]
v_mfma_f32_16x16x32_bf16 v[104:107], a[200:203], v[160:163], v[104:107]
ds_read_b128 v[192:195], v19 offset:22528
v_mfma_f32_16x16x32_bf16 v[108:111], a[200:203], v[164:167], v[108:111]
ds_read_b128 v[196:199], v19 offset:24576
v_mfma_f32_16x16x32_bf16 v[112:115], a[200:203], v[168:171], v[112:115]
ds_read_b128 v[200:203], v19 offset:26624
v_mfma_f32_16x16x32_bf16 v[116:119], a[200:203], v[172:175], v[116:119]
buffer_load_dwordx4 v17, s[8:11], s86 offen offset:3072 lds
v_mfma_f32_16x16x32_bf16 v[120:123], a[200:203], v[176:179], v[120:123]
ds_read_b128 v[204:207], v19 offset:28672
v_mfma_f32_16x16x32_bf16 v[124:127], a[204:207], v[152:155], v[124:127]
ds_read_b64_tr_b16 a[212:213], v21 offset:36864
v_mfma_f32_16x16x32_bf16 v[128:131], a[204:207], v[156:159], v[128:131]
v_mfma_f32_16x16x32_bf16 v[132:135], a[204:207], v[160:163], v[132:135]
ds_read_b64_tr_b16 a[214:215], v21 offset:37376
s_add_u32 m0, s80, 98304
s_nop 0
buffer_load_dwordx4 v10, s[4:7], s54 offen offset:0 lds
v_mfma_f32_16x16x32_bf16 v[136:139], a[204:207], v[164:167], v[136:139]
ds_read_b64_tr_b16 a[216:217], v22 offset:36864
v_mfma_f32_16x16x32_bf16 v[140:143], a[204:207], v[168:171], v[140:143]
v_mfma_f32_16x16x32_bf16 v[144:147], a[204:207], v[172:175], v[144:147]
ds_read_b64_tr_b16 a[218:219], v22 offset:37376
v_mfma_f32_16x16x32_bf16 v[148:151], a[204:207], v[176:179], v[148:151]
ds_read_b64_tr_b16 a[220:221], v23 offset:36864
buffer_load_dwordx4 v11, s[4:7], s54 offen offset:1024 lds
s_waitcnt lgkmcnt(5)
v_mfma_f32_16x16x32_bf16 v[40:43], a[208:211], v[180:183], v[40:43]
v_mfma_f32_16x16x32_bf16 v[44:47], a[208:211], v[184:187], v[44:47]
ds_read_b64_tr_b16 a[222:223], v23 offset:37376
v_mfma_f32_16x16x32_bf16 v[48:51], a[208:211], v[188:191], v[48:51]
v_mfma_f32_16x16x32_bf16 v[52:55], a[208:211], v[192:195], v[52:55]
buffer_load_dwordx4 v12, s[4:7], s54 offen offset:2048 lds
v_mfma_f32_16x16x32_bf16 v[56:59], a[208:211], v[196:199], v[56:59]
v_mfma_f32_16x16x32_bf16 v[60:63], a[208:211], v[200:203], v[60:63]
v_mfma_f32_16x16x32_bf16 v[64:67], a[208:211], v[204:207], v[64:67]
s_waitcnt lgkmcnt(0)
v_mfma_f32_16x16x32_bf16 v[68:71], a[212:215], v[180:183], v[68:71]
buffer_load_dwordx4 v13, s[4:7], s54 offen offset:3072 lds
s_lshr_b64 s[98:99], s[98:99], 4
s_and_b32 s54, s98, 15
s_lshl_b32 s54, s54, 7
v_mfma_f32_16x16x32_bf16 v[72:75], a[212:215], v[184:187], v[72:75]
v_mfma_f32_16x16x32_bf16 v[76:79], a[212:215], v[188:191], v[76:79]
v_mfma_f32_16x16x32_bf16 v[80:83], a[212:215], v[192:195], v[80:83]
v_mfma_f32_16x16x32_bf16 v[84:87], a[212:215], v[196:199], v[84:87]
v_mfma_f32_16x16x32_bf16 v[88:91], a[212:215], v[200:203], v[88:91]
s_waitcnt vmcnt(12) lgkmcnt(0)
s_barrier
ds_read_b64_tr_b16 a[192:193], v24 offset:0
v_mfma_f32_16x16x32_bf16 v[92:95], a[212:215], v[204:207], v[92:95]
ds_read_b64_tr_b16 a[194:195], v24 offset:512
v_mfma_f32_16x16x32_bf16 v[96:99], a[216:219], v[180:183], v[96:99]
ds_read_b128 v[152:155], v18 offset:32768
v_mfma_f32_16x16x32_bf16 v[100:103], a[216:219], v[184:187], v[100:103]
s_add_u32 m0, s52, 32768
s_add_u32 s86, s55, 262144
buffer_load_dwordx4 v14, s[8:11], s55 offen offset:0 lds
v_mfma_f32_16x16x32_bf16 v[104:107], a[216:219], v[188:191], v[104:107]
ds_read_b128 v[156:159], v18 offset:34816
v_mfma_f32_16x16x32_bf16 v[108:111], a[216:219], v[192:195], v[108:111]
ds_read_b128 v[160:163], v18 offset:36864
v_mfma_f32_16x16x32_bf16 v[112:115], a[216:219], v[196:199], v[112:115]
ds_read_b128 v[164:167], v18 offset:38912
v_mfma_f32_16x16x32_bf16 v[116:119], a[216:219], v[200:203], v[116:119]
ds_read_b128 v[168:171], v18 offset:40960
v_mfma_f32_16x16x32_bf16 v[120:123], a[216:219], v[204:207], v[120:123]
ds_read_b128 v[172:175], v18 offset:43008
buffer_load_dwordx4 v15, s[8:11], s55 offen offset:1024 lds
v_mfma_f32_16x16x32_bf16 v[124:127], a[220:223], v[180:183], v[124:127]
v_mfma_f32_16x16x32_bf16 v[128:131], a[220:223], v[184:187], v[128:131]
ds_read_b128 v[176:179], v18 offset:45056
v_mfma_f32_16x16x32_bf16 v[132:135], a[220:223], v[188:191], v[132:135]
ds_read_b64_tr_b16 a[196:197], v25 offset:0
v_mfma_f32_16x16x32_bf16 v[136:139], a[220:223], v[192:195], v[136:139]
ds_read_b64_tr_b16 a[198:199], v25 offset:512
v_mfma_f32_16x16x32_bf16 v[140:143], a[220:223], v[196:199], v[140:143]
buffer_load_dwordx4 v16, s[8:11], s55 offen offset:2048 lds
v_mfma_f32_16x16x32_bf16 v[144:147], a[220:223], v[200:203], v[144:147]
v_mfma_f32_16x16x32_bf16 v[148:151], a[220:223], v[204:207], v[148:151]
s_waitcnt lgkmcnt(2)
v_mfma_f32_16x16x32_bf16 v[40:43], a[192:195], v[152:155], v[40:43]
v_mfma_f32_16x16x32_bf16 v[44:47], a[192:195], v[156:159], v[44:47]
v_mfma_f32_16x16x32_bf16 v[48:51], a[192:195], v[160:163], v[48:51]
ds_read_b64_tr_b16 a[200:201], v26 offset:0
buffer_load_dwordx4 v17, s[8:11], s55 offen offset:3072 lds
s_lshr_b64 s[96:97], s[96:97], 4
s_and_b32 s55, s96, 15
s_lshl_b32 s55, s55, 19
v_mfma_f32_16x16x32_bf16 v[52:55], a[192:195], v[164:167], v[52:55]
v_mfma_f32_16x16x32_bf16 v[56:59], a[192:195], v[168:171], v[56:59]
ds_read_b64_tr_b16 a[202:203], v26 offset:512
v_mfma_f32_16x16x32_bf16 v[60:63], a[192:195], v[172:175], v[60:63]
ds_read_b64_tr_b16 a[204:205], v27 offset:0
v_mfma_f32_16x16x32_bf16 v[64:67], a[192:195], v[176:179], v[64:67]
s_add_u32 m0, s52, 36864
s_nop 0
buffer_load_dwordx4 v14, s[8:11], s86 offen offset:0 lds
s_waitcnt lgkmcnt(3)
v_mfma_f32_16x16x32_bf16 v[68:71], a[196:199], v[152:155], v[68:71]
ds_read_b64_tr_b16 a[206:207], v27 offset:512
v_mfma_f32_16x16x32_bf16 v[72:75], a[196:199], v[156:159], v[72:75]
ds_read_b64_tr_b16 a[208:209], v24 offset:4096
v_mfma_f32_16x16x32_bf16 v[76:79], a[196:199], v[160:163], v[76:79]
v_mfma_f32_16x16x32_bf16 v[80:83], a[196:199], v[164:167], v[80:83]
ds_read_b64_tr_b16 a[210:211], v24 offset:4608
buffer_load_dwordx4 v15, s[8:11], s86 offen offset:1024 lds
v_mfma_f32_16x16x32_bf16 v[84:87], a[196:199], v[168:171], v[84:87]
ds_read_b128 v[180:183], v19 offset:32768
v_mfma_f32_16x16x32_bf16 v[88:91], a[196:199], v[172:175], v[88:91]
v_mfma_f32_16x16x32_bf16 v[92:95], a[196:199], v[176:179], v[92:95]
ds_read_b128 v[184:187], v19 offset:34816
s_waitcnt lgkmcnt(4)
v_mfma_f32_16x16x32_bf16 v[96:99], a[200:203], v[152:155], v[96:99]
ds_read_b128 v[188:191], v19 offset:36864
buffer_load_dwordx4 v16, s[8:11], s86 offen offset:2048 lds
v_mfma_f32_16x16x32_bf16 v[100:103], a[200:203], v[156:159], v[100:103]
v_mfma_f32_16x16x32_bf16 v[104:107], a[200:203], v[160:163], v[104:107]
ds_read_b128 v[192:195], v19 offset:38912
v_mfma_f32_16x16x32_bf16 v[108:111], a[200:203], v[164:167], v[108:111]
ds_read_b128 v[196:199], v19 offset:40960
v_mfma_f32_16x16x32_bf16 v[112:115], a[200:203], v[168:171], v[112:115]
ds_read_b128 v[200:203], v19 offset:43008
v_mfma_f32_16x16x32_bf16 v[116:119], a[200:203], v[172:175], v[116:119]
buffer_load_dwordx4 v17, s[8:11], s86 offen offset:3072 lds
v_mfma_f32_16x16x32_bf16 v[120:123], a[200:203], v[176:179], v[120:123]
ds_read_b128 v[204:207], v19 offset:45056
v_mfma_f32_16x16x32_bf16 v[124:127], a[204:207], v[152:155], v[124:127]
ds_read_b64_tr_b16 a[212:213], v25 offset:4096
v_mfma_f32_16x16x32_bf16 v[128:131], a[204:207], v[156:159], v[128:131]
v_mfma_f32_16x16x32_bf16 v[132:135], a[204:207], v[160:163], v[132:135]
ds_read_b64_tr_b16 a[214:215], v25 offset:4608
s_add_u32 m0, s80, 114688
s_nop 0
buffer_load_dwordx4 v10, s[4:7], s54 offen offset:0 lds
v_mfma_f32_16x16x32_bf16 v[136:139], a[204:207], v[164:167], v[136:139]
ds_read_b64_tr_b16 a[216:217], v26 offset:4096
v_mfma_f32_16x16x32_bf16 v[140:143], a[204:207], v[168:171], v[140:143]
v_mfma_f32_16x16x32_bf16 v[144:147], a[204:207], v[172:175], v[144:147]
ds_read_b64_tr_b16 a[218:219], v26 offset:4608
v_mfma_f32_16x16x32_bf16 v[148:151], a[204:207], v[176:179], v[148:151]
ds_read_b64_tr_b16 a[220:221], v27 offset:4096
buffer_load_dwordx4 v11, s[4:7], s54 offen offset:1024 lds
s_waitcnt lgkmcnt(5)
v_mfma_f32_16x16x32_bf16 v[40:43], a[208:211], v[180:183], v[40:43]
v_mfma_f32_16x16x32_bf16 v[44:47], a[208:211], v[184:187], v[44:47]
ds_read_b64_tr_b16 a[222:223], v27 offset:4608
v_mfma_f32_16x16x32_bf16 v[48:51], a[208:211], v[188:191], v[48:51]
v_mfma_f32_16x16x32_bf16 v[52:55], a[208:211], v[192:195], v[52:55]
buffer_load_dwordx4 v12, s[4:7], s54 offen offset:2048 lds
v_mfma_f32_16x16x32_bf16 v[56:59], a[208:211], v[196:199], v[56:59]
v_mfma_f32_16x16x32_bf16 v[60:63], a[208:211], v[200:203], v[60:63]
v_mfma_f32_16x16x32_bf16 v[64:67], a[208:211], v[204:207], v[64:67]
s_waitcnt lgkmcnt(0)
v_mfma_f32_16x16x32_bf16 v[68:71], a[212:215], v[180:183], v[68:71]
buffer_load_dwordx4 v13, s[4:7], s54 offen offset:3072 lds
s_lshr_b64 s[98:99], s[98:99], 4
s_and_b32 s54, s98, 15
s_lshl_b32 s54, s54, 7
v_mfma_f32_16x16x32_bf16 v[72:75], a[212:215], v[184:187], v[72:75]
v_mfma_f32_16x16x32_bf16 v[76:79], a[212:215], v[188:191], v[76:79]
v_mfma_f32_16x16x32_bf16 v[80:83], a[212:215], v[192:195], v[80:83]
v_mfma_f32_16x16x32_bf16 v[84:87], a[212:215], v[196:199], v[84:87]
v_mfma_f32_16x16x32_bf16 v[88:91], a[212:215], v[200:203], v[88:91]
s_waitcnt vmcnt(12) lgkmcnt(0)
s_barrier
ds_read_b64_tr_b16 a[192:193], v20 offset:0
v_mfma_f32_16x16x32_bf16 v[92:95], a[212:215], v[204:207], v[92:95]
ds_read_b64_tr_b16 a[194:195], v20 offset:512
v_mfma_f32_16x16x32_bf16 v[96:99], a[216:219], v[180:183], v[96:99]
ds_read_b128 v[152:155], v18 offset:0
v_mfma_f32_16x16x32_bf16 v[100:103], a[216:219], v[184:187], v[100:103]
s_add_u32 m0, s52, 65536
s_add_u32 s86, s55, 262144
buffer_load_dwordx4 v14, s[8:11], s55 offen offset:0 lds
v_mfma_f32_16x16x32_bf16 v[104:107], a[216:219], v[188:191], v[104:107]
ds_read_b128 v[156:159], v18 offset:2048
v_mfma_f32_16x16x32_bf16 v[108:111], a[216:219], v[192:195], v[108:111]
ds_read_b128 v[160:163], v18 offset:4096
v_mfma_f32_16x16x32_bf16 v[112:115], a[216:219], v[196:199], v[112:115]
ds_read_b128 v[164:167], v18 offset:6144
v_mfma_f32_16x16x32_bf16 v[116:119], a[216:219], v[200:203], v[116:119]
ds_read_b128 v[168:171], v18 offset:8192
v_mfma_f32_16x16x32_bf16 v[120:123], a[216:219], v[204:207], v[120:123]
ds_read_b128 v[172:175], v18 offset:10240
buffer_load_dwordx4 v15, s[8:11], s55 offen offset:1024 lds
v_mfma_f32_16x16x32_bf16 v[124:127], a[220:223], v[180:183], v[124:127]
v_mfma_f32_16x16x32_bf16 v[128:131], a[220:223], v[184:187], v[128:131]
ds_read_b128 v[176:179], v18 offset:12288
v_mfma_f32_16x16x32_bf16 v[132:135], a[220:223], v[188:191], v[132:135]
ds_read_b64_tr_b16 a[196:197], v21 offset:0
v_mfma_f32_16x16x32_bf16 v[136:139], a[220:223], v[192:195], v[136:139]
ds_read_b64_tr_b16 a[198:199], v21 offset:512
v_mfma_f32_16x16x32_bf16 v[140:143], a[220:223], v[196:199], v[140:143]
buffer_load_dwordx4 v16, s[8:11], s55 offen offset:2048 lds
v_mfma_f32_16x16x32_bf16 v[144:147], a[220:223], v[200:203], v[144:147]
v_mfma_f32_16x16x32_bf16 v[148:151], a[220:223], v[204:207], v[148:151]
s_waitcnt lgkmcnt(2)
v_mfma_f32_16x16x32_bf16 v[40:43], a[192:195], v[152:155], v[40:43]
v_mfma_f32_16x16x32_bf16 v[44:47], a[192:195], v[156:159], v[44:47]
v_mfma_f32_16x16x32_bf16 v[48:51], a[192:195], v[160:163], v[48:51]
ds_read_b64_tr_b16 a[200:201], v22 offset:0
buffer_load_dwordx4 v17, s[8:11], s55 offen offset:3072 lds
s_lshr_b64 s[96:97], s[96:97], 4
s_and_b32 s55, s96, 15
s_lshl_b32 s55, s55, 19
v_mfma_f32_16x16x32_bf16 v[52:55], a[192:195], v[164:167], v[52:55]
v_mfma_f32_16x16x32_bf16 v[56:59], a[192:195], v[168:171], v[56:59]
ds_read_b64_tr_b16 a[202:203], v22 offset:512
v_mfma_f32_16x16x32_bf16 v[60:63], a[192:195], v[172:175], v[60:63]
ds_read_b64_tr_b16 a[204:205], v23 offset:0
v_mfma_f32_16x16x32_bf16 v[64:67], a[192:195], v[176:179], v[64:67]
s_add_u32 m0, s52, 69632
s_nop 0
buffer_load_dwordx4 v14, s[8:11], s86 offen offset:0 lds
s_waitcnt lgkmcnt(3)
v_mfma_f32_16x16x32_bf16 v[68:71], a[196:199], v[152:155], v[68:71]
ds_read_b64_tr_b16 a[206:207], v23 offset:512
v_mfma_f32_16x16x32_bf16 v[72:75], a[196:199], v[156:159], v[72:75]
ds_read_b64_tr_b16 a[208:209], v20 offset:4096
v_mfma_f32_16x16x32_bf16 v[76:79], a[196:199], v[160:163], v[76:79]
v_mfma_f32_16x16x32_bf16 v[80:83], a[196:199], v[164:167], v[80:83]
ds_read_b64_tr_b16 a[210:211], v20 offset:4608
buffer_load_dwordx4 v15, s[8:11], s86 offen offset:1024 lds
v_mfma_f32_16x16x32_bf16 v[84:87], a[196:199], v[168:171], v[84:87]
ds_read_b128 v[180:183], v19 offset:0
v_mfma_f32_16x16x32_bf16 v[88:91], a[196:199], v[172:175], v[88:91]
v_mfma_f32_16x16x32_bf16 v[92:95], a[196:199], v[176:179], v[92:95]
ds_read_b128 v[184:187], v19 offset:2048
s_waitcnt lgkmcnt(4)
v_mfma_f32_16x16x32_bf16 v[96:99], a[200:203], v[152:155], v[96:99]
ds_read_b128 v[188:191], v19 offset:4096
buffer_load_dwordx4 v16, s[8:11], s86 offen offset:2048 lds
v_mfma_f32_16x16x32_bf16 v[100:103], a[200:203], v[156:159], v[100:103]
v_mfma_f32_16x16x32_bf16 v[104:107], a[200:203], v[160:163], v[104:107]
ds_read_b128 v[192:195], v19 offset:6144
v_mfma_f32_16x16x32_bf16 v[108:111], a[200:203], v[164:167], v[108:111]
ds_read_b128 v[196:199], v19 offset:8192
v_mfma_f32_16x16x32_bf16 v[112:115], a[200:203], v[168:171], v[112:115]
ds_read_b128 v[200:203], v19 offset:10240
v_mfma_f32_16x16x32_bf16 v[116:119], a[200:203], v[172:175], v[116:119]
buffer_load_dwordx4 v17, s[8:11], s86 offen offset:3072 lds
v_mfma_f32_16x16x32_bf16 v[120:123], a[200:203], v[176:179], v[120:123]
ds_read_b128 v[204:207], v19 offset:12288
v_mfma_f32_16x16x32_bf16 v[124:127], a[204:207], v[152:155], v[124:127]
ds_read_b64_tr_b16 a[212:213], v21 offset:4096
v_mfma_f32_16x16x32_bf16 v[128:131], a[204:207], v[156:159], v[128:131]
v_mfma_f32_16x16x32_bf16 v[132:135], a[204:207], v[160:163], v[132:135]
ds_read_b64_tr_b16 a[214:215], v21 offset:4608
s_add_u32 m0, s80, 131072
s_nop 0
buffer_load_dwordx4 v10, s[4:7], s54 offen offset:0 lds
v_mfma_f32_16x16x32_bf16 v[136:139], a[204:207], v[164:167], v[136:139]
ds_read_b64_tr_b16 a[216:217], v22 offset:4096
v_mfma_f32_16x16x32_bf16 v[140:143], a[204:207], v[168:171], v[140:143]
v_mfma_f32_16x16x32_bf16 v[144:147], a[204:207], v[172:175], v[144:147]
ds_read_b64_tr_b16 a[218:219], v22 offset:4608
v_mfma_f32_16x16x32_bf16 v[148:151], a[204:207], v[176:179], v[148:151]
ds_read_b64_tr_b16 a[220:221], v23 offset:4096
buffer_load_dwordx4 v11, s[4:7], s54 offen offset:1024 lds
s_waitcnt lgkmcnt(5)
v_mfma_f32_16x16x32_bf16 v[40:43], a[208:211], v[180:183], v[40:43]
v_mfma_f32_16x16x32_bf16 v[44:47], a[208:211], v[184:187], v[44:47]
ds_read_b64_tr_b16 a[222:223], v23 offset:4608
v_mfma_f32_16x16x32_bf16 v[48:51], a[208:211], v[188:191], v[48:51]
v_mfma_f32_16x16x32_bf16 v[52:55], a[208:211], v[192:195], v[52:55]
buffer_load_dwordx4 v12, s[4:7], s54 offen offset:2048 lds
v_mfma_f32_16x16x32_bf16 v[56:59], a[208:211], v[196:199], v[56:59]
v_mfma_f32_16x16x32_bf16 v[60:63], a[208:211], v[200:203], v[60:63]
v_mfma_f32_16x16x32_bf16 v[64:67], a[208:211], v[204:207], v[64:67]
s_waitcnt lgkmcnt(0)
v_mfma_f32_16x16x32_bf16 v[68:71], a[212:215], v[180:183], v[68:71]
buffer_load_dwordx4 v13, s[4:7], s54 offen offset:3072 lds
s_lshr_b64 s[98:99], s[98:99], 4
s_and_b32 s54, s98, 15
s_lshl_b32 s54, s54, 7
v_mfma_f32_16x16x32_bf16 v[72:75], a[212:215], v[184:187], v[72:75]
v_mfma_f32_16x16x32_bf16 v[76:79], a[212:215], v[188:191], v[76:79]
v_mfma_f32_16x16x32_bf16 v[80:83], a[212:215], v[192:195], v[80:83]
v_mfma_f32_16x16x32_bf16 v[84:87], a[212:215], v[196:199], v[84:87]
v_mfma_f32_16x16x32_bf16 v[88:91], a[212:215], v[200:203], v[88:91]
s_waitcnt vmcnt(12) lgkmcnt(0)
s_barrier
ds_read_b64_tr_b16 a[192:193], v20 offset:32768
v_mfma_f32_16x16x32_bf16 v[92:95], a[212:215], v[204:207], v[92:95]
ds_read_b64_tr_b16 a[194:195], v20 offset:33280
v_mfma_f32_16x16x32_bf16 v[96:99], a[216:219], v[180:183], v[96:99]
ds_read_b128 v[152:155], v18 offset:16384
v_mfma_f32_16x16x32_bf16 v[100:103], a[216:219], v[184:187], v[100:103]
s_add_u32 m0, s52, 0
s_add_u32 s86, s55, 262144
buffer_load_dwordx4 v14, s[8:11], s55 offen offset:0 lds
v_mfma_f32_16x16x32_bf16 v[104:107], a[216:219], v[188:191], v[104:107]
ds_read_b128 v[156:159], v18 offset:18432
v_mfma_f32_16x16x32_bf16 v[108:111], a[216:219], v[192:195], v[108:111]
ds_read_b128 v[160:163], v18 offset:20480
v_mfma_f32_16x16x32_bf16 v[112:115], a[216:219], v[196:199], v[112:115]
ds_read_b128 v[164:167], v18 offset:22528
v_mfma_f32_16x16x32_bf16 v[116:119], a[216:219], v[200:203], v[116:119]
ds_read_b128 v[168:171], v18 offset:24576
v_mfma_f32_16x16x32_bf16 v[120:123], a[216:219], v[204:207], v[120:123]
ds_read_b128 v[172:175], v18 offset:26624
buffer_load_dwordx4 v15, s[8:11], s55 offen offset:1024 lds
v_mfma_f32_16x16x32_bf16 v[124:127], a[220:223], v[180:183], v[124:127]
v_mfma_f32_16x16x32_bf16 v[128:131], a[220:223], v[184:187], v[128:131]
ds_read_b128 v[176:179], v18 offset:28672
v_mfma_f32_16x16x32_bf16 v[132:135], a[220:223], v[188:191], v[132:135]
ds_read_b64_tr_b16 a[196:197], v21 offset:32768
v_mfma_f32_16x16x32_bf16 v[136:139], a[220:223], v[192:195], v[136:139]
ds_read_b64_tr_b16 a[198:199], v21 offset:33280
v_mfma_f32_16x16x32_bf16 v[140:143], a[220:223], v[196:199], v[140:143]
buffer_load_dwordx4 v16, s[8:11], s55 offen offset:2048 lds
v_mfma_f32_16x16x32_bf16 v[144:147], a[220:223], v[200:203], v[144:147]
v_mfma_f32_16x16x32_bf16 v[148:151], a[220:223], v[204:207], v[148:151]
s_sub_u32 s53, s53, 1
s_cmp_lg_u32 s53, 0
s_cbranch_scc1 L_gl_2
s_waitcnt lgkmcnt(2)
v_mfma_f32_16x16x32_bf16 v[40:43], a[192:195], v[152:155], v[40:43]
v_mfma_f32_16x16x32_bf16 v[44:47], a[192:195], v[156:159], v[44:47]
v_mfma_f32_16x16x32_bf16 v[48:51], a[192:195], v[160:163], v[48:51]
ds_read_b64_tr_b16 a[200:201], v22 offset:32768
buffer_load_dwordx4 v17, s[8:11], s55 offen offset:3072 lds
s_lshr_b64 s[96:97], s[96:97], 4
s_and_b32 s55, s96, 15
s_lshl_b32 s55, s55, 19
v_mfma_f32_16x16x32_bf16 v[52:55], a[192:195], v[164:167], v[52:55]
v_mfma_f32_16x16x32_bf16 v[56:59], a[192:195], v[168:171], v[56:59]
ds_read_b64_tr_b16 a[202:203], v22 offset:33280
v_mfma_f32_16x16x32_bf16 v[60:63], a[192:195], v[172:175], v[60:63]
ds_read_b64_tr_b16 a[204:205], v23 offset:32768
v_mfma_f32_16x16x32_bf16 v[64:67], a[192:195], v[176:179], v[64:67]
s_add_u32 m0, s52, 4096
s_nop 0
buffer_load_dwordx4 v14, s[8:11], s86 offen offset:0 lds
s_waitcnt lgkmcnt(3)
v_mfma_f32_16x16x32_bf16 v[68:71], a[196:199], v[152:155], v[68:71]
ds_read_b64_tr_b16 a[206:207], v23 offset:33280
v_mfma_f32_16x16x32_bf16 v[72:75], a[196:199], v[156:159], v[72:75]
ds_read_b64_tr_b16 a[208:209], v20 offset:36864
v_mfma_f32_16x16x32_bf16 v[76:79], a[196:199], v[160:163], v[76:79]
v_mfma_f32_16x16x32_bf16 v[80:83], a[196:199], v[164:167], v[80:83]
ds_read_b64_tr_b16 a[210:211], v20 offset:37376
buffer_load_dwordx4 v15, s[8:11], s86 offen offset:1024 lds
v_mfma_f32_16x16x32_bf16 v[84:87], a[196:199], v[168:171], v[84:87]
ds_read_b128 v[180:183], v19 offset:16384
v_mfma_f32_16x16x32_bf16 v[88:91], a[196:199], v[172:175], v[88:91]
v_mfma_f32_16x16x32_bf16 v[92:95], a[196:199], v[176:179], v[92:95]
ds_read_b128 v[184:187], v19 offset:18432
s_waitcnt lgkmcnt(4)
v_mfma_f32_16x16x32_bf16 v[96:99], a[200:203], v[152:155], v[96:99]
ds_read_b128 v[188:191], v19 offset:20480
buffer_load_dwordx4 v16, s[8:11], s86 offen offset:2048 lds
v_mfma_f32_16x16x32_bf16 v[100:103], a[200:203], v[156:159], v[100:103]
v_mfma_f32_16x16x32_bf16 v[104:107], a[200:203], v[160:163], v[104:107]
ds_read_b128 v[192:195], v19 offset:22528
v_mfma_f32_16x16x32_bf16 v[108:111], a[200:203], v[164:167], v[108:111]
ds_read_b128 v[196:199], v19 offset:24576
v_mfma_f32_16x16x32_bf16 v[112:115], a[200:203], v[168:171], v[112:115]
ds_read_b128 v[200:203], v19 offset:26624
v_mfma_f32_16x16x32_bf16 v[116:119], a[200:203], v[172:175], v[116:119]
buffer_load_dwordx4 v17, s[8:11], s86 offen offset:3072 lds
v_mfma_f32_16x16x32_bf16 v[120:123], a[200:203], v[176:179], v[120:123]
ds_read_b128 v[204:207], v19 offset:28672
v_mfma_f32_16x16x32_bf16 v[124:127], a[204:207], v[152:155], v[124:127]
ds_read_b64_tr_b16 a[212:213], v21 offset:36864
v_mfma_f32_16x16x32_bf16 v[128:131], a[204:207], v[156:159], v[128:131]
v_mfma_f32_16x16x32_bf16 v[132:135], a[204:207], v[160:163], v[132:135]
ds_read_b64_tr_b16 a[214:215], v21 offset:37376
s_add_u32 m0, s80, 98304
s_nop 0
buffer_load_dwordx4 v10, s[4:7], s54 offen offset:0 lds
v_mfma_f32_16x16x32_bf16 v[136:139], a[204:207], v[164:167], v[136:139]
ds_read_b64_tr_b16 a[216:217], v22 offset:36864
v_mfma_f32_16x16x32_bf16 v[140:143], a[204:207], v[168:171], v[140:143]
v_mfma_f32_16x16x32_bf16 v[144:147], a[204:207], v[172:175], v[144:147]
ds_read_b64_tr_b16 a[218:219], v22 offset:37376
v_mfma_f32_16x16x32_bf16 v[148:151], a[204:207], v[176:179], v[148:151]
ds_read_b64_tr_b16 a[220:221], v23 offset:36864
buffer_load_dwordx4 v11, s[4:7], s54 offen offset:1024 lds
s_waitcnt lgkmcnt(5)
v_mfma_f32_16x16x32_bf16 v[40:43], a[208:211], v[180:183], v[40:43]
v_mfma_f32_16x16x32_bf16 v[44:47], a[208:211], v[184:187], v[44:47]
ds_read_b64_tr_b16 a[222:223], v23 offset:37376
v_mfma_f32_16x16x32_bf16 v[48:51], a[208:211], v[188:191], v[48:51]
v_mfma_f32_16x16x32_bf16 v[52:55], a[208:211], v[192:195], v[52:55]
buffer_load_dwordx4 v12, s[4:7], s54 offen offset:2048 lds
v_mfma_f32_16x16x32_bf16 v[56:59], a[208:211], v[196:199], v[56:59]
v_mfma_f32_16x16x32_bf16 v[60:63], a[208:211], v[200:203], v[60:63]
v_mfma_f32_16x16x32_bf16 v[64:67], a[208:211], v[204:207], v[64:67]
s_waitcnt lgkmcnt(0)
v_mfma_f32_16x16x32_bf16 v[68:71], a[212:215], v[180:183], v[68:71]
buffer_load_dwordx4 v13, s[4:7], s54 offen offset:3072 lds
s_lshr_b64 s[98:99], s[98:99], 4
s_and_b32 s54, s98, 15
s_lshl_b32 s54, s54, 7
v_mfma_f32_16x16x32_bf16 v[72:75], a[212:215], v[184:187], v[72:75]
v_mfma_f32_16x16x32_bf16 v[76:79], a[212:215], v[188:191], v[76:79]
v_mfma_f32_16x16x32_bf16 v[80:83], a[212:215], v[192:195], v[80:83]
v_mfma_f32_16x16x32_bf16 v[84:87], a[212:215], v[196:199], v[84:87]
v_mfma_f32_16x16x32_bf16 v[88:91], a[212:215], v[200:203], v[88:91]
s_waitcnt vmcnt(12) lgkmcnt(0)
s_barrier
ds_read_b64_tr_b16 a[192:193], v24 offset:0
v_mfma_f32_16x16x32_bf16 v[92:95], a[212:215], v[204:207], v[92:95]
ds_read_b64_tr_b16 a[194:195], v24 offset:512
s_add_u32 m0, s80, 147456
s_lshl_b32 s56, s85, 12
s_add_u32 s56, s56, 0
buffer_load_dwordx4 v28, s[12:15], s56 offen offset:0 nt lds
v_mfma_f32_16x16x32_bf16 v[96:99], a[216:219], v[180:183], v[96:99]
ds_read_b128 v[152:155], v18 offset:32768
v_mfma_f32_16x16x32_bf16 v[100:103], a[216:219], v[184:187], v[100:103]
buffer_load_dwordx4 v29, s[12:15], s56 offen offset:1024 nt lds
v_mfma_f32_16x16x32_bf16 v[104:107], a[216:219], v[188:191], v[104:107]
ds_read_b128 v[156:159], v18 offset:34816
v_mfma_f32_16x16x32_bf16 v[108:111], a[216:219], v[192:195], v[108:111]
ds_read_b128 v[160:163], v18 offset:36864
buffer_load_dwordx4 v30, s[12:15], s56 offen offset:2048 nt lds
v_mfma_f32_16x16x32_bf16 v[112:115], a[216:219], v[196:199], v[112:115]
ds_read_b128 v[164:167], v18 offset:38912
v_mfma_f32_16x16x32_bf16 v[116:119], a[216:219], v[200:203], v[116:119]
ds_read_b128 v[168:171], v18 offset:40960
buffer_load_dwordx4 v31, s[12:15], s56 offen offset:3072 nt lds
v_mfma_f32_16x16x32_bf16 v[120:123], a[216:219], v[204:207], v[120:123]
ds_read_b128 v[172:175], v18 offset:43008
v_mfma_f32_16x16x32_bf16 v[124:127], a[220:223], v[180:183], v[124:127]
s_add_u32 m0, s80, 49152
s_lshl_b32 s56, s85, 12
s_add_u32 s56, s56, 8192
buffer_load_dwordx4 v28, s[12:15], s56 offen offset:0 nt lds
v_mfma_f32_16x16x32_bf16 v[128:131], a[220:223], v[184:187], v[128:131]
ds_read_b128 v[176:179], v18 offset:45056
v_mfma_f32_16x16x32_bf16 v[132:135], a[220:223], v[188:191], v[132:135]
ds_read_b64_tr_b16 a[196:197], v25 offset:0
buffer_load_dwordx4 v29, s[12:15], s56 offen offset:1024 nt lds
v_mfma_f32_16x16x32_bf16 v[136:139], a[220:223], v[192:195], v[136:139]
ds_read_b64_tr_b16 a[198:199], v25 offset:512
v_mfma_f32_16x16x32_bf16 v[140:143], a[220:223], v[196:199], v[140:143]
buffer_load_dwordx4 v30, s[12:15], s56 offen offset:2048 nt lds
v_mfma_f32_16x16x32_bf16 v[144:147], a[220:223], v[200:203], v[144:147]
v_mfma_f32_16x16x32_bf16 v[148:151], a[220:223], v[204:207], v[148:151]
buffer_load_dwordx4 v31, s[12:15], s56 offen offset:3072 nt lds
s_waitcnt lgkmcnt(2)
v_mfma_f32_16x16x32_bf16 v[40:43], a[192:195], v[152:155], v[40:43]
v_mfma_f32_16x16x32_bf16 v[44:47], a[192:195], v[156:159], v[44:47]
v_mfma_f32_16x16x32_bf16 v[48:51], a[192:195], v[160:163], v[48:51]
ds_read_b64_tr_b16 a[200:201], v26 offset:0
s_add_u32 m0, s80, 32768
s_lshl_b32 s56, s85, 12
s_add_u32 s56, s56, 0
buffer_load_dwordx4 v32, s[16:19], s56 offen offset:0 nt lds
v_mfma_f32_16x16x32_bf16 v[52:55], a[192:195], v[164:167], v[52:55]
v_mfma_f32_16x16x32_bf16 v[56:59], a[192:195], v[168:171], v[56:59]
ds_read_b64_tr_b16 a[202:203], v26 offset:512
v_mfma_f32_16x16x32_bf16 v[60:63], a[192:195], v[172:175], v[60:63]
ds_read_b64_tr_b16 a[204:205], v27 offset:0
v_mfma_f32_16x16x32_bf16 v[64:67], a[192:195], v[176:179], v[64:67]
s_waitcnt lgkmcnt(3)
v_mfma_f32_16x16x32_bf16 v[68:71], a[196:199], v[152:155], v[68:71]
ds_read_b64_tr_b16 a[206:207], v27 offset:512
buffer_load_dwordx4 v33, s[16:19], s56 offen offset:1024 nt lds
v_mfma_f32_16x16x32_bf16 v[72:75], a[196:199], v[156:159], v[72:75]
ds_read_b64_tr_b16 a[208:209], v24 offset:4096
v_mfma_f32_16x16x32_bf16 v[76:79], a[196:199], v[160:163], v[76:79]
v_mfma_f32_16x16x32_bf16 v[80:83], a[196:199], v[164:167], v[80:83]
ds_read_b64_tr_b16 a[210:211], v24 offset:4608
v_mfma_f32_16x16x32_bf16 v[84:87], a[196:199], v[168:171], v[84:87]
ds_read_b128 v[180:183], v19 offset:32768
buffer_load_dwordx4 v32, s[16:19], s56 offen offset:2048 nt lds
v_mfma_f32_16x16x32_bf16 v[88:91], a[196:199], v[172:175], v[88:91]
v_mfma_f32_16x16x32_bf16 v[92:95], a[196:199], v[176:179], v[92:95]
ds_read_b128 v[184:187], v19 offset:34816
s_waitcnt lgkmcnt(4)
v_mfma_f32_16x16x32_bf16 v[96:99], a[200:203], v[152:155], v[96:99]
ds_read_b128 v[188:191], v19 offset:36864
v_mfma_f32_16x16x32_bf16 v[100:103], a[200:203], v[156:159], v[100:103]
v_mfma_f32_16x16x32_bf16 v[104:107], a[200:203], v[160:163], v[104:107]
ds_read_b128 v[192:195], v19 offset:38912
buffer_load_dwordx4 v33, s[16:19], s56 offen offset:3072 nt lds
v_mfma_f32_16x16x32_bf16 v[108:111], a[200:203], v[164:167], v[108:111]
ds_read_b128 v[196:199], v19 offset:40960
v_mfma_f32_16x16x32_bf16 v[112:115], a[200:203], v[168:171], v[112:115]
ds_read_b128 v[200:203], v19 offset:43008
v_mfma_f32_16x16x32_bf16 v[116:119], a[200:203], v[172:175], v[116:119]
v_mfma_f32_16x16x32_bf16 v[120:123], a[200:203], v[176:179], v[120:123]
ds_read_b128 v[204:207], v19 offset:45056
v_mfma_f32_16x16x32_bf16 v[124:127], a[204:207], v[152:155], v[124:127]
ds_read_b64_tr_b16 a[212:213], v25 offset:4096
s_add_u32 m0, s80, 114688
s_lshl_b32 s56, s85, 12
s_add_u32 s56, s56, 24576
buffer_load_dwordx4 v28, s[12:15], s56 offen offset:0 nt lds
v_mfma_f32_16x16x32_bf16 v[128:131], a[204:207], v[156:159], v[128:131]
v_mfma_f32_16x16x32_bf16 v[132:135], a[204:207], v[160:163], v[132:135]
ds_read_b64_tr_b16 a[214:215], v25 offset:4608
v_mfma_f32_16x16x32_bf16 v[136:139], a[204:207], v[164:167], v[136:139]
ds_read_b64_tr_b16 a[216:217], v26 offset:4096
v_mfma_f32_16x16x32_bf16 v[140:143], a[204:207], v[168:171], v[140:143]
v_mfma_f32_16x16x32_bf16 v[144:147], a[204:207], v[172:175], v[144:147]
ds_read_b64_tr_b16 a[218:219], v26 offset:4608
buffer_load_dwordx4 v29, s[12:15], s56 offen offset:1024 nt lds
v_mfma_f32_16x16x32_bf16 v[148:151], a[204:207], v[176:179], v[148:151]
ds_read_b64_tr_b16 a[220:221], v27 offset:4096
s_waitcnt lgkmcnt(5)
v_mfma_f32_16x16x32_bf16 v[40:43], a[208:211], v[180:183], v[40:43]
v_mfma_f32_16x16x32_bf16 v[44:47], a[208:211], v[184:187], v[44:47]
ds_read_b64_tr_b16 a[222:223], v27 offset:4608
v_mfma_f32_16x16x32_bf16 v[48:51], a[208:211], v[188:191], v[48:51]
buffer_load_dwordx4 v30, s[12:15], s56 offen offset:2048 nt lds
v_mfma_f32_16x16x32_bf16 v[52:55], a[208:211], v[192:195], v[52:55]
v_mfma_f32_16x16x32_bf16 v[56:59], a[208:211], v[196:199], v[56:59]
v_mfma_f32_16x16x32_bf16 v[60:63], a[208:211], v[200:203], v[60:63]
v_mfma_f32_16x16x32_bf16 v[64:67], a[208:211], v[204:207], v[64:67]
s_waitcnt lgkmcnt(0)
v_mfma_f32_16x16x32_bf16 v[68:71], a[212:215], v[180:183], v[68:71]
buffer_load_dwordx4 v31, s[12:15], s56 offen offset:3072 nt lds
v_mfma_f32_16x16x32_bf16 v[72:75], a[212:215], v[184:187], v[72:75]
v_mfma_f32_16x16x32_bf16 v[76:79], a[212:215], v[188:191], v[76:79]
v_mfma_f32_16x16x32_bf16 v[80:83], a[212:215], v[192:195], v[80:83]
v_mfma_f32_16x16x32_bf16 v[84:87], a[212:215], v[196:199], v[84:87]
v_mfma_f32_16x16x32_bf16 v[88:91], a[212:215], v[200:203], v[88:91]
s_waitcnt vmcnt(16) lgkmcnt(0)
s_barrier
ds_read_b64_tr_b16 a[192:193], v20 offset:0
v_mfma_f32_16x16x32_bf16 v[92:95], a[212:215], v[204:207], v[92:95]
ds_read_b64_tr_b16 a[194:195], v20 offset:512
v_mfma_f32_16x16x32_bf16 v[96:99], a[216:219], v[180:183], v[96:99]
ds_read_b128 v[152:155], v18 offset:0
s_add_u32 m0, s80, 81920
s_lshl_b32 s56, s85, 12
s_add_u32 s56, s56, 16384
buffer_load_dwordx4 v28, s[12:15], s56 offen offset:0 nt lds
v_mfma_f32_16x16x32_bf16 v[100:103], a[216:219], v[184:187], v[100:103]
v_mfma_f32_16x16x32_bf16 v[104:107], a[216:219], v[188:191], v[104:107]
ds_read_b128 v[156:159], v18 offset:2048
v_mfma_f32_16x16x32_bf16 v[108:111], a[216:219], v[192:195], v[108:111]
ds_read_b128 v[160:163], v18 offset:4096
v_mfma_f32_16x16x32_bf16 v[112:115], a[216:219], v[196:199], v[112:115]
ds_read_b128 v[164:167], v18 offset:6144
buffer_load_dwordx4 v29, s[12:15], s56 offen offset:1024 nt lds
v_mfma_f32_16x16x32_bf16 v[116:119], a[216:219], v[200:203], v[116:119]
ds_read_b128 v[168:171], v18 offset:8192
v_mfma_f32_16x16x32_bf16 v[120:123], a[216:219], v[204:207], v[120:123]
ds_read_b128 v[172:175], v18 offset:10240
v_mfma_f32_16x16x32_bf16 v[124:127], a[220:223], v[180:183], v[124:127]
v_mfma_f32_16x16x32_bf16 v[128:131], a[220:223], v[184:187], v[128:131]
ds_read_b128 v[176:179], v18 offset:12288
buffer_load_dwordx4 v30, s[12:15], s56 offen offset:2048 nt lds
v_mfma_f32_16x16x32_bf16 v[132:135], a[220:223], v[188:191], v[132:135]
ds_read_b64_tr_b16 a[196:197], v21 offset:0
v_mfma_f32_16x16x32_bf16 v[136:139], a[220:223], v[192:195], v[136:139]
ds_read_b64_tr_b16 a[198:199], v21 offset:512
v_mfma_f32_16x16x32_bf16 v[140:143], a[220:223], v[196:199], v[140:143]
v_mfma_f32_16x16x32_bf16 v[144:147], a[220:223], v[200:203], v[144:147]
buffer_load_dwordx4 v31, s[12:15], s56 offen offset:3072 nt lds
v_mfma_f32_16x16x32_bf16 v[148:151], a[220:223], v[204:207], v[148:151]
s_waitcnt lgkmcnt(2)
v_mfma_f32_16x16x32_bf16 v[40:43], a[192:195], v[152:155], v[40:43]
v_mfma_f32_16x16x32_bf16 v[44:47], a[192:195], v[156:159], v[44:47]
v_mfma_f32_16x16x32_bf16 v[48:51], a[192:195], v[160:163], v[48:51]
ds_read_b64_tr_b16 a[200:201], v22 offset:0
v_mfma_f32_16x16x32_bf16 v[52:55], a[192:195], v[164:167], v[52:55]
v_mfma_f32_16x16x32_bf16 v[56:59], a[192:195], v[168:171], v[56:59]
ds_read_b64_tr_b16 a[202:203], v22 offset:512
s_add_u32 m0, s80, 65536
s_lshl_b32 s56, s85, 12
s_add_u32 s56, s56, 8192
buffer_load_dwordx4 v32, s[16:19], s56 offen offset:0 nt lds
v_mfma_f32_16x16x32_bf16 v[60:63], a[192:195], v[172:175], v[60:63]
ds_read_b64_tr_b16 a[204:205], v23 offset:0
v_mfma_f32_16x16x32_bf16 v[64:67], a[192:195], v[176:179], v[64:67]
s_waitcnt lgkmcnt(3)
v_mfma_f32_16x16x32_bf16 v[68:71], a[196:199], v[152:155], v[68:71]
ds_read_b64_tr_b16 a[206:207], v23 offset:512
v_mfma_f32_16x16x32_bf16 v[72:75], a[196:199], v[156:159], v[72:75]
ds_read_b64_tr_b16 a[208:209], v20 offset:4096
v_mfma_f32_16x16x32_bf16 v[76:79], a[196:199], v[160:163], v[76:79]
v_mfma_f32_16x16x32_bf16 v[80:83], a[196:199], v[164:167], v[80:83]
ds_read_b64_tr_b16 a[210:211], v20 offset:4608
v_mfma_f32_16x16x32_bf16 v[84:87], a[196:199], v[168:171], v[84:87]
ds_read_b64_tr_b16 a[212:213], v21 offset:4096
v_mfma_f32_16x16x32_bf16 v[88:91], a[196:199], v[172:175], v[88:91]
v_mfma_f32_16x16x32_bf16 v[92:95], a[196:199], v[176:179], v[92:95]
ds_read_b64_tr_b16 a[214:215], v21 offset:4608
s_waitcnt lgkmcnt(4)
v_mfma_f32_16x16x32_bf16 v[96:99], a[200:203], v[152:155], v[96:99]
ds_read_b64_tr_b16 a[216:217], v22 offset:4096
buffer_load_dwordx4 v33, s[16:19], s56 offen offset:1024 nt lds
v_mfma_f32_16x16x32_bf16 v[100:103], a[200:203], v[156:159], v[100:103]
v_mfma_f32_16x16x32_bf16 v[104:107], a[200:203], v[160:163], v[104:107]
ds_read_b64_tr_b16 a[218:219], v22 offset:4608
v_mfma_f32_16x16x32_bf16 v[108:111], a[200:203], v[164:167], v[108:111]
ds_read_b64_tr_b16 a[220:221], v23 offset:4096
v_mfma_f32_16x16x32_bf16 v[112:115], a[200:203], v[168:171], v[112:115]
ds_read_b64_tr_b16 a[222:223], v23 offset:4608
v_mfma_f32_16x16x32_bf16 v[116:119], a[200:203], v[172:175], v[116:119]
v_mfma_f32_16x16x32_bf16 v[120:123], a[200:203], v[176:179], v[120:123]
ds_read_b128 v[180:183], v19 offset:0
v_mfma_f32_16x16x32_bf16 v[124:127], a[204:207], v[152:155], v[124:127]
ds_read_b128 v[184:187], v19 offset:2048
v_mfma_f32_16x16x32_bf16 v[128:131], a[204:207], v[156:159], v[128:131]
v_mfma_f32_16x16x32_bf16 v[132:135], a[204:207], v[160:163], v[132:135]
ds_read_b128 v[188:191], v19 offset:4096
buffer_load_dwordx4 v32, s[16:19], s56 offen offset:2048 nt lds
v_mfma_f32_16x16x32_bf16 v[136:139], a[204:207], v[164:167], v[136:139]
ds_read_b128 v[192:195], v19 offset:6144
v_mfma_f32_16x16x32_bf16 v[140:143], a[204:207], v[168:171], v[140:143]
v_mfma_f32_16x16x32_bf16 v[144:147], a[204:207], v[172:175], v[144:147]
ds_read_b128 v[196:199], v19 offset:8192
v_mfma_f32_16x16x32_bf16 v[148:151], a[204:207], v[176:179], v[148:151]
ds_read_b128 v[200:203], v19 offset:10240
s_waitcnt lgkmcnt(4)
v_mfma_f32_16x16x32_bf16 v[40:43], a[208:211], v[180:183], v[40:43]
v_mfma_f32_16x16x32_bf16 v[68:71], a[212:215], v[180:183], v[68:71]
ds_read_b128 v[204:207], v19 offset:12288
v_mfma_f32_16x16x32_bf16 v[96:99], a[216:219], v[180:183], v[96:99]
v_mfma_f32_16x16x32_bf16 v[124:127], a[220:223], v[180:183], v[124:127]
v_mfma_f32_16x16x32_bf16 v[44:47], a[208:211], v[184:187], v[44:47]
v_mfma_f32_16x16x32_bf16 v[72:75], a[212:215], v[184:187], v[72:75]
buffer_load_dwordx4 v33, s[16:19], s56 offen offset:3072 nt lds
v_mfma_f32_16x16x32_bf16 v[100:103], a[216:219], v[184:187], v[100:103]
v_mfma_f32_16x16x32_bf16 v[128:131], a[220:223], v[184:187], v[128:131]
s_waitcnt lgkmcnt(0)
v_mfma_f32_16x16x32_bf16 v[48:51], a[208:211], v[188:191], v[48:51]
v_mfma_f32_16x16x32_bf16 v[76:79], a[212:215], v[188:191], v[76:79]
v_mfma_f32_16x16x32_bf16 v[104:107], a[216:219], v[188:191], v[104:107]
v_mfma_f32_16x16x32_bf16 v[132:135], a[220:223], v[188:191], v[132:135]
v_mfma_f32_16x16x32_bf16 v[52:55], a[208:211], v[192:195], v[52:55]
v_mfma_f32_16x16x32_bf16 v[80:83], a[212:215], v[192:195], v[80:83]
v_mfma_f32_16x16x32_bf16 v[108:111], a[216:219], v[192:195], v[108:111]
v_mfma_f32_16x16x32_bf16 v[136:139], a[220:223], v[192:195], v[136:139]
v_mfma_f32_16x16x32_bf16 v[56:59], a[208:211], v[196:199], v[56:59]
v_mfma_f32_16x16x32_bf16 v[84:87], a[212:215], v[196:199], v[84:87]
v_mfma_f32_16x16x32_bf16 v[112:115], a[216:219], v[196:199], v[112:115]
v_mfma_f32_16x16x32_bf16 v[140:143], a[220:223], v[196:199], v[140:143]
v_mfma_f32_16x16x32_bf16 v[60:63], a[208:211], v[200:203], v[60:63]
v_mfma_f32_16x16x32_bf16 v[88:91], a[212:215], v[200:203], v[88:91]
v_mfma_f32_16x16x32_bf16 v[116:119], a[216:219], v[200:203], v[116:119]
v_mfma_f32_16x16x32_bf16 v[144:147], a[220:223], v[200:203], v[144:147]
v_mfma_f32_16x16x32_bf16 v[64:67], a[208:211], v[204:207], v[64:67]
v_mfma_f32_16x16x32_bf16 v[92:95], a[212:215], v[204:207], v[92:95]
v_mfma_f32_16x16x32_bf16 v[120:123], a[216:219], v[204:207], v[120:123]
v_mfma_f32_16x16x32_bf16 v[148:151], a[220:223], v[204:207], v[148:151]
v_mov_b32 v4, 0
global_load_dwordx2 v[38:39], v4, s[40:41] sc1
v_and_b32 v2, 15, v1
v_lshrrev_b32 v3, 4, v1
v_lshrrev_b32 v4, 1, v3
s_lshl_b32 s44, s85, 3
v_xor_b32 v4, s44, v4
v_xor_b32 v4, v4, v2
v_lshlrev_b32 v4, 4, v4
v_and_b32 v5, 1, v3
v_lshl_add_u32 v4, v5, 3, v4
s_mul_i32 s44, s84, 98304
v_lshl_add_u32 v5, v2, 8, s44
v_add_u32 v6, v4, v5
v_xor_b32 v7, 32, v6
v_xor_b32 v8, 64, v6
v_xor_b32 v9, 96, v6
s_lshl_b32 s45, s84, 14
v_add_u32 v152, s45, v6
v_add_u32 v153, s45, v7
v_add_u32 v154, s45, v8
v_add_u32 v155, s45, v9
v_xor_b32 v4, v3, v2
v_lshlrev_b32 v4, 4, v4
s_add_u32 s45, s45, 16384
s_mul_i32 s44, s85, s45
v_add3_u32 v5, v5, v4, s44
v_pk_mul_f32 v[40:41], v[40:41], v[34:35]
v_pk_mul_f32 v[42:43], v[42:43], v[34:35]
v_cvt_pk_bf16_f32 v40, v40, v41
v_cvt_pk_bf16_f32 v41, v42, v43
s_barrier
ds_write_b64 v6, v[40:41] offset:0
v_pk_mul_f32 v[68:69], v[68:69], v[34:35]
v_pk_mul_f32 v[70:71], v[70:71], v[34:35]
v_cvt_pk_bf16_f32 v68, v68, v69
v_cvt_pk_bf16_f32 v69, v70, v71
ds_write_b64 v7, v[68:69] offset:0
v_pk_mul_f32 v[96:97], v[96:97], v[34:35]
v_pk_mul_f32 v[98:99], v[98:99], v[34:35]
v_cvt_pk_bf16_f32 v96, v96, v97
v_cvt_pk_bf16_f32 v97, v98, v99
ds_write_b64 v8, v[96:97] offset:0
v_pk_mul_f32 v[124:125], v[124:125], v[34:35]
v_pk_mul_f32 v[126:127], v[126:127], v[34:35]
v_cvt_pk_bf16_f32 v124, v124, v125
v_cvt_pk_bf16_f32 v125, v126, v127
ds_write_b64 v9, v[124:125] offset:0
v_pk_mul_f32 v[44:45], v[44:45], v[34:35]
v_pk_mul_f32 v[46:47], v[46:47], v[34:35]
v_cvt_pk_bf16_f32 v44, v44, v45
v_cvt_pk_bf16_f32 v45, v46, v47
ds_write_b64 v6, v[44:45] offset:4096
v_pk_mul_f32 v[72:73], v[72:73], v[34:35]
v_pk_mul_f32 v[74:75], v[74:75], v[34:35]
v_cvt_pk_bf16_f32 v72, v72, v73
v_cvt_pk_bf16_f32 v73, v74, v75
ds_write_b64 v7, v[72:73] offset:4096
v_pk_mul_f32 v[100:101], v[100:101], v[34:35]
v_pk_mul_f32 v[102:103], v[102:103], v[34:35]
v_cvt_pk_bf16_f32 v100, v100, v101
v_cvt_pk_bf16_f32 v101, v102, v103
ds_write_b64 v8, v[100:101] offset:4096
v_pk_mul_f32 v[128:129], v[128:129], v[34:35]
v_pk_mul_f32 v[130:131], v[130:131], v[34:35]
v_cvt_pk_bf16_f32 v128, v128, v129
v_cvt_pk_bf16_f32 v129, v130, v131
ds_write_b64 v9, v[128:129] offset:4096
v_pk_mul_f32 v[48:49], v[48:49], v[34:35]
v_pk_mul_f32 v[50:51], v[50:51], v[34:35]
v_cvt_pk_bf16_f32 v48, v48, v49
v_cvt_pk_bf16_f32 v49, v50, v51
ds_write_b64 v6, v[48:49] offset:8192
v_pk_mul_f32 v[76:77], v[76:77], v[34:35]
v_pk_mul_f32 v[78:79], v[78:79], v[34:35]
v_cvt_pk_bf16_f32 v76, v76, v77
v_cvt_pk_bf16_f32 v77, v78, v79
ds_write_b64 v7, v[76:77] offset:8192
v_pk_mul_f32 v[104:105], v[104:105], v[34:35]
v_pk_mul_f32 v[106:107], v[106:107], v[34:35]
v_cvt_pk_bf16_f32 v104, v104, v105
v_cvt_pk_bf16_f32 v105, v106, v107
ds_write_b64 v8, v[104:105] offset:8192
v_pk_mul_f32 v[132:133], v[132:133], v[34:35]
v_pk_mul_f32 v[134:135], v[134:135], v[34:35]
v_cvt_pk_bf16_f32 v132, v132, v133
v_cvt_pk_bf16_f32 v133, v134, v135
ds_write_b64 v9, v[132:133] offset:8192
s_waitcnt lgkmcnt(2)
v_pk_mul_f32 v[52:53], v[52:53], v[34:35]
v_pk_mul_f32 v[54:55], v[54:55], v[34:35]
v_cvt_pk_bf16_f32 v52, v52, v53
v_cvt_pk_bf16_f32 v53, v54, v55
ds_write_b64 v6, v[52:53] offset:12288
v_pk_mul_f32 v[80:81], v[80:81], v[34:35]
v_pk_mul_f32 v[82:83], v[82:83], v[34:35]
v_cvt_pk_bf16_f32 v80, v80, v81
v_cvt_pk_bf16_f32 v81, v82, v83
ds_write_b64 v7, v[80:81] offset:12288
v_pk_mul_f32 v[108:109], v[108:109], v[34:35]
v_pk_mul_f32 v[110:111], v[110:111], v[34:35]
v_cvt_pk_bf16_f32 v108, v108, v109
v_cvt_pk_bf16_f32 v109, v110, v111
ds_write_b64 v8, v[108:109] offset:12288
v_pk_mul_f32 v[136:137], v[136:137], v[34:35]
v_pk_mul_f32 v[138:139], v[138:139], v[34:35]
v_cvt_pk_bf16_f32 v136, v136, v137
v_cvt_pk_bf16_f32 v137, v138, v139
ds_write_b64 v9, v[136:137] offset:12288
v_pk_mul_f32 v[56:57], v[56:57], v[34:35]
v_pk_mul_f32 v[58:59], v[58:59], v[34:35]
v_cvt_pk_bf16_f32 v56, v56, v57
v_cvt_pk_bf16_f32 v57, v58, v59
ds_write_b64 v152, v[56:57] offset:16384
v_pk_mul_f32 v[84:85], v[84:85], v[34:35]
v_pk_mul_f32 v[86:87], v[86:87], v[34:35]
v_cvt_pk_bf16_f32 v84, v84, v85
v_cvt_pk_bf16_f32 v85, v86, v87
ds_write_b64 v153, v[84:85] offset:16384
v_pk_mul_f32 v[112:113], v[112:113], v[34:35]
v_pk_mul_f32 v[114:115], v[114:115], v[34:35]
v_cvt_pk_bf16_f32 v112, v112, v113
v_cvt_pk_bf16_f32 v113, v114, v115
ds_write_b64 v154, v[112:113] offset:16384
v_pk_mul_f32 v[140:141], v[140:141], v[34:35]
v_pk_mul_f32 v[142:143], v[142:143], v[34:35]
v_cvt_pk_bf16_f32 v140, v140, v141
v_cvt_pk_bf16_f32 v141, v142, v143
ds_write_b64 v155, v[140:141] offset:16384
v_pk_mul_f32 v[60:61], v[60:61], v[34:35]
v_pk_mul_f32 v[62:63], v[62:63], v[34:35]
v_cvt_pk_bf16_f32 v60, v60, v61
v_cvt_pk_bf16_f32 v61, v62, v63
ds_write_b64 v152, v[60:61] offset:20480
v_pk_mul_f32 v[88:89], v[88:89], v[34:35]
v_pk_mul_f32 v[90:91], v[90:91], v[34:35]
v_cvt_pk_bf16_f32 v88, v88, v89
v_cvt_pk_bf16_f32 v89, v90, v91
ds_write_b64 v153, v[88:89] offset:20480
v_pk_mul_f32 v[116:117], v[116:117], v[34:35]
v_pk_mul_f32 v[118:119], v[118:119], v[34:35]
v_cvt_pk_bf16_f32 v116, v116, v117
v_cvt_pk_bf16_f32 v117, v118, v119
ds_write_b64 v154, v[116:117] offset:20480
v_pk_mul_f32 v[144:145], v[144:145], v[34:35]
v_pk_mul_f32 v[146:147], v[146:147], v[34:35]
v_cvt_pk_bf16_f32 v144, v144, v145
v_cvt_pk_bf16_f32 v145, v146, v147
ds_write_b64 v155, v[144:145] offset:20480
s_waitcnt lgkmcnt(2)
v_pk_mul_f32 v[64:65], v[64:65], v[34:35]
v_pk_mul_f32 v[66:67], v[66:67], v[34:35]
v_cvt_pk_bf16_f32 v64, v64, v65
v_cvt_pk_bf16_f32 v65, v66, v67
ds_write_b64 v152, v[64:65] offset:24576
v_pk_mul_f32 v[92:93], v[92:93], v[34:35]
v_pk_mul_f32 v[94:95], v[94:95], v[34:35]
v_cvt_pk_bf16_f32 v92, v92, v93
v_cvt_pk_bf16_f32 v93, v94, v95
ds_write_b64 v153, v[92:93] offset:24576
v_pk_mul_f32 v[120:121], v[120:121], v[34:35]
v_pk_mul_f32 v[122:123], v[122:123], v[34:35]
v_cvt_pk_bf16_f32 v120, v120, v121
v_cvt_pk_bf16_f32 v121, v122, v123
ds_write_b64 v154, v[120:121] offset:24576
v_pk_mul_f32 v[148:149], v[148:149], v[34:35]
v_pk_mul_f32 v[150:151], v[150:151], v[34:35]
v_cvt_pk_bf16_f32 v148, v148, v149
v_cvt_pk_bf16_f32 v149, v150, v151
ds_write_b64 v155, v[148:149] offset:24576
v_xor_b32 v168, 0, v5
v_xor_b32 v169, 64, v5
v_xor_b32 v170, 128, v5
v_xor_b32 v171, 192, v5
s_waitcnt vmcnt(21) lgkmcnt(0)
s_barrier
ds_read_b128 v[124:127], v212 offset:32768
ds_read_b128 v[140:143], v212 offset:36864
ds_read_b128 v[128:131], v213 offset:32768
ds_read_b128 v[144:147], v213 offset:36864
ds_read_b128 v[132:135], v214 offset:32768
ds_read_b128 v[148:151], v214 offset:36864
ds_read_b128 v[136:139], v215 offset:32768
ds_read_b128 v[152:155], v215 offset:36864
ds_read_b128 a[128:131], v168 offset:0
ds_read_b128 a[132:135], v169 offset:0
ds_read_b128 a[136:139], v170 offset:0
ds_read_b128 a[140:143], v171 offset:0
ds_read_b128 a[144:147], v168 offset:4096
ds_read_b128 a[148:151], v169 offset:4096
s_waitcnt lgkmcnt(4)
ds_read_b128 a[152:155], v170 offset:4096
ds_read_b128 a[156:159], v171 offset:4096
ds_read_b128 a[160:163], v168 offset:8192
ds_read_b128 a[164:167], v169 offset:8192
ds_read_b128 a[168:171], v170 offset:8192
ds_read_b128 a[172:175], v171 offset:8192
ds_read_b128 a[176:179], v168 offset:12288
ds_read_b128 a[180:183], v169 offset:12288
s_waitcnt lgkmcnt(4)
ds_read_b128 a[184:187], v170 offset:12288
ds_read_b128 a[188:191], v171 offset:12288
v_accvgpr_read_b32 v10, a224
v_accvgpr_read_b32 v11, a225
v_accvgpr_read_b32 v12, a226
v_accvgpr_read_b32 v13, a227
v_accvgpr_read_b32 v14, a228
v_accvgpr_read_b32 v15, a229
v_accvgpr_read_b32 v16, a230
v_accvgpr_read_b32 v17, a231
v_accvgpr_read_b32 v18, a232
v_accvgpr_read_b32 v19, a233
v_accvgpr_read_b32 v20, a234
v_accvgpr_read_b32 v21, a235
v_accvgpr_read_b32 v22, a236
v_accvgpr_read_b32 v23, a237
v_accvgpr_read_b32 v24, a238
v_accvgpr_read_b32 v25, a239
v_accvgpr_read_b32 v26, a240
v_accvgpr_read_b32 v27, a241
s_lshl_b32 s44, s38, 21
s_lshl_b32 s45, s39, 9
s_add_u32 s44, s44, s45
s_add_u32 s8, s62, s44
s_addc_u32 s9, s63, 0
s_mov_b32 s10, 0
s_mov_b32 s11, 0x20000
s_sub_u32 s10, 0x800000, s44
s_lshl_b32 s55, s39, 19
s_mov_b64 s[96:97], s[60:61]
s_lshr_b64 s[98:99], s[60:61], 12
s_lshr_b64 s[98:99], s[98:99], 4
s_and_b32 s54, s98, 15
s_lshl_b32 s54, s54, 11
v_lshrrev_b32 v34, 2, v1
v_lshlrev_b32 v34, 11, v34
v_and_b32 v35, 3, v1
v_lshl_add_u32 v34, v35, 7, v34
s_lshl_b32 s88, s34, 18
s_lshl_b32 s44, s32, 15
s_add_u32 s88, s88, s44
s_waitcnt vmcnt(63) lgkmcnt(0)
s_barrier
s_add_u32 s56, s85, 4
s_lshl_b32 s56, s56, 13
s_sub_u32 s57, s56, 16384
s_cmp_lg_u32 s85, 0
s_cbranch_scc1 L_att3
s_add_u32 m0, s81, 98304
s_nop 0
buffer_load_dwordx4 v32, s[16:19], s57 offen offset:0 nt lds
buffer_load_dwordx4 v33, s[16:19], s57 offen offset:1024 nt lds
buffer_load_dwordx4 v32, s[16:19], s57 offen offset:2048 nt lds
buffer_load_dwordx4 v33, s[16:19], s57 offen offset:3072 nt lds
s_add_u32 s57, s57, 4096
v_mfma_f32_16x16x32_bf16 v[60:63], v[124:127], a[128:131], v[232:235]
v_mfma_f32_16x16x32_bf16 v[64:67], v[124:127], a[144:147], v[236:239]
v_mfma_f32_16x16x32_bf16 v[68:71], v[124:127], a[160:163], v[240:243]
v_mfma_f32_16x16x32_bf16 v[72:75], v[124:127], a[176:179], v[244:247]
v_mfma_f32_16x16x32_bf16 v[76:79], v[140:143], a[128:131], v[232:235]
v_mfma_f32_16x16x32_bf16 v[80:83], v[140:143], a[144:147], v[236:239]
v_mfma_f32_16x16x32_bf16 v[84:87], v[140:143], a[160:163], v[240:243]
v_mfma_f32_16x16x32_bf16 v[88:91], v[140:143], a[176:179], v[244:247]
v_mfma_f32_16x16x32_bf16 v[60:63], v[128:131], a[132:135], v[60:63]
v_mfma_f32_16x16x32_bf16 v[64:67], v[128:131], a[148:151], v[64:67]
v_mfma_f32_16x16x32_bf16 v[68:71], v[128:131], a[164:167], v[68:71]
v_mfma_f32_16x16x32_bf16 v[72:75], v[128:131], a[180:183], v[72:75]
v_mfma_f32_16x16x32_bf16 v[76:79], v[144:147], a[132:135], v[76:79]
v_mfma_f32_16x16x32_bf16 v[80:83], v[144:147], a[148:151], v[80:83]
v_mfma_f32_16x16x32_bf16 v[84:87], v[144:147], a[164:167], v[84:87]
v_mfma_f32_16x16x32_bf16 v[88:91], v[144:147], a[180:183], v[88:91]
v_mfma_f32_16x16x32_bf16 v[60:63], v[132:135], a[136:139], v[60:63]
v_mfma_f32_16x16x32_bf16 v[64:67], v[132:135], a[152:155], v[64:67]
v_mfma_f32_16x16x32_bf16 v[68:71], v[132:135], a[168:171], v[68:71]
v_mfma_f32_16x16x32_bf16 v[72:75], v[132:135], a[184:187], v[72:75]
v_mfma_f32_16x16x32_bf16 v[76:79], v[148:151], a[136:139], v[76:79]
v_mfma_f32_16x16x32_bf16 v[80:83], v[148:151], a[152:155], v[80:83]
v_mfma_f32_16x16x32_bf16 v[84:87], v[148:151], a[168:171], v[84:87]
v_mfma_f32_16x16x32_bf16 v[88:91], v[148:151], a[184:187], v[88:91]
v_mfma_f32_16x16x32_bf16 v[60:63], v[136:139], a[140:143], v[60:63]
v_mfma_f32_16x16x32_bf16 v[64:67], v[136:139], a[156:159], v[64:67]
v_mfma_f32_16x16x32_bf16 v[68:71], v[136:139], a[172:175], v[68:71]
v_mfma_f32_16x16x32_bf16 v[72:75], v[136:139], a[188:191], v[72:75]
v_mfma_f32_16x16x32_bf16 v[76:79], v[152:155], a[140:143], v[76:79]
v_mfma_f32_16x16x32_bf16 v[80:83], v[152:155], a[156:159], v[80:83]
v_mfma_f32_16x16x32_bf16 v[84:87], v[152:155], a[172:175], v[84:87]
v_mfma_f32_16x16x32_bf16 v[88:91], v[152:155], a[188:191], v[88:91]
s_waitcnt vmcnt(4) lgkmcnt(0)
s_barrier
ds_read_b128 v[124:127], v208 offset:0
ds_read_b128 v[140:143], v208 offset:4096
ds_read_b128 v[128:131], v209 offset:0
ds_read_b128 v[144:147], v209 offset:4096
ds_read_b128 v[132:135], v210 offset:0
ds_read_b128 v[148:151], v210 offset:4096
ds_read_b128 v[136:139], v211 offset:0
ds_read_b128 v[152:155], v211 offset:4096
v_readfirstlane_b32 s90, v38
v_readfirstlane_b32 s91, v39
v_max3_f32 v2, v60, v61, v62
v_max3_f32 v2, v2, v63, v76
v_max3_f32 v2, v2, v77, v78
v_max_f32 v2, v2, v79
v_mov_b32 v3, v2
s_nop 1
v_permlane16_swap_b32 v2, v3
s_nop 1
v_max_f32 v2, v2, v3
v_mov_b32 v3, v2
s_nop 1
v_permlane32_swap_b32 v2, v3
s_nop 1
v_max_f32 v2, v2, v3
v_sub_f32 v60, v60, v2
v_sub_f32 v61, v61, v2
v_sub_f32 v62, v62, v2
v_sub_f32 v63, v63, v2
v_sub_f32 v76, v76, v2
v_sub_f32 v77, v77, v2
v_sub_f32 v78, v78, v2
v_sub_f32 v79, v79, v2
v_sub_f32 v232, v232, v2
v_sub_f32 v233, v233, v2
v_sub_f32 v234, v234, v2
v_sub_f32 v235, v235, v2
v_max3_f32 v2, v64, v65, v66
v_max3_f32 v2, v2, v67, v80
v_max3_f32 v2, v2, v81, v82
v_max_f32 v2, v2, v83
v_mov_b32 v3, v2
s_nop 1
v_permlane16_swap_b32 v2, v3
s_nop 1
v_max_f32 v2, v2, v3
v_mov_b32 v3, v2
s_nop 1
v_permlane32_swap_b32 v2, v3
s_nop 1
v_max_f32 v2, v2, v3
v_sub_f32 v64, v64, v2
v_sub_f32 v65, v65, v2
v_sub_f32 v66, v66, v2
v_sub_f32 v67, v67, v2
v_sub_f32 v80, v80, v2
v_sub_f32 v81, v81, v2
v_sub_f32 v82, v82, v2
v_sub_f32 v83, v83, v2
v_sub_f32 v236, v236, v2
v_sub_f32 v237, v237, v2
v_sub_f32 v238, v238, v2
v_sub_f32 v239, v239, v2
v_max3_f32 v2, v68, v69, v70
v_max3_f32 v2, v2, v71, v84
v_max3_f32 v2, v2, v85, v86
v_max_f32 v2, v2, v87
v_mov_b32 v3, v2
s_nop 1
v_permlane16_swap_b32 v2, v3
s_nop 1
v_max_f32 v2, v2, v3
v_mov_b32 v3, v2
s_nop 1
v_permlane32_swap_b32 v2, v3
s_nop 1
v_max_f32 v2, v2, v3
v_sub_f32 v68, v68, v2
v_sub_f32 v69, v69, v2
v_sub_f32 v70, v70, v2
v_sub_f32 v71, v71, v2
v_sub_f32 v84, v84, v2
v_sub_f32 v85, v85, v2
v_sub_f32 v86, v86, v2
v_sub_f32 v87, v87, v2
v_sub_f32 v240, v240, v2
v_sub_f32 v241, v241, v2
v_sub_f32 v242, v242, v2
v_sub_f32 v243, v243, v2
v_max3_f32 v2, v72, v73, v74
v_max3_f32 v2, v2, v75, v88
v_max3_f32 v2, v2, v89, v90
v_max_f32 v2, v2, v91
v_mov_b32 v3, v2
s_nop 1
v_permlane16_swap_b32 v2, v3
s_nop 1
v_max_f32 v2, v2, v3
v_mov_b32 v3, v2
s_nop 1
v_permlane32_swap_b32 v2, v3
s_nop 1
v_max_f32 v2, v2, v3
v_sub_f32 v72, v72, v2
v_sub_f32 v73, v73, v2
v_sub_f32 v74, v74, v2
v_sub_f32 v75, v75, v2
v_sub_f32 v88, v88, v2
v_sub_f32 v89, v89, v2
v_sub_f32 v90, v90, v2
v_sub_f32 v91, v91, v2
v_sub_f32 v244, v244, v2
v_sub_f32 v245, v245, v2
v_sub_f32 v246, v246, v2
v_sub_f32 v247, v247, v2
v_exp_f32 v60, v60
v_exp_f32 v61, v61
v_exp_f32 v62, v62
v_exp_f32 v63, v63
v_exp_f32 v76, v76
v_exp_f32 v77, v77
v_exp_f32 v78, v78
v_exp_f32 v79, v79
s_mov_b32 s53, 7
L_aloop_4:
s_waitcnt lgkmcnt(0)
v_mfma_f32_16x16x32_bf16 v[92:95], v[124:127], a[128:131], v[232:235]
ds_read_b64_tr_b16 v[156:157], v216 offset:0
v_exp_f32 v64, v64
v_mfma_f32_16x16x32_bf16 v[96:99], v[124:127], a[144:147], v[236:239]
v_exp_f32 v65, v65
v_mfma_f32_16x16x32_bf16 v[100:103], v[124:127], a[160:163], v[240:243]
ds_read_b64_tr_b16 v[158:159], v216 offset:4096
v_pk_add_f32 v[248:249], v[248:249], v[60:61]
v_mfma_f32_16x16x32_bf16 v[104:107], v[124:127], a[176:179], v[244:247]
v_cvt_pk_bf16_f32 v44, v60, v61
v_exp_f32 v66, v66
v_mfma_f32_16x16x32_bf16 v[108:111], v[140:143], a[128:131], v[232:235]
ds_read_b64_tr_b16 v[160:161], v217 offset:0
s_add_u32 m0, s81, 102400
s_nop 0
s_waitcnt vmcnt(4)
buffer_load_dwordx4 v32, s[16:19], s57 offen offset:0 nt lds
s_cmp_lg_u32 s82, 0
s_cbranch_scc1 L_r2_3
L_b2_4:
v_exp_f32 v67, v67
v_mfma_f32_16x16x32_bf16 v[112:115], v[140:143], a[144:147], v[236:239]
v_pk_add_f32 v[248:249], v[248:249], v[62:63]
v_mfma_f32_16x16x32_bf16 v[116:119], v[140:143], a[160:163], v[240:243]
ds_read_b64_tr_b16 v[162:163], v217 offset:4096
v_cvt_pk_bf16_f32 v45, v62, v63
v_mfma_f32_16x16x32_bf16 v[120:123], v[140:143], a[176:179], v[244:247]
v_exp_f32 v80, v80
v_mfma_f32_16x16x32_bf16 v[92:95], v[128:131], a[132:135], v[92:95]
ds_read_b64_tr_b16 v[164:165], v218 offset:0
v_exp_f32 v81, v81
v_mfma_f32_16x16x32_bf16 v[96:99], v[128:131], a[148:151], v[96:99]
v_pk_add_f32 v[248:249], v[248:249], v[76:77]
v_cvt_pk_bf16_f32 v46, v76, v77
v_mfma_f32_16x16x32_bf16 v[100:103], v[128:131], a[164:167], v[100:103]
ds_read_b64_tr_b16 v[166:167], v218 offset:4096
v_exp_f32 v82, v82
v_mfma_f32_16x16x32_bf16 v[104:107], v[128:131], a[180:183], v[104:107]
v_exp_f32 v83, v83
v_mfma_f32_16x16x32_bf16 v[108:111], v[144:147], a[132:135], v[108:111]
ds_read_b64_tr_b16 v[168:169], v219 offset:0
s_waitcnt vmcnt(4)
buffer_load_dwordx4 v33, s[16:19], s57 offen offset:1024 nt lds
v_pk_add_f32 v[248:249], v[248:249], v[78:79]
v_mfma_f32_16x16x32_bf16 v[112:115], v[144:147], a[148:151], v[112:115]
v_cvt_pk_bf16_f32 v47, v78, v79
v_exp_f32 v68, v68
v_mfma_f32_16x16x32_bf16 v[116:119], v[144:147], a[164:167], v[116:119]
ds_read_b64_tr_b16 v[170:171], v219 offset:4096
v_exp_f32 v69, v69
v_mfma_f32_16x16x32_bf16 v[120:123], v[144:147], a[180:183], v[120:123]
ds_read_b64_tr_b16 v[172:173], v220 offset:0
v_pk_add_f32 v[250:251], v[250:251], v[64:65]
v_mfma_f32_16x16x32_bf16 v[92:95], v[132:135], a[136:139], v[92:95]
v_cvt_pk_bf16_f32 v48, v64, v65
v_mfma_f32_16x16x32_bf16 v[96:99], v[132:135], a[152:155], v[96:99]
ds_read_b64_tr_b16 v[174:175], v220 offset:4096
v_exp_f32 v70, v70
v_mfma_f32_16x16x32_bf16 v[100:103], v[132:135], a[168:171], v[100:103]
v_exp_f32 v71, v71
v_mfma_f32_16x16x32_bf16 v[104:107], v[132:135], a[184:187], v[104:107]
ds_read_b64_tr_b16 v[176:177], v221 offset:0
v_pk_add_f32 v[250:251], v[250:251], v[66:67]
v_cvt_pk_bf16_f32 v49, v66, v67
v_mfma_f32_16x16x32_bf16 v[108:111], v[148:151], a[136:139], v[108:111]
v_exp_f32 v84, v84
v_mfma_f32_16x16x32_bf16 v[112:115], v[148:151], a[152:155], v[112:115]
ds_read_b64_tr_b16 v[178:179], v221 offset:4096
s_waitcnt vmcnt(4)
buffer_load_dwordx4 v32, s[16:19], s57 offen offset:2048 nt lds
v_exp_f32 v85, v85
v_mfma_f32_16x16x32_bf16 v[116:119], v[148:151], a[168:171], v[116:119]
v_pk_add_f32 v[250:251], v[250:251], v[80:81]
v_cvt_pk_bf16_f32 v50, v80, v81
v_mfma_f32_16x16x32_bf16 v[120:123], v[148:151], a[184:187], v[120:123]
ds_read_b64_tr_b16 v[180:181], v222 offset:0
v_exp_f32 v86, v86
v_mfma_f32_16x16x32_bf16 v[92:95], v[136:139], a[140:143], v[92:95]
v_exp_f32 v87, v87
v_mfma_f32_16x16x32_bf16 v[96:99], v[136:139], a[156:159], v[96:99]
ds_read_b64_tr_b16 v[182:183], v222 offset:4096
v_pk_add_f32 v[250:251], v[250:251], v[82:83]
v_mfma_f32_16x16x32_bf16 v[100:103], v[136:139], a[172:175], v[100:103]
v_cvt_pk_bf16_f32 v51, v82, v83
v_mfma_f32_16x16x32_bf16 v[104:107], v[136:139], a[188:191], v[104:107]
ds_read_b64_tr_b16 v[184:185], v223 offset:0
v_exp_f32 v72, v72
v_mfma_f32_16x16x32_bf16 v[108:111], v[152:155], a[140:143], v[108:111]
v_exp_f32 v73, v73
v_mfma_f32_16x16x32_bf16 v[112:115], v[152:155], a[156:159], v[112:115]
s_waitcnt lgkmcnt(11)
ds_read_b64_tr_b16 v[186:187], v223 offset:4096
s_waitcnt vmcnt(4)
buffer_load_dwordx4 v33, s[16:19], s57 offen offset:3072 nt lds
s_add_u32 s57, s57, 12288
v_pk_add_f32 v[252:253], v[252:253], v[68:69]
v_cvt_pk_bf16_f32 v52, v68, v69
v_mfma_f32_16x16x32_bf16 v[116:119], v[152:155], a[172:175], v[116:119]
v_exp_f32 v74, v74
v_mfma_f32_16x16x32_bf16 v[120:123], v[152:155], a[188:191], v[120:123]
v_exp_f32 v75, v75
v_mfma_f32_16x16x32_bf16 a[0:3], v[156:159], v[44:47], a[0:3]
v_pk_add_f32 v[252:253], v[252:253], v[70:71]
v_cvt_pk_bf16_f32 v53, v70, v71
v_mfma_f32_16x16x32_bf16 a[16:19], v[160:163], v[44:47], a[16:19]
v_exp_f32 v88, v88
s_waitcnt lgkmcnt(10)
v_mfma_f32_16x16x32_bf16 a[32:35], v[164:167], v[44:47], a[32:35]
v_exp_f32 v89, v89
s_waitcnt vmcnt(8) lgkmcnt(0)
s_barrier
v_mfma_f32_16x16x32_bf16 a[48:51], v[168:171], v[44:47], a[48:51]
v_pk_add_f32 v[252:253], v[252:253], v[84:85]
v_mfma_f32_16x16x32_bf16 a[64:67], v[172:175], v[44:47], a[64:67]
v_cvt_pk_bf16_f32 v54, v84, v85
ds_read_b128 v[124:127], v208 offset:32768
v_mfma_f32_16x16x32_bf16 a[80:83], v[176:179], v[44:47], a[80:83]
v_exp_f32 v90, v90
v_mfma_f32_16x16x32_bf16 a[96:99], v[180:183], v[44:47], a[96:99]
v_exp_f32 v91, v91
s_add_u32 m0, s81, 147456
s_nop 0
s_waitcnt vmcnt(4)
buffer_load_dwordx4 v28, s[12:15], s56 offen offset:0 nt lds
v_mfma_f32_16x16x32_bf16 a[112:115], v[184:187], v[44:47], a[112:115]
v_pk_add_f32 v[252:253], v[252:253], v[86:87]
v_cvt_pk_bf16_f32 v55, v86, v87
ds_read_b128 v[140:143], v208 offset:36864
v_mfma_f32_16x16x32_bf16 a[4:7], v[156:159], v[48:51], a[4:7]
v_pk_add_f32 v[254:255], v[254:255], v[72:73]
v_cvt_pk_bf16_f32 v56, v72, v73
v_mfma_f32_16x16x32_bf16 a[20:23], v[160:163], v[48:51], a[20:23]
v_pk_add_f32 v[254:255], v[254:255], v[74:75]
v_mfma_f32_16x16x32_bf16 a[36:39], v[164:167], v[48:51], a[36:39]
v_cvt_pk_bf16_f32 v57, v74, v75
v_pk_add_f32 v[254:255], v[254:255], v[88:89]
ds_read_b128 v[128:131], v209 offset:32768
v_mfma_f32_16x16x32_bf16 a[52:55], v[168:171], v[48:51], a[52:55]
v_cvt_pk_bf16_f32 v58, v88, v89
v_pk_add_f32 v[254:255], v[254:255], v[90:91]
v_mfma_f32_16x16x32_bf16 a[68:71], v[172:175], v[48:51], a[68:71]
v_cvt_pk_bf16_f32 v59, v90, v91
v_mfma_f32_16x16x32_bf16 a[84:87], v[176:179], v[48:51], a[84:87]
v_max3_f32 v2, v92, v93, v94
v_max3_f32 v2, v2, v95, v96
ds_read_b128 v[144:147], v209 offset:36864
s_waitcnt vmcnt(4)
buffer_load_dwordx4 v29, s[12:15], s56 offen offset:1024 nt lds
v_mfma_f32_16x16x32_bf16 a[100:103], v[180:183], v[48:51], a[100:103]
v_max3_f32 v2, v2, v97, v98
v_max3_f32 v2, v2, v99, v100
v_mfma_f32_16x16x32_bf16 a[116:119], v[184:187], v[48:51], a[116:119]
v_max3_f32 v2, v2, v101, v102
ds_read_b128 v[132:135], v210 offset:32768
v_mfma_f32_16x16x32_bf16 a[8:11], v[156:159], v[52:55], a[8:11]
v_max3_f32 v2, v2, v103, v104
v_max3_f32 v2, v2, v105, v106
v_mfma_f32_16x16x32_bf16 a[24:27], v[160:163], v[52:55], a[24:27]
v_max3_f32 v2, v2, v107, v108
v_max3_f32 v2, v2, v109, v110
v_mfma_f32_16x16x32_bf16 a[40:43], v[164:167], v[52:55], a[40:43]
v_max3_f32 v2, v2, v111, v112
v_max3_f32 v2, v2, v113, v114
ds_read_b128 v[148:151], v210 offset:36864
v_mfma_f32_16x16x32_bf16 a[56:59], v[168:171], v[52:55], a[56:59]
v_max3_f32 v2, v2, v115, v116
v_mfma_f32_16x16x32_bf16 a[72:75], v[172:175], v[52:55], a[72:75]
v_max3_f32 v2, v2, v117, v118
v_max3_f32 v2, v2, v119, v120
v_mfma_f32_16x16x32_bf16 a[88:91], v[176:179], v[52:55], a[88:91]
v_max3_f32 v2, v2, v121, v122
v_max_f32 v2, v2, v123
ds_read_b128 v[136:139], v211 offset:32768
s_waitcnt vmcnt(4)
buffer_load_dwordx4 v30, s[12:15], s56 offen offset:2048 nt lds
v_mfma_f32_16x16x32_bf16 a[104:107], v[180:183], v[52:55], a[104:107]
v_cmp_lt_f32 vcc, s59, v2
s_cbranch_vccnz L_r1_5
L_b1_6:
v_mfma_f32_16x16x32_bf16 a[120:123], v[184:187], v[52:55], a[120:123]
v_mfma_f32_16x16x32_bf16 a[12:15], v[156:159], v[56:59], a[12:15]
v_exp_f32 v92, v92
ds_read_b128 v[152:155], v211 offset:36864
v_mfma_f32_16x16x32_bf16 a[28:31], v[160:163], v[56:59], a[28:31]
v_exp_f32 v93, v93
v_mfma_f32_16x16x32_bf16 a[44:47], v[164:167], v[56:59], a[44:47]
v_exp_f32 v94, v94
v_mfma_f32_16x16x32_bf16 a[60:63], v[168:171], v[56:59], a[60:63]
v_exp_f32 v95, v95
v_mfma_f32_16x16x32_bf16 a[76:79], v[172:175], v[56:59], a[76:79]
v_exp_f32 v108, v108
s_waitcnt vmcnt(4)
buffer_load_dwordx4 v31, s[12:15], s56 offen offset:3072 nt lds
s_add_u32 s56, s56, 4096
v_mfma_f32_16x16x32_bf16 a[92:95], v[176:179], v[56:59], a[92:95]
v_exp_f32 v109, v109
v_mfma_f32_16x16x32_bf16 a[108:111], v[180:183], v[56:59], a[108:111]
v_exp_f32 v110, v110
v_mfma_f32_16x16x32_bf16 a[124:127], v[184:187], v[56:59], a[124:127]
v_exp_f32 v111, v111
s_waitcnt lgkmcnt(0)
v_mfma_f32_16x16x32_bf16 v[60:63], v[124:127], a[128:131], v[232:235]
ds_read_b64_tr_b16 v[156:157], v216 offset:32768
v_exp_f32 v96, v96
v_mfma_f32_16x16x32_bf16 v[64:67], v[124:127], a[144:147], v[236:239]
v_exp_f32 v97, v97
v_mfma_f32_16x16x32_bf16 v[68:71], v[124:127], a[160:163], v[240:243]
ds_read_b64_tr_b16 v[158:159], v216 offset:36864
v_pk_add_f32 v[248:249], v[248:249], v[92:93]
v_mfma_f32_16x16x32_bf16 v[72:75], v[124:127], a[176:179], v[244:247]
v_cvt_pk_bf16_f32 v44, v92, v93
v_exp_f32 v98, v98
v_mfma_f32_16x16x32_bf16 v[76:79], v[140:143], a[128:131], v[232:235]
ds_read_b64_tr_b16 v[160:161], v217 offset:32768
s_add_u32 m0, s81, 151552
s_nop 0
s_waitcnt vmcnt(4)
buffer_load_dwordx4 v28, s[12:15], s56 offen offset:0 nt lds
s_cmp_lg_u32 s82, 0
s_cbranch_scc1 L_r2_7
L_b2_8:
v_exp_f32 v99, v99
v_mfma_f32_16x16x32_bf16 v[80:83], v[140:143], a[144:147], v[236:239]
v_pk_add_f32 v[248:249], v[248:249], v[94:95]
v_mfma_f32_16x16x32_bf16 v[84:87], v[140:143], a[160:163], v[240:243]
ds_read_b64_tr_b16 v[162:163], v217 offset:36864
v_cvt_pk_bf16_f32 v45, v94, v95
v_mfma_f32_16x16x32_bf16 v[88:91], v[140:143], a[176:179], v[244:247]
v_exp_f32 v112, v112
v_mfma_f32_16x16x32_bf16 v[60:63], v[128:131], a[132:135], v[60:63]
ds_read_b64_tr_b16 v[164:165], v218 offset:32768
v_exp_f32 v113, v113
v_mfma_f32_16x16x32_bf16 v[64:67], v[128:131], a[148:151], v[64:67]
v_pk_add_f32 v[248:249], v[248:249], v[108:109]
v_cvt_pk_bf16_f32 v46, v108, v109
v_mfma_f32_16x16x32_bf16 v[68:71], v[128:131], a[164:167], v[68:71]
ds_read_b64_tr_b16 v[166:167], v218 offset:36864
v_exp_f32 v114, v114
v_mfma_f32_16x16x32_bf16 v[72:75], v[128:131], a[180:183], v[72:75]
v_exp_f32 v115, v115
v_mfma_f32_16x16x32_bf16 v[76:79], v[144:147], a[132:135], v[76:79]
ds_read_b64_tr_b16 v[168:169], v219 offset:32768
s_waitcnt vmcnt(4)
buffer_load_dwordx4 v29, s[12:15], s56 offen offset:1024 nt lds
v_pk_add_f32 v[248:249], v[248:249], v[110:111]
v_mfma_f32_16x16x32_bf16 v[80:83], v[144:147], a[148:151], v[80:83]
v_cvt_pk_bf16_f32 v47, v110, v111
v_exp_f32 v100, v100
v_mfma_f32_16x16x32_bf16 v[84:87], v[144:147], a[164:167], v[84:87]
ds_read_b64_tr_b16 v[170:171], v219 offset:36864
v_exp_f32 v101, v101
v_mfma_f32_16x16x32_bf16 v[88:91], v[144:147], a[180:183], v[88:91]
ds_read_b64_tr_b16 v[172:173], v220 offset:32768
v_pk_add_f32 v[250:251], v[250:251], v[96:97]
v_mfma_f32_16x16x32_bf16 v[60:63], v[132:135], a[136:139], v[60:63]
v_cvt_pk_bf16_f32 v48, v96, v97
v_mfma_f32_16x16x32_bf16 v[64:67], v[132:135], a[152:155], v[64:67]
ds_read_b64_tr_b16 v[174:175], v220 offset:36864
v_exp_f32 v102, v102
v_mfma_f32_16x16x32_bf16 v[68:71], v[132:135], a[168:171], v[68:71]
v_exp_f32 v103, v103
v_mfma_f32_16x16x32_bf16 v[72:75], v[132:135], a[184:187], v[72:75]
ds_read_b64_tr_b16 v[176:177], v221 offset:32768
v_pk_add_f32 v[250:251], v[250:251], v[98:99]
v_cvt_pk_bf16_f32 v49, v98, v99
v_mfma_f32_16x16x32_bf16 v[76:79], v[148:151], a[136:139], v[76:79]
v_exp_f32 v116, v116
v_mfma_f32_16x16x32_bf16 v[80:83], v[148:151], a[152:155], v[80:83]
ds_read_b64_tr_b16 v[178:179], v221 offset:36864
s_waitcnt vmcnt(4)
buffer_load_dwordx4 v30, s[12:15], s56 offen offset:2048 nt lds
v_exp_f32 v117, v117
v_mfma_f32_16x16x32_bf16 v[84:87], v[148:151], a[168:171], v[84:87]
v_pk_add_f32 v[250:251], v[250:251], v[112:113]
v_cvt_pk_bf16_f32 v50, v112, v113
v_mfma_f32_16x16x32_bf16 v[88:91], v[148:151], a[184:187], v[88:91]
ds_read_b64_tr_b16 v[180:181], v222 offset:32768
v_exp_f32 v118, v118
v_mfma_f32_16x16x32_bf16 v[60:63], v[136:139], a[140:143], v[60:63]
v_exp_f32 v119, v119
v_mfma_f32_16x16x32_bf16 v[64:67], v[136:139], a[156:159], v[64:67]
ds_read_b64_tr_b16 v[182:183], v222 offset:36864
v_pk_add_f32 v[250:251], v[250:251], v[114:115]
v_mfma_f32_16x16x32_bf16 v[68:71], v[136:139], a[172:175], v[68:71]
v_cvt_pk_bf16_f32 v51, v114, v115
v_mfma_f32_16x16x32_bf16 v[72:75], v[136:139], a[188:191], v[72:75]
ds_read_b64_tr_b16 v[184:185], v223 offset:32768
v_exp_f32 v104, v104
v_mfma_f32_16x16x32_bf16 v[76:79], v[152:155], a[140:143], v[76:79]
v_exp_f32 v105, v105
v_mfma_f32_16x16x32_bf16 v[80:83], v[152:155], a[156:159], v[80:83]
s_waitcnt lgkmcnt(11)
ds_read_b64_tr_b16 v[186:187], v223 offset:36864
s_waitcnt vmcnt(4)
buffer_load_dwordx4 v31, s[12:15], s56 offen offset:3072 nt lds
s_add_u32 s56, s56, 12288
v_pk_add_f32 v[252:253], v[252:253], v[100:101]
v_cvt_pk_bf16_f32 v52, v100, v101
v_mfma_f32_16x16x32_bf16 v[84:87], v[152:155], a[172:175], v[84:87]
v_exp_f32 v106, v106
v_mfma_f32_16x16x32_bf16 v[88:91], v[152:155], a[188:191], v[88:91]
v_exp_f32 v107, v107
v_mfma_f32_16x16x32_bf16 a[0:3], v[156:159], v[44:47], a[0:3]
v_pk_add_f32 v[252:253], v[252:253], v[102:103]
v_cvt_pk_bf16_f32 v53, v102, v103
v_mfma_f32_16x16x32_bf16 a[16:19], v[160:163], v[44:47], a[16:19]
v_exp_f32 v120, v120
s_waitcnt lgkmcnt(10)
v_mfma_f32_16x16x32_bf16 a[32:35], v[164:167], v[44:47], a[32:35]
v_exp_f32 v121, v121
s_waitcnt vmcnt(8) lgkmcnt(0)
s_barrier
v_mfma_f32_16x16x32_bf16 a[48:51], v[168:171], v[44:47], a[48:51]
v_pk_add_f32 v[252:253], v[252:253], v[116:117]
v_mfma_f32_16x16x32_bf16 a[64:67], v[172:175], v[44:47], a[64:67]
v_cvt_pk_bf16_f32 v54, v116, v117
ds_read_b128 v[124:127], v212 offset:0
v_mfma_f32_16x16x32_bf16 a[80:83], v[176:179], v[44:47], a[80:83]
v_exp_f32 v122, v122
v_mfma_f32_16x16x32_bf16 a[96:99], v[180:183], v[44:47], a[96:99]
v_exp_f32 v123, v123
s_add_u32 m0, s81, 32768
s_nop 0
s_waitcnt vmcnt(4)
buffer_load_dwordx4 v32, s[16:19], s57 offen offset:0 nt lds
v_mfma_f32_16x16x32_bf16 a[112:115], v[184:187], v[44:47], a[112:115]
v_pk_add_f32 v[252:253], v[252:253], v[118:119]
v_cvt_pk_bf16_f32 v55, v118, v119
ds_read_b128 v[140:143], v212 offset:4096
v_mfma_f32_16x16x32_bf16 a[4:7], v[156:159], v[48:51], a[4:7]
v_pk_add_f32 v[254:255], v[254:255], v[104:105]
v_cvt_pk_bf16_f32 v56, v104, v105
v_mfma_f32_16x16x32_bf16 a[20:23], v[160:163], v[48:51], a[20:23]
v_pk_add_f32 v[254:255], v[254:255], v[106:107]
v_mfma_f32_16x16x32_bf16 a[36:39], v[164:167], v[48:51], a[36:39]
v_cvt_pk_bf16_f32 v57, v106, v107
v_pk_add_f32 v[254:255], v[254:255], v[120:121]
ds_read_b128 v[128:131], v213 offset:0
v_mfma_f32_16x16x32_bf16 a[52:55], v[168:171], v[48:51], a[52:55]
v_cvt_pk_bf16_f32 v58, v120, v121
v_pk_add_f32 v[254:255], v[254:255], v[122:123]
v_mfma_f32_16x16x32_bf16 a[68:71], v[172:175], v[48:51], a[68:71]
v_cvt_pk_bf16_f32 v59, v122, v123
v_mfma_f32_16x16x32_bf16 a[84:87], v[176:179], v[48:51], a[84:87]
v_max3_f32 v2, v60, v61, v62
v_max3_f32 v2, v2, v63, v64
ds_read_b128 v[144:147], v213 offset:4096
s_waitcnt vmcnt(4)
buffer_load_dwordx4 v33, s[16:19], s57 offen offset:1024 nt lds
v_mfma_f32_16x16x32_bf16 a[100:103], v[180:183], v[48:51], a[100:103]
v_max3_f32 v2, v2, v65, v66
v_max3_f32 v2, v2, v67, v68
v_mfma_f32_16x16x32_bf16 a[116:119], v[184:187], v[48:51], a[116:119]
v_max3_f32 v2, v2, v69, v70
ds_read_b128 v[132:135], v214 offset:0
v_mfma_f32_16x16x32_bf16 a[8:11], v[156:159], v[52:55], a[8:11]
v_max3_f32 v2, v2, v71, v72
v_max3_f32 v2, v2, v73, v74
v_mfma_f32_16x16x32_bf16 a[24:27], v[160:163], v[52:55], a[24:27]
v_max3_f32 v2, v2, v75, v76
v_max3_f32 v2, v2, v77, v78
v_mfma_f32_16x16x32_bf16 a[40:43], v[164:167], v[52:55], a[40:43]
v_max3_f32 v2, v2, v79, v80
v_max3_f32 v2, v2, v81, v82
ds_read_b128 v[148:151], v214 offset:4096
v_mfma_f32_16x16x32_bf16 a[56:59], v[168:171], v[52:55], a[56:59]
v_max3_f32 v2, v2, v83, v84
v_mfma_f32_16x16x32_bf16 a[72:75], v[172:175], v[52:55], a[72:75]
v_max3_f32 v2, v2, v85, v86
v_max3_f32 v2, v2, v87, v88
v_mfma_f32_16x16x32_bf16 a[88:91], v[176:179], v[52:55], a[88:91]
v_max3_f32 v2, v2, v89, v90
v_max_f32 v2, v2, v91
ds_read_b128 v[136:139], v215 offset:0
s_waitcnt vmcnt(4)
buffer_load_dwordx4 v32, s[16:19], s57 offen offset:2048 nt lds
v_mfma_f32_16x16x32_bf16 a[104:107], v[180:183], v[52:55], a[104:107]
v_cmp_lt_f32 vcc, s59, v2
s_cbranch_vccnz L_r1_9
L_b1_10:
v_mfma_f32_16x16x32_bf16 a[120:123], v[184:187], v[52:55], a[120:123]
v_mfma_f32_16x16x32_bf16 a[12:15], v[156:159], v[56:59], a[12:15]
v_exp_f32 v60, v60
ds_read_b128 v[152:155], v215 offset:4096
v_mfma_f32_16x16x32_bf16 a[28:31], v[160:163], v[56:59], a[28:31]
v_exp_f32 v61, v61
v_mfma_f32_16x16x32_bf16 a[44:47], v[164:167], v[56:59], a[44:47]
v_exp_f32 v62, v62
v_mfma_f32_16x16x32_bf16 a[60:63], v[168:171], v[56:59], a[60:63]
v_exp_f32 v63, v63
v_mfma_f32_16x16x32_bf16 a[76:79], v[172:175], v[56:59], a[76:79]
v_exp_f32 v76, v76
s_waitcnt vmcnt(4)
buffer_load_dwordx4 v33, s[16:19], s57 offen offset:3072 nt lds
s_add_u32 s57, s57, 4096
v_mfma_f32_16x16x32_bf16 a[92:95], v[176:179], v[56:59], a[92:95]
v_exp_f32 v77, v77
v_mfma_f32_16x16x32_bf16 a[108:111], v[180:183], v[56:59], a[108:111]
v_exp_f32 v78, v78
v_mfma_f32_16x16x32_bf16 a[124:127], v[184:187], v[56:59], a[124:127]
v_exp_f32 v79, v79
s_waitcnt lgkmcnt(0)
v_mfma_f32_16x16x32_bf16 v[92:95], v[124:127], a[128:131], v[232:235]
ds_read_b64_tr_b16 v[156:157], v224 offset:0
v_exp_f32 v64, v64
v_mfma_f32_16x16x32_bf16 v[96:99], v[124:127], a[144:147], v[236:239]
v_exp_f32 v65, v65
v_mfma_f32_16x16x32_bf16 v[100:103], v[124:127], a[160:163], v[240:243]
ds_read_b64_tr_b16 v[158:159], v224 offset:4096
v_pk_add_f32 v[248:249], v[248:249], v[60:61]
v_mfma_f32_16x16x32_bf16 v[104:107], v[124:127], a[176:179], v[244:247]
v_cvt_pk_bf16_f32 v44, v60, v61
v_exp_f32 v66, v66
v_mfma_f32_16x16x32_bf16 v[108:111], v[140:143], a[128:131], v[232:235]
ds_read_b64_tr_b16 v[160:161], v225 offset:0
s_add_u32 m0, s81, 36864
s_nop 0
s_waitcnt vmcnt(4)
buffer_load_dwordx4 v32, s[16:19], s57 offen offset:0 nt lds
s_cmp_lg_u32 s82, 0
s_cbranch_scc1 L_r2_11
L_b2_12:
v_exp_f32 v67, v67
v_mfma_f32_16x16x32_bf16 v[112:115], v[140:143], a[144:147], v[236:239]
v_pk_add_f32 v[248:249], v[248:249], v[62:63]
v_mfma_f32_16x16x32_bf16 v[116:119], v[140:143], a[160:163], v[240:243]
ds_read_b64_tr_b16 v[162:163], v225 offset:4096
v_cvt_pk_bf16_f32 v45, v62, v63
v_mfma_f32_16x16x32_bf16 v[120:123], v[140:143], a[176:179], v[244:247]
v_exp_f32 v80, v80
v_mfma_f32_16x16x32_bf16 v[92:95], v[128:131], a[132:135], v[92:95]
ds_read_b64_tr_b16 v[164:165], v226 offset:0
v_exp_f32 v81, v81
v_mfma_f32_16x16x32_bf16 v[96:99], v[128:131], a[148:151], v[96:99]
v_pk_add_f32 v[248:249], v[248:249], v[76:77]
v_cvt_pk_bf16_f32 v46, v76, v77
v_mfma_f32_16x16x32_bf16 v[100:103], v[128:131], a[164:167], v[100:103]
ds_read_b64_tr_b16 v[166:167], v226 offset:4096
v_exp_f32 v82, v82
v_mfma_f32_16x16x32_bf16 v[104:107], v[128:131], a[180:183], v[104:107]
v_exp_f32 v83, v83
v_mfma_f32_16x16x32_bf16 v[108:111], v[144:147], a[132:135], v[108:111]
ds_read_b64_tr_b16 v[168:169], v227 offset:0
s_waitcnt vmcnt(4)
buffer_load_dwordx4 v33, s[16:19], s57 offen offset:1024 nt lds
v_pk_add_f32 v[248:249], v[248:249], v[78:79]
v_mfma_f32_16x16x32_bf16 v[112:115], v[144:147], a[148:151], v[112:115]
v_cvt_pk_bf16_f32 v47, v78, v79
v_exp_f32 v68, v68
v_mfma_f32_16x16x32_bf16 v[116:119], v[144:147], a[164:167], v[116:119]
ds_read_b64_tr_b16 v[170:171], v227 offset:4096
v_exp_f32 v69, v69
v_mfma_f32_16x16x32_bf16 v[120:123], v[144:147], a[180:183], v[120:123]
ds_read_b64_tr_b16 v[172:173], v228 offset:0
v_pk_add_f32 v[250:251], v[250:251], v[64:65]
v_mfma_f32_16x16x32_bf16 v[92:95], v[132:135], a[136:139], v[92:95]
v_cvt_pk_bf16_f32 v48, v64, v65
v_mfma_f32_16x16x32_bf16 v[96:99], v[132:135], a[152:155], v[96:99]
ds_read_b64_tr_b16 v[174:175], v228 offset:4096
v_exp_f32 v70, v70
v_mfma_f32_16x16x32_bf16 v[100:103], v[132:135], a[168:171], v[100:103]
v_exp_f32 v71, v71
v_mfma_f32_16x16x32_bf16 v[104:107], v[132:135], a[184:187], v[104:107]
ds_read_b64_tr_b16 v[176:177], v229 offset:0
v_pk_add_f32 v[250:251], v[250:251], v[66:67]
v_cvt_pk_bf16_f32 v49, v66, v67
v_mfma_f32_16x16x32_bf16 v[108:111], v[148:151], a[136:139], v[108:111]
v_exp_f32 v84, v84
v_mfma_f32_16x16x32_bf16 v[112:115], v[148:151], a[152:155], v[112:115]
ds_read_b64_tr_b16 v[178:179], v229 offset:4096
s_waitcnt vmcnt(4)
buffer_load_dwordx4 v32, s[16:19], s57 offen offset:2048 nt lds
v_exp_f32 v85, v85
v_mfma_f32_16x16x32_bf16 v[116:119], v[148:151], a[168:171], v[116:119]
v_pk_add_f32 v[250:251], v[250:251], v[80:81]
v_cvt_pk_bf16_f32 v50, v80, v81
v_mfma_f32_16x16x32_bf16 v[120:123], v[148:151], a[184:187], v[120:123]
ds_read_b64_tr_b16 v[180:181], v230 offset:0
v_exp_f32 v86, v86
v_mfma_f32_16x16x32_bf16 v[92:95], v[136:139], a[140:143], v[92:95]
v_exp_f32 v87, v87
v_mfma_f32_16x16x32_bf16 v[96:99], v[136:139], a[156:159], v[96:99]
ds_read_b64_tr_b16 v[182:183], v230 offset:4096
v_pk_add_f32 v[250:251], v[250:251], v[82:83]
v_mfma_f32_16x16x32_bf16 v[100:103], v[136:139], a[172:175], v[100:103]
v_cvt_pk_bf16_f32 v51, v82, v83
v_mfma_f32_16x16x32_bf16 v[104:107], v[136:139], a[188:191], v[104:107]
ds_read_b64_tr_b16 v[184:185], v231 offset:0
v_exp_f32 v72, v72
v_mfma_f32_16x16x32_bf16 v[108:111], v[152:155], a[140:143], v[108:111]
v_exp_f32 v73, v73
v_mfma_f32_16x16x32_bf16 v[112:115], v[152:155], a[156:159], v[112:115]
s_waitcnt lgkmcnt(11)
ds_read_b64_tr_b16 v[186:187], v231 offset:4096
s_waitcnt vmcnt(4)
buffer_load_dwordx4 v33, s[16:19], s57 offen offset:3072 nt lds
s_add_u32 s57, s57, 12288
v_pk_add_f32 v[252:253], v[252:253], v[68:69]
v_cvt_pk_bf16_f32 v52, v68, v69
v_mfma_f32_16x16x32_bf16 v[116:119], v[152:155], a[172:175], v[116:119]
v_exp_f32 v74, v74
v_mfma_f32_16x16x32_bf16 v[120:123], v[152:155], a[188:191], v[120:123]
v_exp_f32 v75, v75
v_mfma_f32_16x16x32_bf16 a[0:3], v[156:159], v[44:47], a[0:3]
v_pk_add_f32 v[252:253], v[252:253], v[70:71]
v_cvt_pk_bf16_f32 v53, v70, v71
v_mfma_f32_16x16x32_bf16 a[16:19], v[160:163], v[44:47], a[16:19]
v_exp_f32 v88, v88
s_waitcnt lgkmcnt(10)
v_mfma_f32_16x16x32_bf16 a[32:35], v[164:167], v[44:47], a[32:35]
v_exp_f32 v89, v89
s_waitcnt vmcnt(8) lgkmcnt(0)
s_barrier
v_mfma_f32_16x16x32_bf16 a[48:51], v[168:171], v[44:47], a[48:51]
v_pk_add_f32 v[252:253], v[252:253], v[84:85]
v_mfma_f32_16x16x32_bf16 a[64:67], v[172:175], v[44:47], a[64:67]
v_cvt_pk_bf16_f32 v54, v84, v85
ds_read_b128 v[124:127], v212 offset:32768
v_mfma_f32_16x16x32_bf16 a[80:83], v[176:179], v[44:47], a[80:83]
v_exp_f32 v90, v90
v_mfma_f32_16x16x32_bf16 a[96:99], v[180:183], v[44:47], a[96:99]
v_exp_f32 v91, v91
s_add_u32 m0, s81, 81920
s_nop 0
s_waitcnt vmcnt(4)
buffer_load_dwordx4 v28, s[12:15], s56 offen offset:0 nt lds
v_mfma_f32_16x16x32_bf16 a[112:115], v[184:187], v[44:47], a[112:115]
v_pk_add_f32 v[252:253], v[252:253], v[86:87]
v_cvt_pk_bf16_f32 v55, v86, v87
ds_read_b128 v[140:143], v212 offset:36864
v_mfma_f32_16x16x32_bf16 a[4:7], v[156:159], v[48:51], a[4:7]
v_pk_add_f32 v[254:255], v[254:255], v[72:73]
v_cvt_pk_bf16_f32 v56, v72, v73
v_mfma_f32_16x16x32_bf16 a[20:23], v[160:163], v[48:51], a[20:23]
v_pk_add_f32 v[254:255], v[254:255], v[74:75]
v_mfma_f32_16x16x32_bf16 a[36:39], v[164:167], v[48:51], a[36:39]
v_cvt_pk_bf16_f32 v57, v74, v75
v_pk_add_f32 v[254:255], v[254:255], v[88:89]
ds_read_b128 v[128:131], v213 offset:32768
v_mfma_f32_16x16x32_bf16 a[52:55], v[168:171], v[48:51], a[52:55]
v_cvt_pk_bf16_f32 v58, v88, v89
v_pk_add_f32 v[254:255], v[254:255], v[90:91]
v_mfma_f32_16x16x32_bf16 a[68:71], v[172:175], v[48:51], a[68:71]
v_cvt_pk_bf16_f32 v59, v90, v91
v_mfma_f32_16x16x32_bf16 a[84:87], v[176:179], v[48:51], a[84:87]
v_max3_f32 v2, v92, v93, v94
v_max3_f32 v2, v2, v95, v96
ds_read_b128 v[144:147], v213 offset:36864
s_waitcnt vmcnt(4)
buffer_load_dwordx4 v29, s[12:15], s56 offen offset:1024 nt lds
v_mfma_f32_16x16x32_bf16 a[100:103], v[180:183], v[48:51], a[100:103]
v_max3_f32 v2, v2, v97, v98
v_max3_f32 v2, v2, v99, v100
v_mfma_f32_16x16x32_bf16 a[116:119], v[184:187], v[48:51], a[116:119]
v_max3_f32 v2, v2, v101, v102
ds_read_b128 v[132:135], v214 offset:32768
v_mfma_f32_16x16x32_bf16 a[8:11], v[156:159], v[52:55], a[8:11]
v_max3_f32 v2, v2, v103, v104
v_max3_f32 v2, v2, v105, v106
v_mfma_f32_16x16x32_bf16 a[24:27], v[160:163], v[52:55], a[24:27]
v_max3_f32 v2, v2, v107, v108
v_max3_f32 v2, v2, v109, v110
v_mfma_f32_16x16x32_bf16 a[40:43], v[164:167], v[52:55], a[40:43]
v_max3_f32 v2, v2, v111, v112
v_max3_f32 v2, v2, v113, v114
ds_read_b128 v[148:151], v214 offset:36864
v_mfma_f32_16x16x32_bf16 a[56:59], v[168:171], v[52:55], a[56:59]
v_max3_f32 v2, v2, v115, v116
v_mfma_f32_16x16x32_bf16 a[72:75], v[172:175], v[52:55], a[72:75]
v_max3_f32 v2, v2, v117, v118
v_max3_f32 v2, v2, v119, v120
v_mfma_f32_16x16x32_bf16 a[88:91], v[176:179], v[52:55], a[88:91]
v_max3_f32 v2, v2, v121, v122
v_max_f32 v2, v2, v123
ds_read_b128 v[136:139], v215 offset:32768
s_waitcnt vmcnt(4)
buffer_load_dwordx4 v30, s[12:15], s56 offen offset:2048 nt lds
v_mfma_f32_16x16x32_bf16 a[104:107], v[180:183], v[52:55], a[104:107]
v_cmp_lt_f32 vcc, s59, v2
s_cbranch_vccnz L_r1_13
L_b1_14:
v_mfma_f32_16x16x32_bf16 a[120:123], v[184:187], v[52:55], a[120:123]
v_mfma_f32_16x16x32_bf16 a[12:15], v[156:159], v[56:59], a[12:15]
v_exp_f32 v92, v92
ds_read_b128 v[152:155], v215 offset:36864
v_mfma_f32_16x16x32_bf16 a[28:31], v[160:163], v[56:59], a[28:31]
v_exp_f32 v93, v93
v_mfma_f32_16x16x32_bf16 a[44:47], v[164:167], v[56:59], a[44:47]
v_exp_f32 v94, v94
v_mfma_f32_16x16x32_bf16 a[60:63], v[168:171], v[56:59], a[60:63]
v_exp_f32 v95, v95
v_mfma_f32_16x16x32_bf16 a[76:79], v[172:175], v[56:59], a[76:79]
v_exp_f32 v108, v108
s_waitcnt vmcnt(4)
buffer_load_dwordx4 v31, s[12:15], s56 offen offset:3072 nt lds
s_add_u32 s56, s56, 4096
v_mfma_f32_16x16x32_bf16 a[92:95], v[176:179], v[56:59], a[92:95]
v_exp_f32 v109, v109
v_mfma_f32_16x16x32_bf16 a[108:111], v[180:183], v[56:59], a[108:111]
v_exp_f32 v110, v110
v_mfma_f32_16x16x32_bf16 a[124:127], v[184:187], v[56:59], a[124:127]
v_exp_f32 v111, v111
s_waitcnt lgkmcnt(0)
v_mfma_f32_16x16x32_bf16 v[60:63], v[124:127], a[128:131], v[232:235]
ds_read_b64_tr_b16 v[156:157], v224 offset:32768
v_exp_f32 v96, v96
v_mfma_f32_16x16x32_bf16 v[64:67], v[124:127], a[144:147], v[236:239]
v_exp_f32 v97, v97
v_mfma_f32_16x16x32_bf16 v[68:71], v[124:127], a[160:163], v[240:243]
ds_read_b64_tr_b16 v[158:159], v224 offset:36864
v_pk_add_f32 v[248:249], v[248:249], v[92:93]
v_mfma_f32_16x16x32_bf16 v[72:75], v[124:127], a[176:179], v[244:247]
v_cvt_pk_bf16_f32 v44, v92, v93
v_exp_f32 v98, v98
v_mfma_f32_16x16x32_bf16 v[76:79], v[140:143], a[128:131], v[232:235]
ds_read_b64_tr_b16 v[160:161], v225 offset:32768
s_add_u32 m0, s81, 86016
s_nop 0
s_waitcnt vmcnt(4)
buffer_load_dwordx4 v28, s[12:15], s56 offen offset:0 nt lds
s_cmp_lg_u32 s82, 0
s_cbranch_scc1 L_r2_15
L_b2_16:
v_exp_f32 v99, v99
v_mfma_f32_16x16x32_bf16 v[80:83], v[140:143], a[144:147], v[236:239]
v_pk_add_f32 v[248:249], v[248:249], v[94:95]
v_mfma_f32_16x16x32_bf16 v[84:87], v[140:143], a[160:163], v[240:243]
ds_read_b64_tr_b16 v[162:163], v225 offset:36864
v_cvt_pk_bf16_f32 v45, v94, v95
v_mfma_f32_16x16x32_bf16 v[88:91], v[140:143], a[176:179], v[244:247]
v_exp_f32 v112, v112
v_mfma_f32_16x16x32_bf16 v[60:63], v[128:131], a[132:135], v[60:63]
ds_read_b64_tr_b16 v[164:165], v226 offset:32768
v_exp_f32 v113, v113
v_mfma_f32_16x16x32_bf16 v[64:67], v[128:131], a[148:151], v[64:67]
v_pk_add_f32 v[248:249], v[248:249], v[108:109]
v_cvt_pk_bf16_f32 v46, v108, v109
v_mfma_f32_16x16x32_bf16 v[68:71], v[128:131], a[164:167], v[68:71]
ds_read_b64_tr_b16 v[166:167], v226 offset:36864
v_exp_f32 v114, v114
v_mfma_f32_16x16x32_bf16 v[72:75], v[128:131], a[180:183], v[72:75]
v_exp_f32 v115, v115
v_mfma_f32_16x16x32_bf16 v[76:79], v[144:147], a[132:135], v[76:79]
ds_read_b64_tr_b16 v[168:169], v227 offset:32768
s_waitcnt vmcnt(4)
buffer_load_dwordx4 v29, s[12:15], s56 offen offset:1024 nt lds
v_pk_add_f32 v[248:249], v[248:249], v[110:111]
v_mfma_f32_16x16x32_bf16 v[80:83], v[144:147], a[148:151], v[80:83]
v_cvt_pk_bf16_f32 v47, v110, v111
v_exp_f32 v100, v100
v_mfma_f32_16x16x32_bf16 v[84:87], v[144:147], a[164:167], v[84:87]
ds_read_b64_tr_b16 v[170:171], v227 offset:36864
v_exp_f32 v101, v101
v_mfma_f32_16x16x32_bf16 v[88:91], v[144:147], a[180:183], v[88:91]
ds_read_b64_tr_b16 v[172:173], v228 offset:32768
v_pk_add_f32 v[250:251], v[250:251], v[96:97]
v_mfma_f32_16x16x32_bf16 v[60:63], v[132:135], a[136:139], v[60:63]
v_cvt_pk_bf16_f32 v48, v96, v97
v_mfma_f32_16x16x32_bf16 v[64:67], v[132:135], a[152:155], v[64:67]
ds_read_b64_tr_b16 v[174:175], v228 offset:36864
v_exp_f32 v102, v102
v_mfma_f32_16x16x32_bf16 v[68:71], v[132:135], a[168:171], v[68:71]
v_exp_f32 v103, v103
v_mfma_f32_16x16x32_bf16 v[72:75], v[132:135], a[184:187], v[72:75]
ds_read_b64_tr_b16 v[176:177], v229 offset:32768
v_pk_add_f32 v[250:251], v[250:251], v[98:99]
v_cvt_pk_bf16_f32 v49, v98, v99
v_mfma_f32_16x16x32_bf16 v[76:79], v[148:151], a[136:139], v[76:79]
v_exp_f32 v116, v116
v_mfma_f32_16x16x32_bf16 v[80:83], v[148:151], a[152:155], v[80:83]
ds_read_b64_tr_b16 v[178:179], v229 offset:36864
s_waitcnt vmcnt(4)
buffer_load_dwordx4 v30, s[12:15], s56 offen offset:2048 nt lds
v_exp_f32 v117, v117
v_mfma_f32_16x16x32_bf16 v[84:87], v[148:151], a[168:171], v[84:87]
v_pk_add_f32 v[250:251], v[250:251], v[112:113]
v_cvt_pk_bf16_f32 v50, v112, v113
v_mfma_f32_16x16x32_bf16 v[88:91], v[148:151], a[184:187], v[88:91]
ds_read_b64_tr_b16 v[180:181], v230 offset:32768
v_exp_f32 v118, v118
v_mfma_f32_16x16x32_bf16 v[60:63], v[136:139], a[140:143], v[60:63]
v_exp_f32 v119, v119
v_mfma_f32_16x16x32_bf16 v[64:67], v[136:139], a[156:159], v[64:67]
ds_read_b64_tr_b16 v[182:183], v230 offset:36864
v_pk_add_f32 v[250:251], v[250:251], v[114:115]
v_mfma_f32_16x16x32_bf16 v[68:71], v[136:139], a[172:175], v[68:71]
v_cvt_pk_bf16_f32 v51, v114, v115
v_mfma_f32_16x16x32_bf16 v[72:75], v[136:139], a[188:191], v[72:75]
ds_read_b64_tr_b16 v[184:185], v231 offset:32768
v_exp_f32 v104, v104
v_mfma_f32_16x16x32_bf16 v[76:79], v[152:155], a[140:143], v[76:79]
v_exp_f32 v105, v105
v_mfma_f32_16x16x32_bf16 v[80:83], v[152:155], a[156:159], v[80:83]
s_waitcnt lgkmcnt(11)
ds_read_b64_tr_b16 v[186:187], v231 offset:36864
s_waitcnt vmcnt(4)
buffer_load_dwordx4 v31, s[12:15], s56 offen offset:3072 nt lds
s_add_u32 s56, s56, 12288
v_pk_add_f32 v[252:253], v[252:253], v[100:101]
v_cvt_pk_bf16_f32 v52, v100, v101
v_mfma_f32_16x16x32_bf16 v[84:87], v[152:155], a[172:175], v[84:87]
v_exp_f32 v106, v106
v_mfma_f32_16x16x32_bf16 v[88:91], v[152:155], a[188:191], v[88:91]
v_exp_f32 v107, v107
v_mfma_f32_16x16x32_bf16 a[0:3], v[156:159], v[44:47], a[0:3]
v_pk_add_f32 v[252:253], v[252:253], v[102:103]
v_cvt_pk_bf16_f32 v53, v102, v103
v_mfma_f32_16x16x32_bf16 a[16:19], v[160:163], v[44:47], a[16:19]
v_exp_f32 v120, v120
s_waitcnt lgkmcnt(10)
v_mfma_f32_16x16x32_bf16 a[32:35], v[164:167], v[44:47], a[32:35]
v_exp_f32 v121, v121
s_waitcnt vmcnt(8) lgkmcnt(0)
s_barrier
v_mfma_f32_16x16x32_bf16 a[48:51], v[168:171], v[44:47], a[48:51]
v_pk_add_f32 v[252:253], v[252:253], v[116:117]
v_mfma_f32_16x16x32_bf16 a[64:67], v[172:175], v[44:47], a[64:67]
v_cvt_pk_bf16_f32 v54, v116, v117
ds_read_b128 v[124:127], v208 offset:0
v_mfma_f32_16x16x32_bf16 a[80:83], v[176:179], v[44:47], a[80:83]
v_exp_f32 v122, v122
v_mfma_f32_16x16x32_bf16 a[96:99], v[180:183], v[44:47], a[96:99]
v_exp_f32 v123, v123
s_add_u32 m0, s81, 98304
s_nop 0
s_waitcnt vmcnt(4)
buffer_load_dwordx4 v32, s[16:19], s57 offen offset:0 nt lds
v_mfma_f32_16x16x32_bf16 a[112:115], v[184:187], v[44:47], a[112:115]
v_pk_add_f32 v[252:253], v[252:253], v[118:119]
v_cvt_pk_bf16_f32 v55, v118, v119
ds_read_b128 v[140:143], v208 offset:4096
v_mfma_f32_16x16x32_bf16 a[4:7], v[156:159], v[48:51], a[4:7]
v_pk_add_f32 v[254:255], v[254:255], v[104:105]
v_cvt_pk_bf16_f32 v56, v104, v105
v_mfma_f32_16x16x32_bf16 a[20:23], v[160:163], v[48:51], a[20:23]
v_pk_add_f32 v[254:255], v[254:255], v[106:107]
v_mfma_f32_16x16x32_bf16 a[36:39], v[164:167], v[48:51], a[36:39]
v_cvt_pk_bf16_f32 v57, v106, v107
v_pk_add_f32 v[254:255], v[254:255], v[120:121]
ds_read_b128 v[128:131], v209 offset:0
v_mfma_f32_16x16x32_bf16 a[52:55], v[168:171], v[48:51], a[52:55]
v_cvt_pk_bf16_f32 v58, v120, v121
v_pk_add_f32 v[254:255], v[254:255], v[122:123]
v_mfma_f32_16x16x32_bf16 a[68:71], v[172:175], v[48:51], a[68:71]
v_cvt_pk_bf16_f32 v59, v122, v123
v_mfma_f32_16x16x32_bf16 a[84:87], v[176:179], v[48:51], a[84:87]
v_max3_f32 v2, v60, v61, v62
v_max3_f32 v2, v2, v63, v64
ds_read_b128 v[144:147], v209 offset:4096
s_waitcnt vmcnt(4)
buffer_load_dwordx4 v33, s[16:19], s57 offen offset:1024 nt lds
v_mfma_f32_16x16x32_bf16 a[100:103], v[180:183], v[48:51], a[100:103]
v_max3_f32 v2, v2, v65, v66
v_max3_f32 v2, v2, v67, v68
v_mfma_f32_16x16x32_bf16 a[116:119], v[184:187], v[48:51], a[116:119]
v_max3_f32 v2, v2, v69, v70
ds_read_b128 v[132:135], v210 offset:0
v_mfma_f32_16x16x32_bf16 a[8:11], v[156:159], v[52:55], a[8:11]
v_max3_f32 v2, v2, v71, v72
v_max3_f32 v2, v2, v73, v74
v_mfma_f32_16x16x32_bf16 a[24:27], v[160:163], v[52:55], a[24:27]
v_max3_f32 v2, v2, v75, v76
v_max3_f32 v2, v2, v77, v78
v_mfma_f32_16x16x32_bf16 a[40:43], v[164:167], v[52:55], a[40:43]
v_max3_f32 v2, v2, v79, v80
v_max3_f32 v2, v2, v81, v82
ds_read_b128 v[148:151], v210 offset:4096
v_mfma_f32_16x16x32_bf16 a[56:59], v[168:171], v[52:55], a[56:59]
v_max3_f32 v2, v2, v83, v84
v_mfma_f32_16x16x32_bf16 a[72:75], v[172:175], v[52:55], a[72:75]
v_max3_f32 v2, v2, v85, v86
v_max3_f32 v2, v2, v87, v88
v_mfma_f32_16x16x32_bf16 a[88:91], v[176:179], v[52:55], a[88:91]
v_max3_f32 v2, v2, v89, v90
v_max_f32 v2, v2, v91
ds_read_b128 v[136:139], v211 offset:0
s_waitcnt vmcnt(4)
buffer_load_dwordx4 v32, s[16:19], s57 offen offset:2048 nt lds
v_mfma_f32_16x16x32_bf16 a[104:107], v[180:183], v[52:55], a[104:107]
v_cmp_lt_f32 vcc, s59, v2
s_cbranch_vccnz L_r1_17
L_b1_18:
v_mfma_f32_16x16x32_bf16 a[120:123], v[184:187], v[52:55], a[120:123]
v_mfma_f32_16x16x32_bf16 a[12:15], v[156:159], v[56:59], a[12:15]
v_exp_f32 v60, v60
ds_read_b128 v[152:155], v211 offset:4096
v_mfma_f32_16x16x32_bf16 a[28:31], v[160:163], v[56:59], a[28:31]
v_exp_f32 v61, v61
v_mfma_f32_16x16x32_bf16 a[44:47], v[164:167], v[56:59], a[44:47]
v_exp_f32 v62, v62
v_mfma_f32_16x16x32_bf16 a[60:63], v[168:171], v[56:59], a[60:63]
v_exp_f32 v63, v63
v_mfma_f32_16x16x32_bf16 a[76:79], v[172:175], v[56:59], a[76:79]
v_exp_f32 v76, v76
s_waitcnt vmcnt(4)
buffer_load_dwordx4 v33, s[16:19], s57 offen offset:3072 nt lds
s_add_u32 s57, s57, 4096
v_mfma_f32_16x16x32_bf16 a[92:95], v[176:179], v[56:59], a[92:95]
v_exp_f32 v77, v77
v_mfma_f32_16x16x32_bf16 a[108:111], v[180:183], v[56:59], a[108:111]
v_exp_f32 v78, v78
v_mfma_f32_16x16x32_bf16 a[124:127], v[184:187], v[56:59], a[124:127]
v_exp_f32 v79, v79
s_sub_u32 s53, s53, 1
s_cmp_lg_u32 s53, 0
s_cbranch_scc1 L_aloop_4
s_waitcnt lgkmcnt(0)
v_mfma_f32_16x16x32_bf16 v[92:95], v[124:127], a[128:131], v[232:235]
ds_read_b64_tr_b16 v[156:157], v216 offset:0
v_exp_f32 v64, v64
v_mfma_f32_16x16x32_bf16 v[96:99], v[124:127], a[144:147], v[236:239]
v_exp_f32 v65, v65
v_mfma_f32_16x16x32_bf16 v[100:103], v[124:127], a[160:163], v[240:243]
ds_read_b64_tr_b16 v[158:159], v216 offset:4096
v_pk_add_f32 v[248:249], v[248:249], v[60:61]
v_mfma_f32_16x16x32_bf16 v[104:107], v[124:127], a[176:179], v[244:247]
v_cvt_pk_bf16_f32 v44, v60, v61
v_exp_f32 v66, v66
v_mfma_f32_16x16x32_bf16 v[108:111], v[140:143], a[128:131], v[232:235]
ds_read_b64_tr_b16 v[160:161], v217 offset:0
s_add_u32 m0, s81, 102400
s_nop 0
s_waitcnt vmcnt(4)
buffer_load_dwordx4 v32, s[16:19], s57 offen offset:0 nt lds
s_cmp_lg_u32 s82, 0
s_cbranch_scc1 L_r2_19
L_b2_20:
v_exp_f32 v67, v67
v_mfma_f32_16x16x32_bf16 v[112:115], v[140:143], a[144:147], v[236:239]
v_pk_add_f32 v[248:249], v[248:249], v[62:63]
v_mfma_f32_16x16x32_bf16 v[116:119], v[140:143], a[160:163], v[240:243]
ds_read_b64_tr_b16 v[162:163], v217 offset:4096
v_cvt_pk_bf16_f32 v45, v62, v63
v_mfma_f32_16x16x32_bf16 v[120:123], v[140:143], a[176:179], v[244:247]
v_exp_f32 v80, v80
v_mfma_f32_16x16x32_bf16 v[92:95], v[128:131], a[132:135], v[92:95]
ds_read_b64_tr_b16 v[164:165], v218 offset:0
v_exp_f32 v81, v81
v_mfma_f32_16x16x32_bf16 v[96:99], v[128:131], a[148:151], v[96:99]
v_pk_add_f32 v[248:249], v[248:249], v[76:77]
v_cvt_pk_bf16_f32 v46, v76, v77
v_mfma_f32_16x16x32_bf16 v[100:103], v[128:131], a[164:167], v[100:103]
ds_read_b64_tr_b16 v[166:167], v218 offset:4096
v_exp_f32 v82, v82
v_mfma_f32_16x16x32_bf16 v[104:107], v[128:131], a[180:183], v[104:107]
v_exp_f32 v83, v83
v_mfma_f32_16x16x32_bf16 v[108:111], v[144:147], a[132:135], v[108:111]
ds_read_b64_tr_b16 v[168:169], v219 offset:0
s_waitcnt vmcnt(4)
buffer_load_dwordx4 v33, s[16:19], s57 offen offset:1024 nt lds
v_pk_add_f32 v[248:249], v[248:249], v[78:79]
v_mfma_f32_16x16x32_bf16 v[112:115], v[144:147], a[148:151], v[112:115]
v_cvt_pk_bf16_f32 v47, v78, v79
v_exp_f32 v68, v68
v_mfma_f32_16x16x32_bf16 v[116:119], v[144:147], a[164:167], v[116:119]
ds_read_b64_tr_b16 v[170:171], v219 offset:4096
v_exp_f32 v69, v69
v_mfma_f32_16x16x32_bf16 v[120:123], v[144:147], a[180:183], v[120:123]
ds_read_b64_tr_b16 v[172:173], v220 offset:0
v_pk_add_f32 v[250:251], v[250:251], v[64:65]
v_mfma_f32_16x16x32_bf16 v[92:95], v[132:135], a[136:139], v[92:95]
v_cvt_pk_bf16_f32 v48, v64, v65
v_mfma_f32_16x16x32_bf16 v[96:99], v[132:135], a[152:155], v[96:99]
ds_read_b64_tr_b16 v[174:175], v220 offset:4096
v_exp_f32 v70, v70
v_mfma_f32_16x16x32_bf16 v[100:103], v[132:135], a[168:171], v[100:103]
v_exp_f32 v71, v71
v_mfma_f32_16x16x32_bf16 v[104:107], v[132:135], a[184:187], v[104:107]
ds_read_b64_tr_b16 v[176:177], v221 offset:0
v_pk_add_f32 v[250:251], v[250:251], v[66:67]
v_cvt_pk_bf16_f32 v49, v66, v67
v_mfma_f32_16x16x32_bf16 v[108:111], v[148:151], a[136:139], v[108:111]
v_exp_f32 v84, v84
v_mfma_f32_16x16x32_bf16 v[112:115], v[148:151], a[152:155], v[112:115]
ds_read_b64_tr_b16 v[178:179], v221 offset:4096
s_waitcnt vmcnt(4)
buffer_load_dwordx4 v32, s[16:19], s57 offen offset:2048 nt lds
v_exp_f32 v85, v85
v_mfma_f32_16x16x32_bf16 v[116:119], v[148:151], a[168:171], v[116:119]
v_pk_add_f32 v[250:251], v[250:251], v[80:81]
v_cvt_pk_bf16_f32 v50, v80, v81
v_mfma_f32_16x16x32_bf16 v[120:123], v[148:151], a[184:187], v[120:123]
ds_read_b64_tr_b16 v[180:181], v222 offset:0
v_exp_f32 v86, v86
v_mfma_f32_16x16x32_bf16 v[92:95], v[136:139], a[140:143], v[92:95]
v_exp_f32 v87, v87
v_mfma_f32_16x16x32_bf16 v[96:99], v[136:139], a[156:159], v[96:99]
ds_read_b64_tr_b16 v[182:183], v222 offset:4096
v_pk_add_f32 v[250:251], v[250:251], v[82:83]
v_mfma_f32_16x16x32_bf16 v[100:103], v[136:139], a[172:175], v[100:103]
v_cvt_pk_bf16_f32 v51, v82, v83
v_mfma_f32_16x16x32_bf16 v[104:107], v[136:139], a[188:191], v[104:107]
ds_read_b64_tr_b16 v[184:185], v223 offset:0
v_exp_f32 v72, v72
v_mfma_f32_16x16x32_bf16 v[108:111], v[152:155], a[140:143], v[108:111]
v_exp_f32 v73, v73
v_mfma_f32_16x16x32_bf16 v[112:115], v[152:155], a[156:159], v[112:115]
s_waitcnt lgkmcnt(11)
ds_read_b64_tr_b16 v[186:187], v223 offset:4096
s_waitcnt vmcnt(4)
buffer_load_dwordx4 v33, s[16:19], s57 offen offset:3072 nt lds
s_add_u32 s57, s57, 12288
v_pk_add_f32 v[252:253], v[252:253], v[68:69]
v_cvt_pk_bf16_f32 v52, v68, v69
v_mfma_f32_16x16x32_bf16 v[116:119], v[152:155], a[172:175], v[116:119]
v_exp_f32 v74, v74
v_mfma_f32_16x16x32_bf16 v[120:123], v[152:155], a[188:191], v[120:123]
v_exp_f32 v75, v75
v_mfma_f32_16x16x32_bf16 a[0:3], v[156:159], v[44:47], a[0:3]
v_pk_add_f32 v[252:253], v[252:253], v[70:71]
v_cvt_pk_bf16_f32 v53, v70, v71
v_mfma_f32_16x16x32_bf16 a[16:19], v[160:163], v[44:47], a[16:19]
v_exp_f32 v88, v88
s_waitcnt lgkmcnt(10)
v_mfma_f32_16x16x32_bf16 a[32:35], v[164:167], v[44:47], a[32:35]
v_exp_f32 v89, v89
s_waitcnt vmcnt(8) lgkmcnt(0)
s_barrier
v_mfma_f32_16x16x32_bf16 a[48:51], v[168:171], v[44:47], a[48:51]
v_pk_add_f32 v[252:253], v[252:253], v[84:85]
v_mfma_f32_16x16x32_bf16 a[64:67], v[172:175], v[44:47], a[64:67]
v_cvt_pk_bf16_f32 v54, v84, v85
ds_read_b128 v[124:127], v208 offset:32768
s_add_u32 m0, s52, 0
s_add_u32 s86, s55, 65536
buffer_load_dwordx4 v14, s[8:11], s55 offen offset:0 lds
v_mfma_f32_16x16x32_bf16 a[80:83], v[176:179], v[44:47], a[80:83]
v_exp_f32 v90, v90
v_mfma_f32_16x16x32_bf16 a[96:99], v[180:183], v[44:47], a[96:99]
v_exp_f32 v91, v91
v_mfma_f32_16x16x32_bf16 a[112:115], v[184:187], v[44:47], a[112:115]
v_pk_add_f32 v[252:253], v[252:253], v[86:87]
v_cvt_pk_bf16_f32 v55, v86, v87
ds_read_b128 v[140:143], v208 offset:36864
v_mfma_f32_16x16x32_bf16 a[4:7], v[156:159], v[48:51], a[4:7]
v_pk_add_f32 v[254:255], v[254:255], v[72:73]
v_cvt_pk_bf16_f32 v56, v72, v73
buffer_load_dwordx4 v15, s[8:11], s55 offen offset:1024 lds
v_mfma_f32_16x16x32_bf16 a[20:23], v[160:163], v[48:51], a[20:23]
v_pk_add_f32 v[254:255], v[254:255], v[74:75]
v_mfma_f32_16x16x32_bf16 a[36:39], v[164:167], v[48:51], a[36:39]
v_cvt_pk_bf16_f32 v57, v74, v75
v_pk_add_f32 v[254:255], v[254:255], v[88:89]
ds_read_b128 v[128:131], v209 offset:32768
v_mfma_f32_16x16x32_bf16 a[52:55], v[168:171], v[48:51], a[52:55]
v_cvt_pk_bf16_f32 v58, v88, v89
v_pk_add_f32 v[254:255], v[254:255], v[90:91]
v_mfma_f32_16x16x32_bf16 a[68:71], v[172:175], v[48:51], a[68:71]
v_cvt_pk_bf16_f32 v59, v90, v91
buffer_load_dwordx4 v16, s[8:11], s55 offen offset:2048 lds
v_mfma_f32_16x16x32_bf16 a[84:87], v[176:179], v[48:51], a[84:87]
v_max3_f32 v2, v92, v93, v94
v_max3_f32 v2, v2, v95, v96
ds_read_b128 v[144:147], v209 offset:36864
v_mfma_f32_16x16x32_bf16 a[100:103], v[180:183], v[48:51], a[100:103]
v_max3_f32 v2, v2, v97, v98
v_max3_f32 v2, v2, v99, v100
v_mfma_f32_16x16x32_bf16 a[116:119], v[184:187], v[48:51], a[116:119]
v_max3_f32 v2, v2, v101, v102
ds_read_b128 v[132:135], v210 offset:32768
buffer_load_dwordx4 v17, s[8:11], s55 offen offset:3072 lds
s_lshr_b64 s[96:97], s[96:97], 4
s_and_b32 s55, s96, 15
s_lshl_b32 s55, s55, 17
v_mfma_f32_16x16x32_bf16 a[8:11], v[156:159], v[52:55], a[8:11]
v_max3_f32 v2, v2, v103, v104
v_max3_f32 v2, v2, v105, v106
v_mfma_f32_16x16x32_bf16 a[24:27], v[160:163], v[52:55], a[24:27]
v_max3_f32 v2, v2, v107, v108
v_max3_f32 v2, v2, v109, v110
v_mfma_f32_16x16x32_bf16 a[40:43], v[164:167], v[52:55], a[40:43]
v_max3_f32 v2, v2, v111, v112
v_max3_f32 v2, v2, v113, v114
ds_read_b128 v[148:151], v210 offset:36864
v_mfma_f32_16x16x32_bf16 a[56:59], v[168:171], v[52:55], a[56:59]
v_max3_f32 v2, v2, v115, v116
s_add_u32 m0, s52, 4096
s_nop 0
buffer_load_dwordx4 v14, s[8:11], s86 offen offset:0 lds
v_mfma_f32_16x16x32_bf16 a[72:75], v[172:175], v[52:55], a[72:75]
v_max3_f32 v2, v2, v117, v118
v_max3_f32 v2, v2, v119, v120
v_mfma_f32_16x16x32_bf16 a[88:91], v[176:179], v[52:55], a[88:91]
v_max3_f32 v2, v2, v121, v122
v_max_f32 v2, v2, v123
ds_read_b128 v[136:139], v211 offset:32768
v_mfma_f32_16x16x32_bf16 a[104:107], v[180:183], v[52:55], a[104:107]
v_cmp_lt_f32 vcc, s59, v2
s_cbranch_vccnz L_r1_21
L_b1_22:
buffer_load_dwordx4 v15, s[8:11], s86 offen offset:1024 lds
v_mfma_f32_16x16x32_bf16 a[120:123], v[184:187], v[52:55], a[120:123]
v_mfma_f32_16x16x32_bf16 a[12:15], v[156:159], v[56:59], a[12:15]
v_exp_f32 v92, v92
ds_read_b128 v[152:155], v211 offset:36864
v_mfma_f32_16x16x32_bf16 a[28:31], v[160:163], v[56:59], a[28:31]
v_exp_f32 v93, v93
v_mfma_f32_16x16x32_bf16 a[44:47], v[164:167], v[56:59], a[44:47]
v_exp_f32 v94, v94
buffer_load_dwordx4 v16, s[8:11], s86 offen offset:2048 lds
v_mfma_f32_16x16x32_bf16 a[60:63], v[168:171], v[56:59], a[60:63]
v_exp_f32 v95, v95
v_mfma_f32_16x16x32_bf16 a[76:79], v[172:175], v[56:59], a[76:79]
v_exp_f32 v108, v108
v_mfma_f32_16x16x32_bf16 a[92:95], v[176:179], v[56:59], a[92:95]
v_exp_f32 v109, v109
v_mfma_f32_16x16x32_bf16 a[108:111], v[180:183], v[56:59], a[108:111]
v_exp_f32 v110, v110
buffer_load_dwordx4 v17, s[8:11], s86 offen offset:3072 lds
v_mfma_f32_16x16x32_bf16 a[124:127], v[184:187], v[56:59], a[124:127]
v_exp_f32 v111, v111
s_waitcnt lgkmcnt(0)
v_mfma_f32_16x16x32_bf16 v[60:63], v[124:127], a[128:131], v[232:235]
ds_read_b64_tr_b16 v[156:157], v216 offset:32768
v_exp_f32 v96, v96
v_mfma_f32_16x16x32_bf16 v[64:67], v[124:127], a[144:147], v[236:239]
v_exp_f32 v97, v97
v_mfma_f32_16x16x32_bf16 v[68:71], v[124:127], a[160:163], v[240:243]
ds_read_b64_tr_b16 v[158:159], v216 offset:36864
v_pk_add_f32 v[248:249], v[248:249], v[92:93]
v_mfma_f32_16x16x32_bf16 v[72:75], v[124:127], a[176:179], v[244:247]
v_cvt_pk_bf16_f32 v44, v92, v93
v_exp_f32 v98, v98
v_mfma_f32_16x16x32_bf16 v[76:79], v[140:143], a[128:131], v[232:235]
ds_read_b64_tr_b16 v[160:161], v217 offset:32768
s_cmp_lg_u32 s82, 0
s_cbranch_scc1 L_r2_23
L_b2_24:
v_exp_f32 v99, v99
v_mfma_f32_16x16x32_bf16 v[80:83], v[140:143], a[144:147], v[236:239]
v_pk_add_f32 v[248:249], v[248:249], v[94:95]
v_mfma_f32_16x16x32_bf16 v[84:87], v[140:143], a[160:163], v[240:243]
ds_read_b64_tr_b16 v[162:163], v217 offset:36864
v_cvt_pk_bf16_f32 v45, v94, v95
v_mfma_f32_16x16x32_bf16 v[88:91], v[140:143], a[176:179], v[244:247]
v_exp_f32 v112, v112
v_mfma_f32_16x16x32_bf16 v[60:63], v[128:131], a[132:135], v[60:63]
ds_read_b64_tr_b16 v[164:165], v218 offset:32768
v_exp_f32 v113, v113
v_mfma_f32_16x16x32_bf16 v[64:67], v[128:131], a[148:151], v[64:67]
v_pk_add_f32 v[248:249], v[248:249], v[108:109]
v_cvt_pk_bf16_f32 v46, v108, v109
v_mfma_f32_16x16x32_bf16 v[68:71], v[128:131], a[164:167], v[68:71]
ds_read_b64_tr_b16 v[166:167], v218 offset:36864
v_exp_f32 v114, v114
v_mfma_f32_16x16x32_bf16 v[72:75], v[128:131], a[180:183], v[72:75]
v_exp_f32 v115, v115
v_mfma_f32_16x16x32_bf16 v[76:79], v[144:147], a[132:135], v[76:79]
ds_read_b64_tr_b16 v[168:169], v219 offset:32768
v_pk_add_f32 v[248:249], v[248:249], v[110:111]
v_mfma_f32_16x16x32_bf16 v[80:83], v[144:147], a[148:151], v[80:83]
v_cvt_pk_bf16_f32 v47, v110, v111
v_exp_f32 v100, v100
v_mfma_f32_16x16x32_bf16 v[84:87], v[144:147], a[164:167], v[84:87]
ds_read_b64_tr_b16 v[170:171], v219 offset:36864
v_exp_f32 v101, v101
v_mfma_f32_16x16x32_bf16 v[88:91], v[144:147], a[180:183], v[88:91]
ds_read_b64_tr_b16 v[172:173], v220 offset:32768
v_pk_add_f32 v[250:251], v[250:251], v[96:97]
v_mfma_f32_16x16x32_bf16 v[60:63], v[132:135], a[136:139], v[60:63]
v_cvt_pk_bf16_f32 v48, v96, v97
v_mfma_f32_16x16x32_bf16 v[64:67], v[132:135], a[152:155], v[64:67]
ds_read_b64_tr_b16 v[174:175], v220 offset:36864
v_exp_f32 v102, v102
v_mfma_f32_16x16x32_bf16 v[68:71], v[132:135], a[168:171], v[68:71]
v_exp_f32 v103, v103
v_mfma_f32_16x16x32_bf16 v[72:75], v[132:135], a[184:187], v[72:75]
ds_read_b64_tr_b16 v[176:177], v221 offset:32768
v_pk_add_f32 v[250:251], v[250:251], v[98:99]
v_cvt_pk_bf16_f32 v49, v98, v99
v_mfma_f32_16x16x32_bf16 v[76:79], v[148:151], a[136:139], v[76:79]
v_exp_f32 v116, v116
v_mfma_f32_16x16x32_bf16 v[80:83], v[148:151], a[152:155], v[80:83]
ds_read_b64_tr_b16 v[178:179], v221 offset:36864
v_exp_f32 v117, v117
v_mfma_f32_16x16x32_bf16 v[84:87], v[148:151], a[168:171], v[84:87]
v_pk_add_f32 v[250:251], v[250:251], v[112:113]
v_cvt_pk_bf16_f32 v50, v112, v113
v_mfma_f32_16x16x32_bf16 v[88:91], v[148:151], a[184:187], v[88:91]
ds_read_b64_tr_b16 v[180:181], v222 offset:32768
v_exp_f32 v118, v118
v_mfma_f32_16x16x32_bf16 v[60:63], v[136:139], a[140:143], v[60:63]
v_exp_f32 v119, v119
v_mfma_f32_16x16x32_bf16 v[64:67], v[136:139], a[156:159], v[64:67]
ds_read_b64_tr_b16 v[182:183], v222 offset:36864
v_pk_add_f32 v[250:251], v[250:251], v[114:115]
v_mfma_f32_16x16x32_bf16 v[68:71], v[136:139], a[172:175], v[68:71]
v_cvt_pk_bf16_f32 v51, v114, v115
v_mfma_f32_16x16x32_bf16 v[72:75], v[136:139], a[188:191], v[72:75]
ds_read_b64_tr_b16 v[184:185], v223 offset:32768
v_exp_f32 v104, v104
v_mfma_f32_16x16x32_bf16 v[76:79], v[152:155], a[140:143], v[76:79]
v_exp_f32 v105, v105
v_mfma_f32_16x16x32_bf16 v[80:83], v[152:155], a[156:159], v[80:83]
s_waitcnt lgkmcnt(11)
ds_read_b64_tr_b16 v[186:187], v223 offset:36864
v_pk_add_f32 v[252:253], v[252:253], v[100:101]
v_cvt_pk_bf16_f32 v52, v100, v101
v_mfma_f32_16x16x32_bf16 v[84:87], v[152:155], a[172:175], v[84:87]
v_exp_f32 v106, v106
v_mfma_f32_16x16x32_bf16 v[88:91], v[152:155], a[188:191], v[88:91]
v_exp_f32 v107, v107
v_mfma_f32_16x16x32_bf16 a[0:3], v[156:159], v[44:47], a[0:3]
v_pk_add_f32 v[252:253], v[252:253], v[102:103]
v_cvt_pk_bf16_f32 v53, v102, v103
v_mfma_f32_16x16x32_bf16 a[16:19], v[160:163], v[44:47], a[16:19]
v_exp_f32 v120, v120
s_waitcnt lgkmcnt(10)
v_mfma_f32_16x16x32_bf16 a[32:35], v[164:167], v[44:47], a[32:35]
v_exp_f32 v121, v121
s_waitcnt vmcnt(8) lgkmcnt(0)
s_barrier
v_mfma_f32_16x16x32_bf16 a[48:51], v[168:171], v[44:47], a[48:51]
v_pk_add_f32 v[252:253], v[252:253], v[116:117]
v_mfma_f32_16x16x32_bf16 a[64:67], v[172:175], v[44:47], a[64:67]
v_cvt_pk_bf16_f32 v54, v116, v117
ds_read_b128 v[124:127], v212 offset:0
s_add_u32 m0, s52, 32768
s_add_u32 s86, s55, 65536
buffer_load_dwordx4 v14, s[8:11], s55 offen offset:0 lds
v_mfma_f32_16x16x32_bf16 a[80:83], v[176:179], v[44:47], a[80:83]
v_exp_f32 v122, v122
v_mfma_f32_16x16x32_bf16 a[96:99], v[180:183], v[44:47], a[96:99]
v_exp_f32 v123, v123
v_mfma_f32_16x16x32_bf16 a[112:115], v[184:187], v[44:47], a[112:115]
v_pk_add_f32 v[252:253], v[252:253], v[118:119]
v_cvt_pk_bf16_f32 v55, v118, v119
ds_read_b128 v[140:143], v212 offset:4096
v_mfma_f32_16x16x32_bf16 a[4:7], v[156:159], v[48:51], a[4:7]
v_pk_add_f32 v[254:255], v[254:255], v[104:105]
v_cvt_pk_bf16_f32 v56, v104, v105
buffer_load_dwordx4 v15, s[8:11], s55 offen offset:1024 lds
v_mfma_f32_16x16x32_bf16 a[20:23], v[160:163], v[48:51], a[20:23]
v_pk_add_f32 v[254:255], v[254:255], v[106:107]
v_mfma_f32_16x16x32_bf16 a[36:39], v[164:167], v[48:51], a[36:39]
v_cvt_pk_bf16_f32 v57, v106, v107
v_pk_add_f32 v[254:255], v[254:255], v[120:121]
ds_read_b128 v[128:131], v213 offset:0
v_mfma_f32_16x16x32_bf16 a[52:55], v[168:171], v[48:51], a[52:55]
v_cvt_pk_bf16_f32 v58, v120, v121
v_pk_add_f32 v[254:255], v[254:255], v[122:123]
v_mfma_f32_16x16x32_bf16 a[68:71], v[172:175], v[48:51], a[68:71]
v_cvt_pk_bf16_f32 v59, v122, v123
buffer_load_dwordx4 v16, s[8:11], s55 offen offset:2048 lds
v_mfma_f32_16x16x32_bf16 a[84:87], v[176:179], v[48:51], a[84:87]
v_max3_f32 v2, v60, v61, v62
v_max3_f32 v2, v2, v63, v64
ds_read_b128 v[144:147], v213 offset:4096
v_mfma_f32_16x16x32_bf16 a[100:103], v[180:183], v[48:51], a[100:103]
v_max3_f32 v2, v2, v65, v66
v_max3_f32 v2, v2, v67, v68
v_mfma_f32_16x16x32_bf16 a[116:119], v[184:187], v[48:51], a[116:119]
v_max3_f32 v2, v2, v69, v70
ds_read_b128 v[132:135], v214 offset:0
buffer_load_dwordx4 v17, s[8:11], s55 offen offset:3072 lds
s_lshr_b64 s[96:97], s[96:97], 4
s_and_b32 s55, s96, 15
s_lshl_b32 s55, s55, 17
v_mfma_f32_16x16x32_bf16 a[8:11], v[156:159], v[52:55], a[8:11]
v_max3_f32 v2, v2, v71, v72
v_max3_f32 v2, v2, v73, v74
v_mfma_f32_16x16x32_bf16 a[24:27], v[160:163], v[52:55], a[24:27]
v_max3_f32 v2, v2, v75, v76
v_max3_f32 v2, v2, v77, v78
v_mfma_f32_16x16x32_bf16 a[40:43], v[164:167], v[52:55], a[40:43]
v_max3_f32 v2, v2, v79, v80
v_max3_f32 v2, v2, v81, v82
ds_read_b128 v[148:151], v214 offset:4096
v_mfma_f32_16x16x32_bf16 a[56:59], v[168:171], v[52:55], a[56:59]
v_max3_f32 v2, v2, v83, v84
s_add_u32 m0, s52, 36864
s_nop 0
buffer_load_dwordx4 v14, s[8:11], s86 offen offset:0 lds
v_mfma_f32_16x16x32_bf16 a[72:75], v[172:175], v[52:55], a[72:75]
v_max3_f32 v2, v2, v85, v86
v_max3_f32 v2, v2, v87, v88
v_mfma_f32_16x16x32_bf16 a[88:91], v[176:179], v[52:55], a[88:91]
v_max3_f32 v2, v2, v89, v90
v_max_f32 v2, v2, v91
ds_read_b128 v[136:139], v215 offset:0
v_mfma_f32_16x16x32_bf16 a[104:107], v[180:183], v[52:55], a[104:107]
v_cmp_lt_f32 vcc, s59, v2
s_cbranch_vccnz L_r1_25
L_b1_26:
buffer_load_dwordx4 v15, s[8:11], s86 offen offset:1024 lds
v_mfma_f32_16x16x32_bf16 a[120:123], v[184:187], v[52:55], a[120:123]
v_mfma_f32_16x16x32_bf16 a[12:15], v[156:159], v[56:59], a[12:15]
v_exp_f32 v60, v60
ds_read_b128 v[152:155], v215 offset:4096
v_mfma_f32_16x16x32_bf16 a[28:31], v[160:163], v[56:59], a[28:31]
v_exp_f32 v61, v61
v_mfma_f32_16x16x32_bf16 a[44:47], v[164:167], v[56:59], a[44:47]
v_exp_f32 v62, v62
buffer_load_dwordx4 v16, s[8:11], s86 offen offset:2048 lds
v_mfma_f32_16x16x32_bf16 a[60:63], v[168:171], v[56:59], a[60:63]
v_exp_f32 v63, v63
v_mfma_f32_16x16x32_bf16 a[76:79], v[172:175], v[56:59], a[76:79]
v_exp_f32 v76, v76
v_mfma_f32_16x16x32_bf16 a[92:95], v[176:179], v[56:59], a[92:95]
v_exp_f32 v77, v77
v_mfma_f32_16x16x32_bf16 a[108:111], v[180:183], v[56:59], a[108:111]
v_exp_f32 v78, v78
buffer_load_dwordx4 v17, s[8:11], s86 offen offset:3072 lds
v_mfma_f32_16x16x32_bf16 a[124:127], v[184:187], v[56:59], a[124:127]
v_exp_f32 v79, v79
s_waitcnt lgkmcnt(0)
v_mfma_f32_16x16x32_bf16 v[92:95], v[124:127], a[128:131], v[232:235]
ds_read_b64_tr_b16 v[156:157], v224 offset:0
v_exp_f32 v64, v64
v_mfma_f32_16x16x32_bf16 v[96:99], v[124:127], a[144:147], v[236:239]
v_exp_f32 v65, v65
v_mfma_f32_16x16x32_bf16 v[100:103], v[124:127], a[160:163], v[240:243]
ds_read_b64_tr_b16 v[158:159], v224 offset:4096
v_pk_add_f32 v[248:249], v[248:249], v[60:61]
v_mfma_f32_16x16x32_bf16 v[104:107], v[124:127], a[176:179], v[244:247]
v_cvt_pk_bf16_f32 v44, v60, v61
v_exp_f32 v66, v66
v_mfma_f32_16x16x32_bf16 v[108:111], v[140:143], a[128:131], v[232:235]
ds_read_b64_tr_b16 v[160:161], v225 offset:0
s_cmp_lg_u32 s82, 0
s_cbranch_scc1 L_r2_27
L_b2_28:
v_exp_f32 v67, v67
v_mfma_f32_16x16x32_bf16 v[112:115], v[140:143], a[144:147], v[236:239]
v_pk_add_f32 v[248:249], v[248:249], v[62:63]
v_mfma_f32_16x16x32_bf16 v[116:119], v[140:143], a[160:163], v[240:243]
ds_read_b64_tr_b16 v[162:163], v225 offset:4096
v_cvt_pk_bf16_f32 v45, v62, v63
v_mfma_f32_16x16x32_bf16 v[120:123], v[140:143], a[176:179], v[244:247]
v_exp_f32 v80, v80
v_mfma_f32_16x16x32_bf16 v[92:95], v[128:131], a[132:135], v[92:95]
ds_read_b64_tr_b16 v[164:165], v226 offset:0
v_exp_f32 v81, v81
v_mfma_f32_16x16x32_bf16 v[96:99], v[128:131], a[148:151], v[96:99]
v_pk_add_f32 v[248:249], v[248:249], v[76:77]
v_cvt_pk_bf16_f32 v46, v76, v77
v_mfma_f32_16x16x32_bf16 v[100:103], v[128:131], a[164:167], v[100:103]
ds_read_b64_tr_b16 v[166:167], v226 offset:4096
v_exp_f32 v82, v82
v_mfma_f32_16x16x32_bf16 v[104:107], v[128:131], a[180:183], v[104:107]
v_exp_f32 v83, v83
v_mfma_f32_16x16x32_bf16 v[108:111], v[144:147], a[132:135], v[108:111]
ds_read_b64_tr_b16 v[168:169], v227 offset:0
v_pk_add_f32 v[248:249], v[248:249], v[78:79]
v_mfma_f32_16x16x32_bf16 v[112:115], v[144:147], a[148:151], v[112:115]
v_cvt_pk_bf16_f32 v47, v78, v79
v_exp_f32 v68, v68
v_mfma_f32_16x16x32_bf16 v[116:119], v[144:147], a[164:167], v[116:119]
ds_read_b64_tr_b16 v[170:171], v227 offset:4096
v_exp_f32 v69, v69
v_mfma_f32_16x16x32_bf16 v[120:123], v[144:147], a[180:183], v[120:123]
ds_read_b64_tr_b16 v[172:173], v228 offset:0
v_pk_add_f32 v[250:251], v[250:251], v[64:65]
v_mfma_f32_16x16x32_bf16 v[92:95], v[132:135], a[136:139], v[92:95]
v_cvt_pk_bf16_f32 v48, v64, v65
v_mfma_f32_16x16x32_bf16 v[96:99], v[132:135], a[152:155], v[96:99]
ds_read_b64_tr_b16 v[174:175], v228 offset:4096
v_exp_f32 v70, v70
v_mfma_f32_16x16x32_bf16 v[100:103], v[132:135], a[168:171], v[100:103]
v_exp_f32 v71, v71
v_mfma_f32_16x16x32_bf16 v[104:107], v[132:135], a[184:187], v[104:107]
ds_read_b64_tr_b16 v[176:177], v229 offset:0
v_pk_add_f32 v[250:251], v[250:251], v[66:67]
v_cvt_pk_bf16_f32 v49, v66, v67
v_mfma_f32_16x16x32_bf16 v[108:111], v[148:151], a[136:139], v[108:111]
v_exp_f32 v84, v84
v_mfma_f32_16x16x32_bf16 v[112:115], v[148:151], a[152:155], v[112:115]
ds_read_b64_tr_b16 v[178:179], v229 offset:4096
v_exp_f32 v85, v85
v_mfma_f32_16x16x32_bf16 v[116:119], v[148:151], a[168:171], v[116:119]
v_pk_add_f32 v[250:251], v[250:251], v[80:81]
v_cvt_pk_bf16_f32 v50, v80, v81
v_mfma_f32_16x16x32_bf16 v[120:123], v[148:151], a[184:187], v[120:123]
ds_read_b64_tr_b16 v[180:181], v230 offset:0
v_exp_f32 v86, v86
v_mfma_f32_16x16x32_bf16 v[92:95], v[136:139], a[140:143], v[92:95]
v_exp_f32 v87, v87
v_mfma_f32_16x16x32_bf16 v[96:99], v[136:139], a[156:159], v[96:99]
ds_read_b64_tr_b16 v[182:183], v230 offset:4096
v_pk_add_f32 v[250:251], v[250:251], v[82:83]
v_mfma_f32_16x16x32_bf16 v[100:103], v[136:139], a[172:175], v[100:103]
v_cvt_pk_bf16_f32 v51, v82, v83
v_mfma_f32_16x16x32_bf16 v[104:107], v[136:139], a[188:191], v[104:107]
ds_read_b64_tr_b16 v[184:185], v231 offset:0
v_exp_f32 v72, v72
v_mfma_f32_16x16x32_bf16 v[108:111], v[152:155], a[140:143], v[108:111]
v_exp_f32 v73, v73
v_mfma_f32_16x16x32_bf16 v[112:115], v[152:155], a[156:159], v[112:115]
s_waitcnt lgkmcnt(11)
ds_read_b64_tr_b16 v[186:187], v231 offset:4096
v_pk_add_f32 v[252:253], v[252:253], v[68:69]
v_cvt_pk_bf16_f32 v52, v68, v69
v_mfma_f32_16x16x32_bf16 v[116:119], v[152:155], a[172:175], v[116:119]
v_exp_f32 v74, v74
v_mfma_f32_16x16x32_bf16 v[120:123], v[152:155], a[188:191], v[120:123]
v_exp_f32 v75, v75
v_mfma_f32_16x16x32_bf16 a[0:3], v[156:159], v[44:47], a[0:3]
v_pk_add_f32 v[252:253], v[252:253], v[70:71]
v_cvt_pk_bf16_f32 v53, v70, v71
v_mfma_f32_16x16x32_bf16 a[16:19], v[160:163], v[44:47], a[16:19]
v_exp_f32 v88, v88
s_waitcnt lgkmcnt(10)
v_mfma_f32_16x16x32_bf16 a[32:35], v[164:167], v[44:47], a[32:35]
v_exp_f32 v89, v89
s_waitcnt vmcnt(63) lgkmcnt(0)
s_barrier
v_mfma_f32_16x16x32_bf16 a[48:51], v[168:171], v[44:47], a[48:51]
v_pk_add_f32 v[252:253], v[252:253], v[84:85]
v_mfma_f32_16x16x32_bf16 a[64:67], v[172:175], v[44:47], a[64:67]
v_cvt_pk_bf16_f32 v54, v84, v85
v_mfma_f32_16x16x32_bf16 a[80:83], v[176:179], v[44:47], a[80:83]
v_exp_f32 v90, v90
v_mfma_f32_16x16x32_bf16 a[96:99], v[180:183], v[44:47], a[96:99]
v_exp_f32 v91, v91
v_mfma_f32_16x16x32_bf16 a[112:115], v[184:187], v[44:47], a[112:115]
v_pk_add_f32 v[252:253], v[252:253], v[86:87]
v_cvt_pk_bf16_f32 v55, v86, v87
v_mfma_f32_16x16x32_bf16 a[4:7], v[156:159], v[48:51], a[4:7]
v_pk_add_f32 v[254:255], v[254:255], v[72:73]
v_cvt_pk_bf16_f32 v56, v72, v73
v_mfma_f32_16x16x32_bf16 a[20:23], v[160:163], v[48:51], a[20:23]
v_pk_add_f32 v[254:255], v[254:255], v[74:75]
v_mfma_f32_16x16x32_bf16 a[36:39], v[164:167], v[48:51], a[36:39]
v_cvt_pk_bf16_f32 v57, v74, v75
v_pk_add_f32 v[254:255], v[254:255], v[88:89]
v_mfma_f32_16x16x32_bf16 a[52:55], v[168:171], v[48:51], a[52:55]
v_cvt_pk_bf16_f32 v58, v88, v89
v_pk_add_f32 v[254:255], v[254:255], v[90:91]
v_mfma_f32_16x16x32_bf16 a[68:71], v[172:175], v[48:51], a[68:71]
v_cvt_pk_bf16_f32 v59, v90, v91
v_mfma_f32_16x16x32_bf16 a[84:87], v[176:179], v[48:51], a[84:87]
v_max3_f32 v2, v92, v93, v94
v_max3_f32 v2, v2, v95, v96
v_mfma_f32_16x16x32_bf16 a[100:103], v[180:183], v[48:51], a[100:103]
v_max3_f32 v2, v2, v97, v98
v_max3_f32 v2, v2, v99, v100
v_mfma_f32_16x16x32_bf16 a[116:119], v[184:187], v[48:51], a[116:119]
v_max3_f32 v2, v2, v101, v102
v_mfma_f32_16x16x32_bf16 a[8:11], v[156:159], v[52:55], a[8:11]
v_max3_f32 v2, v2, v103, v104
v_max3_f32 v2, v2, v105, v106
v_mfma_f32_16x16x32_bf16 a[24:27], v[160:163], v[52:55], a[24:27]
v_max3_f32 v2, v2, v107, v108
v_max3_f32 v2, v2, v109, v110
v_mfma_f32_16x16x32_bf16 a[40:43], v[164:167], v[52:55], a[40:43]
v_max3_f32 v2, v2, v111, v112
v_max3_f32 v2, v2, v113, v114
v_mfma_f32_16x16x32_bf16 a[56:59], v[168:171], v[52:55], a[56:59]
v_max3_f32 v2, v2, v115, v116
v_mfma_f32_16x16x32_bf16 a[72:75], v[172:175], v[52:55], a[72:75]
v_max3_f32 v2, v2, v117, v118
v_max3_f32 v2, v2, v119, v120
v_mfma_f32_16x16x32_bf16 a[88:91], v[176:179], v[52:55], a[88:91]
v_max3_f32 v2, v2, v121, v122
v_max_f32 v2, v2, v123
v_mfma_f32_16x16x32_bf16 a[104:107], v[180:183], v[52:55], a[104:107]
v_cmp_lt_f32 vcc, s59, v2
s_cbranch_vccnz L_r1_29
L_b1_30:
v_mfma_f32_16x16x32_bf16 a[120:123], v[184:187], v[52:55], a[120:123]
v_mfma_f32_16x16x32_bf16 a[12:15], v[156:159], v[56:59], a[12:15]
v_exp_f32 v92, v92
v_mfma_f32_16x16x32_bf16 a[28:31], v[160:163], v[56:59], a[28:31]
v_exp_f32 v93, v93
v_mfma_f32_16x16x32_bf16 a[44:47], v[164:167], v[56:59], a[44:47]
v_exp_f32 v94, v94
v_mfma_f32_16x16x32_bf16 a[60:63], v[168:171], v[56:59], a[60:63]
v_exp_f32 v95, v95
v_mfma_f32_16x16x32_bf16 a[76:79], v[172:175], v[56:59], a[76:79]
v_exp_f32 v108, v108
v_mfma_f32_16x16x32_bf16 a[92:95], v[176:179], v[56:59], a[92:95]
v_exp_f32 v109, v109
v_mfma_f32_16x16x32_bf16 a[108:111], v[180:183], v[56:59], a[108:111]
v_exp_f32 v110, v110
v_mfma_f32_16x16x32_bf16 a[124:127], v[184:187], v[56:59], a[124:127]
v_exp_f32 v111, v111
ds_read_b64_tr_b16 v[156:157], v224 offset:32768
ds_read_b64_tr_b16 v[158:159], v224 offset:36864
ds_read_b64_tr_b16 v[160:161], v225 offset:32768
ds_read_b64_tr_b16 v[162:163], v225 offset:36864
ds_read_b64_tr_b16 v[164:165], v226 offset:32768
ds_read_b64_tr_b16 v[166:167], v226 offset:36864
ds_read_b64_tr_b16 v[168:169], v227 offset:32768
ds_read_b64_tr_b16 v[170:171], v227 offset:36864
ds_read_b64_tr_b16 v[172:173], v228 offset:32768
ds_read_b64_tr_b16 v[174:175], v228 offset:36864
ds_read_b64_tr_b16 v[176:177], v229 offset:32768
ds_read_b64_tr_b16 v[178:179], v229 offset:36864
ds_read_b64_tr_b16 v[180:181], v230 offset:32768
ds_read_b64_tr_b16 v[182:183], v230 offset:36864
ds_read_b64_tr_b16 v[184:185], v231 offset:32768
s_waitcnt lgkmcnt(11)
ds_read_b64_tr_b16 v[186:187], v231 offset:36864
s_cmp_lg_u32 s82, 0
s_cbranch_scc1 L_r2_31
L_b2_32:
v_exp_f32 v96, v96
v_exp_f32 v97, v97
v_pk_add_f32 v[248:249], v[248:249], v[92:93]
v_cvt_pk_bf16_f32 v44, v92, v93
v_exp_f32 v98, v98
v_exp_f32 v99, v99
v_pk_add_f32 v[248:249], v[248:249], v[94:95]
v_cvt_pk_bf16_f32 v45, v94, v95
v_exp_f32 v112, v112
v_exp_f32 v113, v113
v_pk_add_f32 v[248:249], v[248:249], v[108:109]
v_cvt_pk_bf16_f32 v46, v108, v109
v_exp_f32 v114, v114
v_exp_f32 v115, v115
v_pk_add_f32 v[248:249], v[248:249], v[110:111]
v_cvt_pk_bf16_f32 v47, v110, v111
s_nop 1
v_mfma_f32_16x16x32_bf16 a[0:3], v[156:159], v[44:47], a[0:3]
v_exp_f32 v100, v100
v_exp_f32 v101, v101
v_pk_add_f32 v[250:251], v[250:251], v[96:97]
v_cvt_pk_bf16_f32 v48, v96, v97
v_mfma_f32_16x16x32_bf16 a[16:19], v[160:163], v[44:47], a[16:19]
v_exp_f32 v102, v102
v_exp_f32 v103, v103
v_pk_add_f32 v[250:251], v[250:251], v[98:99]
v_cvt_pk_bf16_f32 v49, v98, v99
v_exp_f32 v116, v116
s_waitcnt lgkmcnt(10)
v_mfma_f32_16x16x32_bf16 a[32:35], v[164:167], v[44:47], a[32:35]
v_exp_f32 v117, v117
v_pk_add_f32 v[250:251], v[250:251], v[112:113]
v_cvt_pk_bf16_f32 v50, v112, v113
v_exp_f32 v118, v118
s_waitcnt lgkmcnt(8)
v_mfma_f32_16x16x32_bf16 a[48:51], v[168:171], v[44:47], a[48:51]
v_exp_f32 v119, v119
v_pk_add_f32 v[250:251], v[250:251], v[114:115]
v_cvt_pk_bf16_f32 v51, v114, v115
v_add_f32 v248, v248, v249
s_waitcnt lgkmcnt(6)
v_mfma_f32_16x16x32_bf16 a[64:67], v[172:175], v[44:47], a[64:67]
v_mov_b32 v249, v248
s_nop 1
v_permlane16_swap_b32 v248, v249
s_nop 1
s_waitcnt lgkmcnt(4)
v_mfma_f32_16x16x32_bf16 a[80:83], v[176:179], v[44:47], a[80:83]
v_add_f32 v248, v248, v249
v_mov_b32 v249, v248
s_nop 1
v_permlane32_swap_b32 v248, v249
s_nop 1
s_waitcnt lgkmcnt(2)
v_mfma_f32_16x16x32_bf16 a[96:99], v[180:183], v[44:47], a[96:99]
v_add_f32 v248, v248, v249
v_rcp_f32 v248, v248
s_nop 0
v_mov_b32 v249, v248
s_waitcnt lgkmcnt(0)
v_mfma_f32_16x16x32_bf16 a[112:115], v[184:187], v[44:47], a[112:115]
s_nop 1
s_barrier
v_mfma_f32_16x16x32_bf16 a[4:7], v[156:159], v[48:51], a[4:7]
v_exp_f32 v104, v104
v_exp_f32 v105, v105
v_pk_add_f32 v[252:253], v[252:253], v[100:101]
v_cvt_pk_bf16_f32 v52, v100, v101
v_mfma_f32_16x16x32_bf16 a[20:23], v[160:163], v[48:51], a[20:23]
v_exp_f32 v106, v106
v_exp_f32 v107, v107
v_pk_add_f32 v[252:253], v[252:253], v[102:103]
v_cvt_pk_bf16_f32 v53, v102, v103
v_exp_f32 v120, v120
v_mfma_f32_16x16x32_bf16 a[36:39], v[164:167], v[48:51], a[36:39]
v_exp_f32 v121, v121
v_pk_add_f32 v[252:253], v[252:253], v[116:117]
v_cvt_pk_bf16_f32 v54, v116, v117
v_exp_f32 v122, v122
v_mfma_f32_16x16x32_bf16 a[52:55], v[168:171], v[48:51], a[52:55]
v_exp_f32 v123, v123
v_pk_add_f32 v[252:253], v[252:253], v[118:119]
v_cvt_pk_bf16_f32 v55, v118, v119
v_add_f32 v250, v250, v251
v_mfma_f32_16x16x32_bf16 a[68:71], v[172:175], v[48:51], a[68:71]
v_mov_b32 v251, v250
s_nop 1
v_permlane16_swap_b32 v250, v251
s_nop 1
v_mfma_f32_16x16x32_bf16 a[84:87], v[176:179], v[48:51], a[84:87]
v_add_f32 v250, v250, v251
v_mov_b32 v251, v250
s_nop 1
v_permlane32_swap_b32 v250, v251
s_nop 1
v_mfma_f32_16x16x32_bf16 a[100:103], v[180:183], v[48:51], a[100:103]
v_add_f32 v250, v250, v251
v_rcp_f32 v250, v250
s_nop 0
v_mov_b32 v251, v250
v_mfma_f32_16x16x32_bf16 a[116:119], v[184:187], v[48:51], a[116:119]
s_nop 1
v_mfma_f32_16x16x32_bf16 a[8:11], v[156:159], v[52:55], a[8:11]
v_pk_add_f32 v[254:255], v[254:255], v[104:105]
v_cvt_pk_bf16_f32 v56, v104, v105
v_pk_add_f32 v[254:255], v[254:255], v[106:107]
v_mfma_f32_16x16x32_bf16 a[24:27], v[160:163], v[52:55], a[24:27]
v_cvt_pk_bf16_f32 v57, v106, v107
v_pk_add_f32 v[254:255], v[254:255], v[120:121]
v_cvt_pk_bf16_f32 v58, v120, v121
v_mfma_f32_16x16x32_bf16 a[40:43], v[164:167], v[52:55], a[40:43]
v_pk_add_f32 v[254:255], v[254:255], v[122:123]
v_cvt_pk_bf16_f32 v59, v122, v123
v_add_f32 v252, v252, v253
v_mfma_f32_16x16x32_bf16 a[56:59], v[168:171], v[52:55], a[56:59]
v_mov_b32 v253, v252
s_nop 1
v_permlane16_swap_b32 v252, v253
s_nop 1
v_mfma_f32_16x16x32_bf16 a[72:75], v[172:175], v[52:55], a[72:75]
v_add_f32 v252, v252, v253
v_mov_b32 v253, v252
s_nop 1
v_mfma_f32_16x16x32_bf16 a[88:91], v[176:179], v[52:55], a[88:91]
v_permlane32_swap_b32 v252, v253
s_nop 1
v_add_f32 v252, v252, v253
v_mfma_f32_16x16x32_bf16 a[104:107], v[180:183], v[52:55], a[104:107]
v_rcp_f32 v252, v252
s_nop 0
v_mov_b32 v253, v252
v_mfma_f32_16x16x32_bf16 a[120:123], v[184:187], v[52:55], a[120:123]
s_nop 1
v_mfma_f32_16x16x32_bf16 a[12:15], v[156:159], v[56:59], a[12:15]
v_add_f32 v254, v254, v255
v_mov_b32 v255, v254
v_mfma_f32_16x16x32_bf16 a[28:31], v[160:163], v[56:59], a[28:31]
s_nop 1
v_permlane16_swap_b32 v254, v255
v_mfma_f32_16x16x32_bf16 a[44:47], v[164:167], v[56:59], a[44:47]
s_nop 1
v_add_f32 v254, v254, v255
v_mfma_f32_16x16x32_bf16 a[60:63], v[168:171], v[56:59], a[60:63]
v_mov_b32 v255, v254
s_nop 1
v_mfma_f32_16x16x32_bf16 a[76:79], v[172:175], v[56:59], a[76:79]
v_permlane32_swap_b32 v254, v255
s_nop 1
v_mfma_f32_16x16x32_bf16 a[92:95], v[176:179], v[56:59], a[92:95]
v_add_f32 v254, v254, v255
v_rcp_f32 v254, v254
v_mfma_f32_16x16x32_bf16 a[108:111], v[180:183], v[56:59], a[108:111]
s_nop 0
v_mov_b32 v255, v254
v_mfma_f32_16x16x32_bf16 a[124:127], v[184:187], v[56:59], a[124:127]
s_nop 1
s_nop 3
v_accvgpr_read_b32 v60, a0
v_accvgpr_read_b32 v61, a1
v_accvgpr_read_b32 v62, a2
v_accvgpr_read_b32 v63, a3
v_accvgpr_read_b32 v64, a16
v_accvgpr_read_b32 v65, a17
v_accvgpr_read_b32 v66, a18
v_accvgpr_read_b32 v67, a19
v_pk_mul_f32 v[60:61], v[60:61], v[248:249]
v_pk_mul_f32 v[62:63], v[62:63], v[248:249]
v_pk_mul_f32 v[64:65], v[64:65], v[248:249]
v_pk_mul_f32 v[66:67], v[66:67], v[248:249]
v_cvt_pk_bf16_f32 v124, v60, v61
v_cvt_pk_bf16_f32 v125, v62, v63
v_cvt_pk_bf16_f32 v126, v64, v65
v_cvt_pk_bf16_f32 v127, v66, v67
ds_write_b128 v37, v[124:127] offset:0
buffer_store_dwordx4 v[124:127], v36, s[24:27], s89 offen offset:0 sc1
v_accvgpr_read_b32 v68, a32
v_accvgpr_read_b32 v69, a33
v_accvgpr_read_b32 v70, a34
v_accvgpr_read_b32 v71, a35
v_accvgpr_read_b32 v72, a48
v_accvgpr_read_b32 v73, a49
v_accvgpr_read_b32 v74, a50
v_accvgpr_read_b32 v75, a51
v_pk_mul_f32 v[68:69], v[68:69], v[248:249]
v_pk_mul_f32 v[70:71], v[70:71], v[248:249]
v_pk_mul_f32 v[72:73], v[72:73], v[248:249]
v_pk_mul_f32 v[74:75], v[74:75], v[248:249]
v_cvt_pk_bf16_f32 v128, v68, v69
v_cvt_pk_bf16_f32 v129, v70, v71
v_cvt_pk_bf16_f32 v130, v72, v73
v_cvt_pk_bf16_f32 v131, v74, v75
ds_write_b128 v37, v[128:131] offset:1024
buffer_store_dwordx4 v[128:131], v36, s[24:27], s89 offen offset:1024 sc1
v_accvgpr_read_b32 v76, a64
v_accvgpr_read_b32 v77, a65
v_accvgpr_read_b32 v78, a66
v_accvgpr_read_b32 v79, a67
v_accvgpr_read_b32 v80, a80
v_accvgpr_read_b32 v81, a81
v_accvgpr_read_b32 v82, a82
v_accvgpr_read_b32 v83, a83
v_pk_mul_f32 v[76:77], v[76:77], v[248:249]
v_pk_mul_f32 v[78:79], v[78:79], v[248:249]
v_pk_mul_f32 v[80:81], v[80:81], v[248:249]
v_pk_mul_f32 v[82:83], v[82:83], v[248:249]
v_cvt_pk_bf16_f32 v132, v76, v77
v_cvt_pk_bf16_f32 v133, v78, v79
v_cvt_pk_bf16_f32 v134, v80, v81
v_cvt_pk_bf16_f32 v135, v82, v83
ds_write_b128 v37, v[132:135] offset:16384
buffer_store_dwordx4 v[132:135], v36, s[24:27], s89 offen offset:2048 sc1
v_accvgpr_read_b32 v84, a96
v_accvgpr_read_b32 v85, a97
v_accvgpr_read_b32 v86, a98
v_accvgpr_read_b32 v87, a99
v_accvgpr_read_b32 v88, a112
v_accvgpr_read_b32 v89, a113
v_accvgpr_read_b32 v90, a114
v_accvgpr_read_b32 v91, a115
v_pk_mul_f32 v[84:85], v[84:85], v[248:249]
v_pk_mul_f32 v[86:87], v[86:87], v[248:249]
v_pk_mul_f32 v[88:89], v[88:89], v[248:249]
v_pk_mul_f32 v[90:91], v[90:91], v[248:249]
v_cvt_pk_bf16_f32 v136, v84, v85
v_cvt_pk_bf16_f32 v137, v86, v87
v_cvt_pk_bf16_f32 v138, v88, v89
v_cvt_pk_bf16_f32 v139, v90, v91
ds_write_b128 v37, v[136:139] offset:17408
buffer_store_dwordx4 v[136:139], v36, s[24:27], s89 offen offset:3072 sc1
s_add_u32 s89, s89, 0x20000
v_accvgpr_read_b32 v60, a4
v_accvgpr_read_b32 v61, a5
v_accvgpr_read_b32 v62, a6
v_accvgpr_read_b32 v63, a7
v_accvgpr_read_b32 v64, a20
v_accvgpr_read_b32 v65, a21
v_accvgpr_read_b32 v66, a22
v_accvgpr_read_b32 v67, a23
v_pk_mul_f32 v[60:61], v[60:61], v[250:251]
v_pk_mul_f32 v[62:63], v[62:63], v[250:251]
v_pk_mul_f32 v[64:65], v[64:65], v[250:251]
v_pk_mul_f32 v[66:67], v[66:67], v[250:251]
v_cvt_pk_bf16_f32 v140, v60, v61
v_cvt_pk_bf16_f32 v141, v62, v63
v_cvt_pk_bf16_f32 v142, v64, v65
v_cvt_pk_bf16_f32 v143, v66, v67
ds_write_b128 v37, v[140:143] offset:2048
buffer_store_dwordx4 v[140:143], v36, s[24:27], s89 offen offset:0 sc1
v_accvgpr_read_b32 v68, a36
v_accvgpr_read_b32 v69, a37
v_accvgpr_read_b32 v70, a38
v_accvgpr_read_b32 v71, a39
v_accvgpr_read_b32 v72, a52
v_accvgpr_read_b32 v73, a53
v_accvgpr_read_b32 v74, a54
v_accvgpr_read_b32 v75, a55
v_pk_mul_f32 v[68:69], v[68:69], v[250:251]
v_pk_mul_f32 v[70:71], v[70:71], v[250:251]
v_pk_mul_f32 v[72:73], v[72:73], v[250:251]
v_pk_mul_f32 v[74:75], v[74:75], v[250:251]
v_cvt_pk_bf16_f32 v144, v68, v69
v_cvt_pk_bf16_f32 v145, v70, v71
v_cvt_pk_bf16_f32 v146, v72, v73
v_cvt_pk_bf16_f32 v147, v74, v75
ds_write_b128 v37, v[144:147] offset:3072
buffer_store_dwordx4 v[144:147], v36, s[24:27], s89 offen offset:1024 sc1
v_accvgpr_read_b32 v76, a68
v_accvgpr_read_b32 v77, a69
v_accvgpr_read_b32 v78, a70
v_accvgpr_read_b32 v79, a71
v_accvgpr_read_b32 v80, a84
v_accvgpr_read_b32 v81, a85
v_accvgpr_read_b32 v82, a86
v_accvgpr_read_b32 v83, a87
v_pk_mul_f32 v[76:77], v[76:77], v[250:251]
v_pk_mul_f32 v[78:79], v[78:79], v[250:251]
v_pk_mul_f32 v[80:81], v[80:81], v[250:251]
v_pk_mul_f32 v[82:83], v[82:83], v[250:251]
v_cvt_pk_bf16_f32 v148, v76, v77
v_cvt_pk_bf16_f32 v149, v78, v79
v_cvt_pk_bf16_f32 v150, v80, v81
v_cvt_pk_bf16_f32 v151, v82, v83
ds_write_b128 v37, v[148:151] offset:18432
buffer_store_dwordx4 v[148:151], v36, s[24:27], s89 offen offset:2048 sc1
v_accvgpr_read_b32 v84, a100
v_accvgpr_read_b32 v85, a101
v_accvgpr_read_b32 v86, a102
v_accvgpr_read_b32 v87, a103
v_accvgpr_read_b32 v88, a116
v_accvgpr_read_b32 v89, a117
v_accvgpr_read_b32 v90, a118
v_accvgpr_read_b32 v91, a119
v_pk_mul_f32 v[84:85], v[84:85], v[250:251]
v_pk_mul_f32 v[86:87], v[86:87], v[250:251]
v_pk_mul_f32 v[88:89], v[88:89], v[250:251]
v_pk_mul_f32 v[90:91], v[90:91], v[250:251]
v_cvt_pk_bf16_f32 v152, v84, v85
v_cvt_pk_bf16_f32 v153, v86, v87
v_cvt_pk_bf16_f32 v154, v88, v89
v_cvt_pk_bf16_f32 v155, v90, v91
ds_write_b128 v37, v[152:155] offset:19456
buffer_store_dwordx4 v[152:155], v36, s[24:27], s89 offen offset:3072 sc1
s_add_u32 s89, s89, 0x20000
v_accvgpr_read_b32 v60, a8
v_accvgpr_read_b32 v61, a9
v_accvgpr_read_b32 v62, a10
v_accvgpr_read_b32 v63, a11
v_accvgpr_read_b32 v64, a24
v_accvgpr_read_b32 v65, a25
v_accvgpr_read_b32 v66, a26
v_accvgpr_read_b32 v67, a27
v_pk_mul_f32 v[60:61], v[60:61], v[252:253]
v_pk_mul_f32 v[62:63], v[62:63], v[252:253]
v_pk_mul_f32 v[64:65], v[64:65], v[252:253]
v_pk_mul_f32 v[66:67], v[66:67], v[252:253]
v_cvt_pk_bf16_f32 v124, v60, v61
v_cvt_pk_bf16_f32 v125, v62, v63
v_cvt_pk_bf16_f32 v126, v64, v65
v_cvt_pk_bf16_f32 v127, v66, v67
ds_write_b128 v37, v[124:127] offset:4096
buffer_store_dwordx4 v[124:127], v36, s[24:27], s89 offen offset:0 sc1
v_accvgpr_read_b32 v68, a40
v_accvgpr_read_b32 v69, a41
v_accvgpr_read_b32 v70, a42
v_accvgpr_read_b32 v71, a43
v_accvgpr_read_b32 v72, a56
v_accvgpr_read_b32 v73, a57
v_accvgpr_read_b32 v74, a58
v_accvgpr_read_b32 v75, a59
v_pk_mul_f32 v[68:69], v[68:69], v[252:253]
v_pk_mul_f32 v[70:71], v[70:71], v[252:253]
v_pk_mul_f32 v[72:73], v[72:73], v[252:253]
v_pk_mul_f32 v[74:75], v[74:75], v[252:253]
v_cvt_pk_bf16_f32 v128, v68, v69
v_cvt_pk_bf16_f32 v129, v70, v71
v_cvt_pk_bf16_f32 v130, v72, v73
v_cvt_pk_bf16_f32 v131, v74, v75
ds_write_b128 v37, v[128:131] offset:5120
buffer_store_dwordx4 v[128:131], v36, s[24:27], s89 offen offset:1024 sc1
v_accvgpr_read_b32 v76, a72
v_accvgpr_read_b32 v77, a73
v_accvgpr_read_b32 v78, a74
v_accvgpr_read_b32 v79, a75
v_accvgpr_read_b32 v80, a88
v_accvgpr_read_b32 v81, a89
v_accvgpr_read_b32 v82, a90
v_accvgpr_read_b32 v83, a91
v_pk_mul_f32 v[76:77], v[76:77], v[252:253]
v_pk_mul_f32 v[78:79], v[78:79], v[252:253]
v_pk_mul_f32 v[80:81], v[80:81], v[252:253]
v_pk_mul_f32 v[82:83], v[82:83], v[252:253]
v_cvt_pk_bf16_f32 v132, v76, v77
v_cvt_pk_bf16_f32 v133, v78, v79
v_cvt_pk_bf16_f32 v134, v80, v81
v_cvt_pk_bf16_f32 v135, v82, v83
ds_write_b128 v37, v[132:135] offset:20480
buffer_store_dwordx4 v[132:135], v36, s[24:27], s89 offen offset:2048 sc1
v_accvgpr_read_b32 v84, a104
v_accvgpr_read_b32 v85, a105
v_accvgpr_read_b32 v86, a106
v_accvgpr_read_b32 v87, a107
v_accvgpr_read_b32 v88, a120
v_accvgpr_read_b32 v89, a121
v_accvgpr_read_b32 v90, a122
v_accvgpr_read_b32 v91, a123
v_pk_mul_f32 v[84:85], v[84:85], v[252:253]
v_pk_mul_f32 v[86:87], v[86:87], v[252:253]
v_pk_mul_f32 v[88:89], v[88:89], v[252:253]
v_pk_mul_f32 v[90:91], v[90:91], v[252:253]
v_cvt_pk_bf16_f32 v136, v84, v85
v_cvt_pk_bf16_f32 v137, v86, v87
v_cvt_pk_bf16_f32 v138, v88, v89
v_cvt_pk_bf16_f32 v139, v90, v91
ds_write_b128 v37, v[136:139] offset:21504
buffer_store_dwordx4 v[136:139], v36, s[24:27], s89 offen offset:3072 sc1
s_add_u32 s89, s89, 0x20000
v_accvgpr_read_b32 v60, a12
v_accvgpr_read_b32 v61, a13
v_accvgpr_read_b32 v62, a14
v_accvgpr_read_b32 v63, a15
v_accvgpr_read_b32 v64, a28
v_accvgpr_read_b32 v65, a29
v_accvgpr_read_b32 v66, a30
v_accvgpr_read_b32 v67, a31
v_pk_mul_f32 v[60:61], v[60:61], v[254:255]
v_pk_mul_f32 v[62:63], v[62:63], v[254:255]
v_pk_mul_f32 v[64:65], v[64:65], v[254:255]
v_pk_mul_f32 v[66:67], v[66:67], v[254:255]
v_cvt_pk_bf16_f32 v140, v60, v61
v_cvt_pk_bf16_f32 v141, v62, v63
v_cvt_pk_bf16_f32 v142, v64, v65
v_cvt_pk_bf16_f32 v143, v66, v67
ds_write_b128 v37, v[140:143] offset:6144
buffer_store_dwordx4 v[140:143], v36, s[24:27], s89 offen offset:0 sc1
v_accvgpr_read_b32 v68, a44
v_accvgpr_read_b32 v69, a45
v_accvgpr_read_b32 v70, a46
v_accvgpr_read_b32 v71, a47
v_accvgpr_read_b32 v72, a60
v_accvgpr_read_b32 v73, a61
v_accvgpr_read_b32 v74, a62
v_accvgpr_read_b32 v75, a63
v_pk_mul_f32 v[68:69], v[68:69], v[254:255]
v_pk_mul_f32 v[70:71], v[70:71], v[254:255]
v_pk_mul_f32 v[72:73], v[72:73], v[254:255]
v_pk_mul_f32 v[74:75], v[74:75], v[254:255]
v_cvt_pk_bf16_f32 v144, v68, v69
v_cvt_pk_bf16_f32 v145, v70, v71
v_cvt_pk_bf16_f32 v146, v72, v73
v_cvt_pk_bf16_f32 v147, v74, v75
ds_write_b128 v37, v[144:147] offset:7168
buffer_store_dwordx4 v[144:147], v36, s[24:27], s89 offen offset:1024 sc1
v_accvgpr_read_b32 v76, a76
v_accvgpr_read_b32 v77, a77
v_accvgpr_read_b32 v78, a78
v_accvgpr_read_b32 v79, a79
v_accvgpr_read_b32 v80, a92
v_accvgpr_read_b32 v81, a93
v_accvgpr_read_b32 v82, a94
v_accvgpr_read_b32 v83, a95
v_pk_mul_f32 v[76:77], v[76:77], v[254:255]
v_pk_mul_f32 v[78:79], v[78:79], v[254:255]
v_pk_mul_f32 v[80:81], v[80:81], v[254:255]
v_pk_mul_f32 v[82:83], v[82:83], v[254:255]
v_cvt_pk_bf16_f32 v148, v76, v77
v_cvt_pk_bf16_f32 v149, v78, v79
v_cvt_pk_bf16_f32 v150, v80, v81
v_cvt_pk_bf16_f32 v151, v82, v83
ds_write_b128 v37, v[148:151] offset:22528
buffer_store_dwordx4 v[148:151], v36, s[24:27], s89 offen offset:2048 sc1
v_accvgpr_read_b32 v84, a108
v_accvgpr_read_b32 v85, a109
v_accvgpr_read_b32 v86, a110
v_accvgpr_read_b32 v87, a111
v_accvgpr_read_b32 v88, a124
v_accvgpr_read_b32 v89, a125
v_accvgpr_read_b32 v90, a126
v_accvgpr_read_b32 v91, a127
v_pk_mul_f32 v[84:85], v[84:85], v[254:255]
v_pk_mul_f32 v[86:87], v[86:87], v[254:255]
v_pk_mul_f32 v[88:89], v[88:89], v[254:255]
v_pk_mul_f32 v[90:91], v[90:91], v[254:255]
v_cvt_pk_bf16_f32 v152, v84, v85
v_cvt_pk_bf16_f32 v153, v86, v87
v_cvt_pk_bf16_f32 v154, v88, v89
v_cvt_pk_bf16_f32 v155, v90, v91
ds_write_b128 v37, v[152:155] offset:23552
buffer_store_dwordx4 v[152:155], v36, s[24:27], s89 offen offset:3072 sc1
s_add_u32 s89, s89, 0x20000
s_waitcnt vmcnt(16)
s_branch L_attdone
L_att3:
s_add_u32 m0, s81, 131072
s_nop 0
buffer_load_dwordx4 v32, s[16:19], s57 offen offset:0 nt lds
buffer_load_dwordx4 v33, s[16:19], s57 offen offset:1024 nt lds
buffer_load_dwordx4 v32, s[16:19], s57 offen offset:2048 nt lds
buffer_load_dwordx4 v33, s[16:19], s57 offen offset:3072 nt lds
s_add_u32 s57, s57, 4096
v_mfma_f32_16x16x32_bf16 v[60:63], v[124:127], a[128:131], v[232:235]
v_mfma_f32_16x16x32_bf16 v[64:67], v[124:127], a[144:147], v[236:239]
v_mfma_f32_16x16x32_bf16 v[68:71], v[124:127], a[160:163], v[240:243]
v_mfma_f32_16x16x32_bf16 v[76:79], v[140:143], a[128:131], v[232:235]
v_mfma_f32_16x16x32_bf16 v[80:83], v[140:143], a[144:147], v[236:239]
v_mfma_f32_16x16x32_bf16 v[84:87], v[140:143], a[160:163], v[240:243]
v_mfma_f32_16x16x32_bf16 v[60:63], v[128:131], a[132:135], v[60:63]
v_mfma_f32_16x16x32_bf16 v[64:67], v[128:131], a[148:151], v[64:67]
v_mfma_f32_16x16x32_bf16 v[68:71], v[128:131], a[164:167], v[68:71]
v_mfma_f32_16x16x32_bf16 v[76:79], v[144:147], a[132:135], v[76:79]
v_mfma_f32_16x16x32_bf16 v[80:83], v[144:147], a[148:151], v[80:83]
v_mfma_f32_16x16x32_bf16 v[84:87], v[144:147], a[164:167], v[84:87]
v_mfma_f32_16x16x32_bf16 v[60:63], v[132:135], a[136:139], v[60:63]
v_mfma_f32_16x16x32_bf16 v[64:67], v[132:135], a[152:155], v[64:67]
v_mfma_f32_16x16x32_bf16 v[68:71], v[132:135], a[168:171], v[68:71]
v_mfma_f32_16x16x32_bf16 v[76:79], v[148:151], a[136:139], v[76:79]
v_mfma_f32_16x16x32_bf16 v[80:83], v[148:151], a[152:155], v[80:83]
v_mfma_f32_16x16x32_bf16 v[84:87], v[148:151], a[168:171], v[84:87]
v_mfma_f32_16x16x32_bf16 v[60:63], v[136:139], a[140:143], v[60:63]
v_mfma_f32_16x16x32_bf16 v[64:67], v[136:139], a[156:159], v[64:67]
v_mfma_f32_16x16x32_bf16 v[68:71], v[136:139], a[172:175], v[68:71]
v_mfma_f32_16x16x32_bf16 v[76:79], v[152:155], a[140:143], v[76:79]
v_mfma_f32_16x16x32_bf16 v[80:83], v[152:155], a[156:159], v[80:83]
v_mfma_f32_16x16x32_bf16 v[84:87], v[152:155], a[172:175], v[84:87]
s_waitcnt vmcnt(4) lgkmcnt(0)
s_barrier
ds_read_b128 v[124:127], v208 offset:0
ds_read_b128 v[140:143], v208 offset:4096
ds_read_b128 v[128:131], v209 offset:0
ds_read_b128 v[144:147], v209 offset:4096
ds_read_b128 v[132:135], v210 offset:0
ds_read_b128 v[148:151], v210 offset:4096
ds_read_b128 v[136:139], v211 offset:0
ds_read_b128 v[152:155], v211 offset:4096
v_readfirstlane_b32 s90, v38
v_readfirstlane_b32 s91, v39
v_max3_f32 v2, v60, v61, v62
v_max3_f32 v2, v2, v63, v76
v_max3_f32 v2, v2, v77, v78
v_max_f32 v2, v2, v79
v_mov_b32 v3, v2
s_nop 1
v_permlane16_swap_b32 v2, v3
s_nop 1
v_max_f32 v2, v2, v3
v_mov_b32 v3, v2
s_nop 1
v_permlane32_swap_b32 v2, v3
s_nop 1
v_max_f32 v2, v2, v3
v_sub_f32 v60, v60, v2
v_sub_f32 v61, v61, v2
v_sub_f32 v62, v62, v2
v_sub_f32 v63, v63, v2
v_sub_f32 v76, v76, v2
v_sub_f32 v77, v77, v2
v_sub_f32 v78, v78, v2
v_sub_f32 v79, v79, v2
v_sub_f32 v232, v232, v2
v_sub_f32 v233, v233, v2
v_sub_f32 v234, v234, v2
v_sub_f32 v235, v235, v2
v_max3_f32 v2, v64, v65, v66
v_max3_f32 v2, v2, v67, v80
v_max3_f32 v2, v2, v81, v82
v_max_f32 v2, v2, v83
v_mov_b32 v3, v2
s_nop 1
v_permlane16_swap_b32 v2, v3
s_nop 1
v_max_f32 v2, v2, v3
v_mov_b32 v3, v2
s_nop 1
v_permlane32_swap_b32 v2, v3
s_nop 1
v_max_f32 v2, v2, v3
v_sub_f32 v64, v64, v2
v_sub_f32 v65, v65, v2
v_sub_f32 v66, v66, v2
v_sub_f32 v67, v67, v2
v_sub_f32 v80, v80, v2
v_sub_f32 v81, v81, v2
v_sub_f32 v82, v82, v2
v_sub_f32 v83, v83, v2
v_sub_f32 v236, v236, v2
v_sub_f32 v237, v237, v2
v_sub_f32 v238, v238, v2
v_sub_f32 v239, v239, v2
v_max3_f32 v2, v68, v69, v70
v_max3_f32 v2, v2, v71, v84
v_max3_f32 v2, v2, v85, v86
v_max_f32 v2, v2, v87
v_mov_b32 v3, v2
s_nop 1
v_permlane16_swap_b32 v2, v3
s_nop 1
v_max_f32 v2, v2, v3
v_mov_b32 v3, v2
s_nop 1
v_permlane32_swap_b32 v2, v3
s_nop 1
v_max_f32 v2, v2, v3
v_sub_f32 v68, v68, v2
v_sub_f32 v69, v69, v2
v_sub_f32 v70, v70, v2
v_sub_f32 v71, v71, v2
v_sub_f32 v84, v84, v2
v_sub_f32 v85, v85, v2
v_sub_f32 v86, v86, v2
v_sub_f32 v87, v87, v2
v_sub_f32 v240, v240, v2
v_sub_f32 v241, v241, v2
v_sub_f32 v242, v242, v2
v_sub_f32 v243, v243, v2
v_exp_f32 v60, v60
v_exp_f32 v61, v61
v_exp_f32 v62, v62
v_exp_f32 v63, v63
v_exp_f32 v76, v76
v_exp_f32 v77, v77
s_mov_b32 s53, 7
L_aloop_3:
s_waitcnt lgkmcnt(0)
v_mfma_f32_16x16x32_bf16 v[92:95], v[124:127], a[128:131], v[232:235]
ds_read_b64_tr_b16 v[156:157], v216 offset:0
v_exp_f32 v78, v78
v_mfma_f32_16x16x32_bf16 v[96:99], v[124:127], a[144:147], v[236:239]
v_exp_f32 v79, v79
v_mfma_f32_16x16x32_bf16 v[100:103], v[124:127], a[160:163], v[240:243]
ds_read_b64_tr_b16 v[158:159], v216 offset:4096
v_pk_add_f32 v[248:249], v[248:249], v[60:61]
v_mfma_f32_16x16x32_bf16 v[108:111], v[140:143], a[128:131], v[232:235]
ds_read_b64_tr_b16 v[160:161], v217 offset:0
s_add_u32 m0, s81, 135168
s_nop 0
s_waitcnt vmcnt(4)
buffer_load_dwordx4 v32, s[16:19], s57 offen offset:0 nt lds
v_cvt_pk_bf16_f32 v44, v60, v61
v_exp_f32 v64, v64
v_mfma_f32_16x16x32_bf16 v[112:115], v[140:143], a[144:147], v[236:239]
ds_read_b64_tr_b16 v[162:163], v217 offset:4096
s_cmp_lg_u32 s82, 0
s_cbranch_scc1 L_r2_33
L_b2_34:
v_exp_f32 v65, v65
v_mfma_f32_16x16x32_bf16 v[116:119], v[140:143], a[160:163], v[240:243]
v_pk_add_f32 v[248:249], v[248:249], v[62:63]
v_mfma_f32_16x16x32_bf16 v[92:95], v[128:131], a[132:135], v[92:95]
ds_read_b64_tr_b16 v[164:165], v218 offset:0
v_cvt_pk_bf16_f32 v45, v62, v63
v_mfma_f32_16x16x32_bf16 v[96:99], v[128:131], a[148:151], v[96:99]
ds_read_b64_tr_b16 v[166:167], v218 offset:4096
v_exp_f32 v66, v66
v_mfma_f32_16x16x32_bf16 v[100:103], v[128:131], a[164:167], v[100:103]
ds_read_b64_tr_b16 v[168:169], v219 offset:0
v_exp_f32 v67, v67
v_mfma_f32_16x16x32_bf16 v[108:111], v[144:147], a[132:135], v[108:111]
s_waitcnt vmcnt(4)
buffer_load_dwordx4 v33, s[16:19], s57 offen offset:1024 nt lds
v_pk_add_f32 v[248:249], v[248:249], v[76:77]
v_cvt_pk_bf16_f32 v46, v76, v77
v_mfma_f32_16x16x32_bf16 v[112:115], v[144:147], a[148:151], v[112:115]
ds_read_b64_tr_b16 v[170:171], v219 offset:4096
v_exp_f32 v80, v80
v_mfma_f32_16x16x32_bf16 v[116:119], v[144:147], a[164:167], v[116:119]
ds_read_b64_tr_b16 v[172:173], v220 offset:0
v_exp_f32 v81, v81
v_mfma_f32_16x16x32_bf16 v[92:95], v[132:135], a[136:139], v[92:95]
v_pk_add_f32 v[248:249], v[248:249], v[78:79]
v_cvt_pk_bf16_f32 v47, v78, v79
v_mfma_f32_16x16x32_bf16 v[96:99], v[132:135], a[152:155], v[96:99]
ds_read_b64_tr_b16 v[174:175], v220 offset:4096
v_exp_f32 v82, v82
v_mfma_f32_16x16x32_bf16 v[100:103], v[132:135], a[168:171], v[100:103]
ds_read_b64_tr_b16 v[176:177], v221 offset:0
v_exp_f32 v83, v83
v_mfma_f32_16x16x32_bf16 v[108:111], v[148:151], a[136:139], v[108:111]
ds_read_b64_tr_b16 v[178:179], v221 offset:4096
v_pk_add_f32 v[250:251], v[250:251], v[64:65]
v_mfma_f32_16x16x32_bf16 v[112:115], v[148:151], a[152:155], v[112:115]
s_waitcnt vmcnt(4)
buffer_load_dwordx4 v32, s[16:19], s57 offen offset:2048 nt lds
v_cvt_pk_bf16_f32 v48, v64, v65
v_mfma_f32_16x16x32_bf16 v[116:119], v[148:151], a[168:171], v[116:119]
ds_read_b64_tr_b16 v[180:181], v222 offset:0
v_exp_f32 v68, v68
v_mfma_f32_16x16x32_bf16 v[92:95], v[136:139], a[140:143], v[92:95]
ds_read_b64_tr_b16 v[182:183], v222 offset:4096
v_exp_f32 v69, v69
v_pk_add_f32 v[250:251], v[250:251], v[66:67]
v_mfma_f32_16x16x32_bf16 v[96:99], v[136:139], a[156:159], v[96:99]
ds_read_b64_tr_b16 v[184:185], v223 offset:0
v_cvt_pk_bf16_f32 v49, v66, v67
v_mfma_f32_16x16x32_bf16 v[100:103], v[136:139], a[172:175], v[100:103]
v_exp_f32 v70, v70
v_mfma_f32_16x16x32_bf16 v[108:111], v[152:155], a[140:143], v[108:111]
s_waitcnt lgkmcnt(11)
ds_read_b64_tr_b16 v[186:187], v223 offset:4096
v_exp_f32 v71, v71
v_mfma_f32_16x16x32_bf16 v[112:115], v[152:155], a[156:159], v[112:115]
s_waitcnt vmcnt(4)
buffer_load_dwordx4 v33, s[16:19], s57 offen offset:3072 nt lds
s_add_u32 s57, s57, 12288
v_pk_add_f32 v[250:251], v[250:251], v[80:81]
v_cvt_pk_bf16_f32 v50, v80, v81
v_mfma_f32_16x16x32_bf16 v[116:119], v[152:155], a[172:175], v[116:119]
v_exp_f32 v84, v84
v_mfma_f32_16x16x32_bf16 a[0:3], v[156:159], v[44:47], a[0:3]
v_exp_f32 v85, v85
v_mfma_f32_16x16x32_bf16 a[16:19], v[160:163], v[44:47], a[16:19]
v_pk_add_f32 v[250:251], v[250:251], v[82:83]
s_waitcnt lgkmcnt(10)
v_mfma_f32_16x16x32_bf16 a[32:35], v[164:167], v[44:47], a[32:35]
v_cvt_pk_bf16_f32 v51, v82, v83
v_exp_f32 v86, v86
s_waitcnt vmcnt(8) lgkmcnt(0)
s_barrier
v_mfma_f32_16x16x32_bf16 a[48:51], v[168:171], v[44:47], a[48:51]
ds_read_b128 v[124:127], v208 offset:32768
v_mfma_f32_16x16x32_bf16 a[64:67], v[172:175], v[44:47], a[64:67]
v_exp_f32 v87, v87
v_pk_add_f32 v[252:253], v[252:253], v[68:69]
v_mfma_f32_16x16x32_bf16 a[80:83], v[176:179], v[44:47], a[80:83]
v_cvt_pk_bf16_f32 v52, v68, v69
ds_read_b128 v[140:143], v208 offset:36864
s_add_u32 m0, s81, 49152
s_nop 0
s_waitcnt vmcnt(4)
buffer_load_dwordx4 v28, s[12:15], s56 offen offset:0 nt lds
v_mfma_f32_16x16x32_bf16 a[96:99], v[180:183], v[44:47], a[96:99]
v_pk_add_f32 v[252:253], v[252:253], v[70:71]
v_cvt_pk_bf16_f32 v53, v70, v71
v_mfma_f32_16x16x32_bf16 a[112:115], v[184:187], v[44:47], a[112:115]
v_pk_add_f32 v[252:253], v[252:253], v[84:85]
v_cvt_pk_bf16_f32 v54, v84, v85
ds_read_b128 v[128:131], v209 offset:32768
v_mfma_f32_16x16x32_bf16 a[4:7], v[156:159], v[48:51], a[4:7]
v_pk_add_f32 v[252:253], v[252:253], v[86:87]
v_mfma_f32_16x16x32_bf16 a[20:23], v[160:163], v[48:51], a[20:23]
v_cvt_pk_bf16_f32 v55, v86, v87
v_max3_f32 v2, v92, v93, v94
ds_read_b128 v[144:147], v209 offset:36864
v_mfma_f32_16x16x32_bf16 a[36:39], v[164:167], v[48:51], a[36:39]
v_max3_f32 v2, v2, v95, v96
v_max3_f32 v2, v2, v97, v98
s_waitcnt vmcnt(4)
buffer_load_dwordx4 v29, s[12:15], s56 offen offset:1024 nt lds
v_mfma_f32_16x16x32_bf16 a[52:55], v[168:171], v[48:51], a[52:55]
v_max3_f32 v2, v2, v99, v100
ds_read_b128 v[132:135], v210 offset:32768
v_mfma_f32_16x16x32_bf16 a[68:71], v[172:175], v[48:51], a[68:71]
v_max3_f32 v2, v2, v101, v102
v_max3_f32 v2, v2, v103, v108
v_mfma_f32_16x16x32_bf16 a[84:87], v[176:179], v[48:51], a[84:87]
v_max3_f32 v2, v2, v109, v110
v_max3_f32 v2, v2, v111, v112
ds_read_b128 v[148:151], v210 offset:36864
v_mfma_f32_16x16x32_bf16 a[100:103], v[180:183], v[48:51], a[100:103]
v_max3_f32 v2, v2, v113, v114
v_max3_f32 v2, v2, v115, v116
v_mfma_f32_16x16x32_bf16 a[116:119], v[184:187], v[48:51], a[116:119]
v_max3_f32 v2, v2, v117, v118
ds_read_b128 v[136:139], v211 offset:32768
v_mfma_f32_16x16x32_bf16 a[8:11], v[156:159], v[52:55], a[8:11]
v_max_f32 v2, v2, v119
s_waitcnt vmcnt(4)
buffer_load_dwordx4 v30, s[12:15], s56 offen offset:2048 nt lds
v_mfma_f32_16x16x32_bf16 a[24:27], v[160:163], v[52:55], a[24:27]
v_cmp_lt_f32 vcc, s59, v2
s_cbranch_vccnz L_r1_35
L_b1_36:
ds_read_b128 v[152:155], v211 offset:36864
v_mfma_f32_16x16x32_bf16 a[40:43], v[164:167], v[52:55], a[40:43]
v_exp_f32 v92, v92
v_mfma_f32_16x16x32_bf16 a[56:59], v[168:171], v[52:55], a[56:59]
v_exp_f32 v93, v93
v_mfma_f32_16x16x32_bf16 a[72:75], v[172:175], v[52:55], a[72:75]
v_exp_f32 v94, v94
v_mfma_f32_16x16x32_bf16 a[88:91], v[176:179], v[52:55], a[88:91]
v_exp_f32 v95, v95
s_waitcnt vmcnt(4)
buffer_load_dwordx4 v31, s[12:15], s56 offen offset:3072 nt lds
s_add_u32 s56, s56, 4096
v_mfma_f32_16x16x32_bf16 a[104:107], v[180:183], v[52:55], a[104:107]
v_exp_f32 v108, v108
v_mfma_f32_16x16x32_bf16 a[120:123], v[184:187], v[52:55], a[120:123]
v_exp_f32 v109, v109
s_waitcnt lgkmcnt(0)
v_mfma_f32_16x16x32_bf16 v[60:63], v[124:127], a[128:131], v[232:235]
ds_read_b64_tr_b16 v[156:157], v216 offset:32768
v_exp_f32 v110, v110
v_mfma_f32_16x16x32_bf16 v[64:67], v[124:127], a[144:147], v[236:239]
v_exp_f32 v111, v111
v_mfma_f32_16x16x32_bf16 v[68:71], v[124:127], a[160:163], v[240:243]
ds_read_b64_tr_b16 v[158:159], v216 offset:36864
v_pk_add_f32 v[248:249], v[248:249], v[92:93]
v_mfma_f32_16x16x32_bf16 v[76:79], v[140:143], a[128:131], v[232:235]
ds_read_b64_tr_b16 v[160:161], v217 offset:32768
s_add_u32 m0, s81, 53248
s_nop 0
s_waitcnt vmcnt(4)
buffer_load_dwordx4 v28, s[12:15], s56 offen offset:0 nt lds
v_cvt_pk_bf16_f32 v44, v92, v93
v_exp_f32 v96, v96
v_mfma_f32_16x16x32_bf16 v[80:83], v[140:143], a[144:147], v[236:239]
ds_read_b64_tr_b16 v[162:163], v217 offset:36864
s_cmp_lg_u32 s82, 0
s_cbranch_scc1 L_r2_37
L_b2_38:
v_exp_f32 v97, v97
v_mfma_f32_16x16x32_bf16 v[84:87], v[140:143], a[160:163], v[240:243]
v_pk_add_f32 v[248:249], v[248:249], v[94:95]
v_mfma_f32_16x16x32_bf16 v[60:63], v[128:131], a[132:135], v[60:63]
ds_read_b64_tr_b16 v[164:165], v218 offset:32768
v_cvt_pk_bf16_f32 v45, v94, v95
v_mfma_f32_16x16x32_bf16 v[64:67], v[128:131], a[148:151], v[64:67]
ds_read_b64_tr_b16 v[166:167], v218 offset:36864
v_exp_f32 v98, v98
v_mfma_f32_16x16x32_bf16 v[68:71], v[128:131], a[164:167], v[68:71]
ds_read_b64_tr_b16 v[168:169], v219 offset:32768
v_exp_f32 v99, v99
v_mfma_f32_16x16x32_bf16 v[76:79], v[144:147], a[132:135], v[76:79]
s_waitcnt vmcnt(4)
buffer_load_dwordx4 v29, s[12:15], s56 offen offset:1024 nt lds
v_pk_add_f32 v[248:249], v[248:249], v[108:109]
v_cvt_pk_bf16_f32 v46, v108, v109
v_mfma_f32_16x16x32_bf16 v[80:83], v[144:147], a[148:151], v[80:83]
ds_read_b64_tr_b16 v[170:171], v219 offset:36864
v_exp_f32 v112, v112
v_mfma_f32_16x16x32_bf16 v[84:87], v[144:147], a[164:167], v[84:87]
ds_read_b64_tr_b16 v[172:173], v220 offset:32768
v_exp_f32 v113, v113
v_mfma_f32_16x16x32_bf16 v[60:63], v[132:135], a[136:139], v[60:63]
v_pk_add_f32 v[248:249], v[248:249], v[110:111]
v_cvt_pk_bf16_f32 v47, v110, v111
v_mfma_f32_16x16x32_bf16 v[64:67], v[132:135], a[152:155], v[64:67]
ds_read_b64_tr_b16 v[174:175], v220 offset:36864
v_exp_f32 v114, v114
v_mfma_f32_16x16x32_bf16 v[68:71], v[132:135], a[168:171], v[68:71]
ds_read_b64_tr_b16 v[176:177], v221 offset:32768
v_exp_f32 v115, v115
v_mfma_f32_16x16x32_bf16 v[76:79], v[148:151], a[136:139], v[76:79]
ds_read_b64_tr_b16 v[178:179], v221 offset:36864
v_pk_add_f32 v[250:251], v[250:251], v[96:97]
v_mfma_f32_16x16x32_bf16 v[80:83], v[148:151], a[152:155], v[80:83]
s_waitcnt vmcnt(4)
buffer_load_dwordx4 v30, s[12:15], s56 offen offset:2048 nt lds
v_cvt_pk_bf16_f32 v48, v96, v97
v_mfma_f32_16x16x32_bf16 v[84:87], v[148:151], a[168:171], v[84:87]
ds_read_b64_tr_b16 v[180:181], v222 offset:32768
v_exp_f32 v100, v100
v_mfma_f32_16x16x32_bf16 v[60:63], v[136:139], a[140:143], v[60:63]
ds_read_b64_tr_b16 v[182:183], v222 offset:36864
v_exp_f32 v101, v101
v_pk_add_f32 v[250:251], v[250:251], v[98:99]
v_mfma_f32_16x16x32_bf16 v[64:67], v[136:139], a[156:159], v[64:67]
ds_read_b64_tr_b16 v[184:185], v223 offset:32768
v_cvt_pk_bf16_f32 v49, v98, v99
v_mfma_f32_16x16x32_bf16 v[68:71], v[136:139], a[172:175], v[68:71]
v_exp_f32 v102, v102
v_mfma_f32_16x16x32_bf16 v[76:79], v[152:155], a[140:143], v[76:79]
s_waitcnt lgkmcnt(11)
ds_read_b64_tr_b16 v[186:187], v223 offset:36864
v_exp_f32 v103, v103
v_mfma_f32_16x16x32_bf16 v[80:83], v[152:155], a[156:159], v[80:83]
s_waitcnt vmcnt(4)
buffer_load_dwordx4 v31, s[12:15], s56 offen offset:3072 nt lds
s_add_u32 s56, s56, 12288
v_pk_add_f32 v[250:251], v[250:251], v[112:113]
v_cvt_pk_bf16_f32 v50, v112, v113
v_mfma_f32_16x16x32_bf16 v[84:87], v[152:155], a[172:175], v[84:87]
v_exp_f32 v116, v116
v_mfma_f32_16x16x32_bf16 a[0:3], v[156:159], v[44:47], a[0:3]
v_exp_f32 v117, v117
v_mfma_f32_16x16x32_bf16 a[16:19], v[160:163], v[44:47], a[16:19]
v_pk_add_f32 v[250:251], v[250:251], v[114:115]
s_waitcnt lgkmcnt(10)
v_mfma_f32_16x16x32_bf16 a[32:35], v[164:167], v[44:47], a[32:35]
v_cvt_pk_bf16_f32 v51, v114, v115
v_exp_f32 v118, v118
s_waitcnt vmcnt(8) lgkmcnt(0)
s_barrier
v_mfma_f32_16x16x32_bf16 a[48:51], v[168:171], v[44:47], a[48:51]
ds_read_b128 v[124:127], v212 offset:0
v_mfma_f32_16x16x32_bf16 a[64:67], v[172:175], v[44:47], a[64:67]
v_exp_f32 v119, v119
v_pk_add_f32 v[252:253], v[252:253], v[100:101]
v_mfma_f32_16x16x32_bf16 a[80:83], v[176:179], v[44:47], a[80:83]
v_cvt_pk_bf16_f32 v52, v100, v101
ds_read_b128 v[140:143], v212 offset:4096
s_add_u32 m0, s81, 65536
s_nop 0
s_waitcnt vmcnt(4)
buffer_load_dwordx4 v32, s[16:19], s57 offen offset:0 nt lds
v_mfma_f32_16x16x32_bf16 a[96:99], v[180:183], v[44:47], a[96:99]
v_pk_add_f32 v[252:253], v[252:253], v[102:103]
v_cvt_pk_bf16_f32 v53, v102, v103
v_mfma_f32_16x16x32_bf16 a[112:115], v[184:187], v[44:47], a[112:115]
v_pk_add_f32 v[252:253], v[252:253], v[116:117]
v_cvt_pk_bf16_f32 v54, v116, v117
ds_read_b128 v[128:131], v213 offset:0
v_mfma_f32_16x16x32_bf16 a[4:7], v[156:159], v[48:51], a[4:7]
v_pk_add_f32 v[252:253], v[252:253], v[118:119]
v_mfma_f32_16x16x32_bf16 a[20:23], v[160:163], v[48:51], a[20:23]
v_cvt_pk_bf16_f32 v55, v118, v119
v_max3_f32 v2, v60, v61, v62
ds_read_b128 v[144:147], v213 offset:4096
v_mfma_f32_16x16x32_bf16 a[36:39], v[164:167], v[48:51], a[36:39]
v_max3_f32 v2, v2, v63, v64
v_max3_f32 v2, v2, v65, v66
s_waitcnt vmcnt(4)
buffer_load_dwordx4 v33, s[16:19], s57 offen offset:1024 nt lds
v_mfma_f32_16x16x32_bf16 a[52:55], v[168:171], v[48:51], a[52:55]
v_max3_f32 v2, v2, v67, v68
ds_read_b128 v[132:135], v214 offset:0
v_mfma_f32_16x16x32_bf16 a[68:71], v[172:175], v[48:51], a[68:71]
v_max3_f32 v2, v2, v69, v70
v_max3_f32 v2, v2, v71, v76
v_mfma_f32_16x16x32_bf16 a[84:87], v[176:179], v[48:51], a[84:87]
v_max3_f32 v2, v2, v77, v78
v_max3_f32 v2, v2, v79, v80
ds_read_b128 v[148:151], v214 offset:4096
v_mfma_f32_16x16x32_bf16 a[100:103], v[180:183], v[48:51], a[100:103]
v_max3_f32 v2, v2, v81, v82
v_max3_f32 v2, v2, v83, v84
v_mfma_f32_16x16x32_bf16 a[116:119], v[184:187], v[48:51], a[116:119]
v_max3_f32 v2, v2, v85, v86
ds_read_b128 v[136:139], v215 offset:0
v_mfma_f32_16x16x32_bf16 a[8:11], v[156:159], v[52:55], a[8:11]
v_max_f32 v2, v2, v87
s_waitcnt vmcnt(4)
buffer_load_dwordx4 v32, s[16:19], s57 offen offset:2048 nt lds
v_mfma_f32_16x16x32_bf16 a[24:27], v[160:163], v[52:55], a[24:27]
v_cmp_lt_f32 vcc, s59, v2
s_cbranch_vccnz L_r1_39
L_b1_40:
ds_read_b128 v[152:155], v215 offset:4096
v_mfma_f32_16x16x32_bf16 a[40:43], v[164:167], v[52:55], a[40:43]
v_exp_f32 v60, v60
v_mfma_f32_16x16x32_bf16 a[56:59], v[168:171], v[52:55], a[56:59]
v_exp_f32 v61, v61
v_mfma_f32_16x16x32_bf16 a[72:75], v[172:175], v[52:55], a[72:75]
v_exp_f32 v62, v62
v_mfma_f32_16x16x32_bf16 a[88:91], v[176:179], v[52:55], a[88:91]
v_exp_f32 v63, v63
s_waitcnt vmcnt(4)
buffer_load_dwordx4 v33, s[16:19], s57 offen offset:3072 nt lds
s_add_u32 s57, s57, 4096
v_mfma_f32_16x16x32_bf16 a[104:107], v[180:183], v[52:55], a[104:107]
v_exp_f32 v76, v76
v_mfma_f32_16x16x32_bf16 a[120:123], v[184:187], v[52:55], a[120:123]
v_exp_f32 v77, v77
s_waitcnt lgkmcnt(0)
v_mfma_f32_16x16x32_bf16 v[92:95], v[124:127], a[128:131], v[232:235]
ds_read_b64_tr_b16 v[156:157], v224 offset:0
v_exp_f32 v78, v78
v_mfma_f32_16x16x32_bf16 v[96:99], v[124:127], a[144:147], v[236:239]
v_exp_f32 v79, v79
v_mfma_f32_16x16x32_bf16 v[100:103], v[124:127], a[160:163], v[240:243]
ds_read_b64_tr_b16 v[158:159], v224 offset:4096
v_pk_add_f32 v[248:249], v[248:249], v[60:61]
v_mfma_f32_16x16x32_bf16 v[108:111], v[140:143], a[128:131], v[232:235]
ds_read_b64_tr_b16 v[160:161], v225 offset:0
s_add_u32 m0, s81, 69632
s_nop 0
s_waitcnt vmcnt(4)
buffer_load_dwordx4 v32, s[16:19], s57 offen offset:0 nt lds
v_cvt_pk_bf16_f32 v44, v60, v61
v_exp_f32 v64, v64
v_mfma_f32_16x16x32_bf16 v[112:115], v[140:143], a[144:147], v[236:239]
ds_read_b64_tr_b16 v[162:163], v225 offset:4096
s_cmp_lg_u32 s82, 0
s_cbranch_scc1 L_r2_41
L_b2_42:
v_exp_f32 v65, v65
v_mfma_f32_16x16x32_bf16 v[116:119], v[140:143], a[160:163], v[240:243]
v_pk_add_f32 v[248:249], v[248:249], v[62:63]
v_mfma_f32_16x16x32_bf16 v[92:95], v[128:131], a[132:135], v[92:95]
ds_read_b64_tr_b16 v[164:165], v226 offset:0
v_cvt_pk_bf16_f32 v45, v62, v63
v_mfma_f32_16x16x32_bf16 v[96:99], v[128:131], a[148:151], v[96:99]
ds_read_b64_tr_b16 v[166:167], v226 offset:4096
v_exp_f32 v66, v66
v_mfma_f32_16x16x32_bf16 v[100:103], v[128:131], a[164:167], v[100:103]
ds_read_b64_tr_b16 v[168:169], v227 offset:0
v_exp_f32 v67, v67
v_mfma_f32_16x16x32_bf16 v[108:111], v[144:147], a[132:135], v[108:111]
s_waitcnt vmcnt(4)
buffer_load_dwordx4 v33, s[16:19], s57 offen offset:1024 nt lds
v_pk_add_f32 v[248:249], v[248:249], v[76:77]
v_cvt_pk_bf16_f32 v46, v76, v77
v_mfma_f32_16x16x32_bf16 v[112:115], v[144:147], a[148:151], v[112:115]
ds_read_b64_tr_b16 v[170:171], v227 offset:4096
v_exp_f32 v80, v80
v_mfma_f32_16x16x32_bf16 v[116:119], v[144:147], a[164:167], v[116:119]
ds_read_b64_tr_b16 v[172:173], v228 offset:0
v_exp_f32 v81, v81
v_mfma_f32_16x16x32_bf16 v[92:95], v[132:135], a[136:139], v[92:95]
v_pk_add_f32 v[248:249], v[248:249], v[78:79]
v_cvt_pk_bf16_f32 v47, v78, v79
v_mfma_f32_16x16x32_bf16 v[96:99], v[132:135], a[152:155], v[96:99]
ds_read_b64_tr_b16 v[174:175], v228 offset:4096
v_exp_f32 v82, v82
v_mfma_f32_16x16x32_bf16 v[100:103], v[132:135], a[168:171], v[100:103]
ds_read_b64_tr_b16 v[176:177], v229 offset:0
v_exp_f32 v83, v83
v_mfma_f32_16x16x32_bf16 v[108:111], v[148:151], a[136:139], v[108:111]
ds_read_b64_tr_b16 v[178:179], v229 offset:4096
v_pk_add_f32 v[250:251], v[250:251], v[64:65]
v_mfma_f32_16x16x32_bf16 v[112:115], v[148:151], a[152:155], v[112:115]
s_waitcnt vmcnt(4)
buffer_load_dwordx4 v32, s[16:19], s57 offen offset:2048 nt lds
v_cvt_pk_bf16_f32 v48, v64, v65
v_mfma_f32_16x16x32_bf16 v[116:119], v[148:151], a[168:171], v[116:119]
ds_read_b64_tr_b16 v[180:181], v230 offset:0
v_exp_f32 v68, v68
v_mfma_f32_16x16x32_bf16 v[92:95], v[136:139], a[140:143], v[92:95]
ds_read_b64_tr_b16 v[182:183], v230 offset:4096
v_exp_f32 v69, v69
v_pk_add_f32 v[250:251], v[250:251], v[66:67]
v_mfma_f32_16x16x32_bf16 v[96:99], v[136:139], a[156:159], v[96:99]
ds_read_b64_tr_b16 v[184:185], v231 offset:0
v_cvt_pk_bf16_f32 v49, v66, v67
v_mfma_f32_16x16x32_bf16 v[100:103], v[136:139], a[172:175], v[100:103]
v_exp_f32 v70, v70
v_mfma_f32_16x16x32_bf16 v[108:111], v[152:155], a[140:143], v[108:111]
s_waitcnt lgkmcnt(11)
ds_read_b64_tr_b16 v[186:187], v231 offset:4096
v_exp_f32 v71, v71
v_mfma_f32_16x16x32_bf16 v[112:115], v[152:155], a[156:159], v[112:115]
s_waitcnt vmcnt(4)
buffer_load_dwordx4 v33, s[16:19], s57 offen offset:3072 nt lds
s_add_u32 s57, s57, 12288
v_pk_add_f32 v[250:251], v[250:251], v[80:81]
v_cvt_pk_bf16_f32 v50, v80, v81
v_mfma_f32_16x16x32_bf16 v[116:119], v[152:155], a[172:175], v[116:119]
v_exp_f32 v84, v84
v_mfma_f32_16x16x32_bf16 a[0:3], v[156:159], v[44:47], a[0:3]
v_exp_f32 v85, v85
v_mfma_f32_16x16x32_bf16 a[16:19], v[160:163], v[44:47], a[16:19]
v_pk_add_f32 v[250:251], v[250:251], v[82:83]
s_waitcnt lgkmcnt(10)
v_mfma_f32_16x16x32_bf16 a[32:35], v[164:167], v[44:47], a[32:35]
v_cvt_pk_bf16_f32 v51, v82, v83
v_exp_f32 v86, v86
s_waitcnt vmcnt(8) lgkmcnt(0)
s_barrier
v_mfma_f32_16x16x32_bf16 a[48:51], v[168:171], v[44:47], a[48:51]
ds_read_b128 v[124:127], v212 offset:32768
v_mfma_f32_16x16x32_bf16 a[64:67], v[172:175], v[44:47], a[64:67]
v_exp_f32 v87, v87
v_pk_add_f32 v[252:253], v[252:253], v[68:69]
v_mfma_f32_16x16x32_bf16 a[80:83], v[176:179], v[44:47], a[80:83]
v_cvt_pk_bf16_f32 v52, v68, v69
ds_read_b128 v[140:143], v212 offset:36864
s_add_u32 m0, s81, 114688
s_nop 0
s_waitcnt vmcnt(4)
buffer_load_dwordx4 v28, s[12:15], s56 offen offset:0 nt lds
v_mfma_f32_16x16x32_bf16 a[96:99], v[180:183], v[44:47], a[96:99]
v_pk_add_f32 v[252:253], v[252:253], v[70:71]
v_cvt_pk_bf16_f32 v53, v70, v71
v_mfma_f32_16x16x32_bf16 a[112:115], v[184:187], v[44:47], a[112:115]
v_pk_add_f32 v[252:253], v[252:253], v[84:85]
v_cvt_pk_bf16_f32 v54, v84, v85
ds_read_b128 v[128:131], v213 offset:32768
v_mfma_f32_16x16x32_bf16 a[4:7], v[156:159], v[48:51], a[4:7]
v_pk_add_f32 v[252:253], v[252:253], v[86:87]
v_mfma_f32_16x16x32_bf16 a[20:23], v[160:163], v[48:51], a[20:23]
v_cvt_pk_bf16_f32 v55, v86, v87
v_max3_f32 v2, v92, v93, v94
ds_read_b128 v[144:147], v213 offset:36864
v_mfma_f32_16x16x32_bf16 a[36:39], v[164:167], v[48:51], a[36:39]
v_max3_f32 v2, v2, v95, v96
v_max3_f32 v2, v2, v97, v98
s_waitcnt vmcnt(4)
buffer_load_dwordx4 v29, s[12:15], s56 offen offset:1024 nt lds
v_mfma_f32_16x16x32_bf16 a[52:55], v[168:171], v[48:51], a[52:55]
v_max3_f32 v2, v2, v99, v100
ds_read_b128 v[132:135], v214 offset:32768
v_mfma_f32_16x16x32_bf16 a[68:71], v[172:175], v[48:51], a[68:71]
v_max3_f32 v2, v2, v101, v102
v_max3_f32 v2, v2, v103, v108
v_mfma_f32_16x16x32_bf16 a[84:87], v[176:179], v[48:51], a[84:87]
v_max3_f32 v2, v2, v109, v110
v_max3_f32 v2, v2, v111, v112
ds_read_b128 v[148:151], v214 offset:36864
v_mfma_f32_16x16x32_bf16 a[100:103], v[180:183], v[48:51], a[100:103]
v_max3_f32 v2, v2, v113, v114
v_max3_f32 v2, v2, v115, v116
v_mfma_f32_16x16x32_bf16 a[116:119], v[184:187], v[48:51], a[116:119]
v_max3_f32 v2, v2, v117, v118
ds_read_b128 v[136:139], v215 offset:32768
v_mfma_f32_16x16x32_bf16 a[8:11], v[156:159], v[52:55], a[8:11]
v_max_f32 v2, v2, v119
s_waitcnt vmcnt(4)
buffer_load_dwordx4 v30, s[12:15], s56 offen offset:2048 nt lds
v_mfma_f32_16x16x32_bf16 a[24:27], v[160:163], v[52:55], a[24:27]
v_cmp_lt_f32 vcc, s59, v2
s_cbranch_vccnz L_r1_43
L_b1_44:
ds_read_b128 v[152:155], v215 offset:36864
v_mfma_f32_16x16x32_bf16 a[40:43], v[164:167], v[52:55], a[40:43]
v_exp_f32 v92, v92
v_mfma_f32_16x16x32_bf16 a[56:59], v[168:171], v[52:55], a[56:59]
v_exp_f32 v93, v93
v_mfma_f32_16x16x32_bf16 a[72:75], v[172:175], v[52:55], a[72:75]
v_exp_f32 v94, v94
v_mfma_f32_16x16x32_bf16 a[88:91], v[176:179], v[52:55], a[88:91]
v_exp_f32 v95, v95
s_waitcnt vmcnt(4)
buffer_load_dwordx4 v31, s[12:15], s56 offen offset:3072 nt lds
s_add_u32 s56, s56, 4096
v_mfma_f32_16x16x32_bf16 a[104:107], v[180:183], v[52:55], a[104:107]
v_exp_f32 v108, v108
v_mfma_f32_16x16x32_bf16 a[120:123], v[184:187], v[52:55], a[120:123]
v_exp_f32 v109, v109
s_waitcnt lgkmcnt(0)
v_mfma_f32_16x16x32_bf16 v[60:63], v[124:127], a[128:131], v[232:235]
ds_read_b64_tr_b16 v[156:157], v224 offset:32768
v_exp_f32 v110, v110
v_mfma_f32_16x16x32_bf16 v[64:67], v[124:127], a[144:147], v[236:239]
v_exp_f32 v111, v111
v_mfma_f32_16x16x32_bf16 v[68:71], v[124:127], a[160:163], v[240:243]
ds_read_b64_tr_b16 v[158:159], v224 offset:36864
v_pk_add_f32 v[248:249], v[248:249], v[92:93]
v_mfma_f32_16x16x32_bf16 v[76:79], v[140:143], a[128:131], v[232:235]
ds_read_b64_tr_b16 v[160:161], v225 offset:32768
s_add_u32 m0, s81, 118784
s_nop 0
s_waitcnt vmcnt(4)
buffer_load_dwordx4 v28, s[12:15], s56 offen offset:0 nt lds
v_cvt_pk_bf16_f32 v44, v92, v93
v_exp_f32 v96, v96
v_mfma_f32_16x16x32_bf16 v[80:83], v[140:143], a[144:147], v[236:239]
ds_read_b64_tr_b16 v[162:163], v225 offset:36864
s_cmp_lg_u32 s82, 0
s_cbranch_scc1 L_r2_45
L_b2_46:
v_exp_f32 v97, v97
v_mfma_f32_16x16x32_bf16 v[84:87], v[140:143], a[160:163], v[240:243]
v_pk_add_f32 v[248:249], v[248:249], v[94:95]
v_mfma_f32_16x16x32_bf16 v[60:63], v[128:131], a[132:135], v[60:63]
ds_read_b64_tr_b16 v[164:165], v226 offset:32768
v_cvt_pk_bf16_f32 v45, v94, v95
v_mfma_f32_16x16x32_bf16 v[64:67], v[128:131], a[148:151], v[64:67]
ds_read_b64_tr_b16 v[166:167], v226 offset:36864
v_exp_f32 v98, v98
v_mfma_f32_16x16x32_bf16 v[68:71], v[128:131], a[164:167], v[68:71]
ds_read_b64_tr_b16 v[168:169], v227 offset:32768
v_exp_f32 v99, v99
v_mfma_f32_16x16x32_bf16 v[76:79], v[144:147], a[132:135], v[76:79]
s_waitcnt vmcnt(4)
buffer_load_dwordx4 v29, s[12:15], s56 offen offset:1024 nt lds
v_pk_add_f32 v[248:249], v[248:249], v[108:109]
v_cvt_pk_bf16_f32 v46, v108, v109
v_mfma_f32_16x16x32_bf16 v[80:83], v[144:147], a[148:151], v[80:83]
ds_read_b64_tr_b16 v[170:171], v227 offset:36864
v_exp_f32 v112, v112
v_mfma_f32_16x16x32_bf16 v[84:87], v[144:147], a[164:167], v[84:87]
ds_read_b64_tr_b16 v[172:173], v228 offset:32768
v_exp_f32 v113, v113
v_mfma_f32_16x16x32_bf16 v[60:63], v[132:135], a[136:139], v[60:63]
v_pk_add_f32 v[248:249], v[248:249], v[110:111]
v_cvt_pk_bf16_f32 v47, v110, v111
v_mfma_f32_16x16x32_bf16 v[64:67], v[132:135], a[152:155], v[64:67]
ds_read_b64_tr_b16 v[174:175], v228 offset:36864
v_exp_f32 v114, v114
v_mfma_f32_16x16x32_bf16 v[68:71], v[132:135], a[168:171], v[68:71]
ds_read_b64_tr_b16 v[176:177], v229 offset:32768
v_exp_f32 v115, v115
v_mfma_f32_16x16x32_bf16 v[76:79], v[148:151], a[136:139], v[76:79]
ds_read_b64_tr_b16 v[178:179], v229 offset:36864
v_pk_add_f32 v[250:251], v[250:251], v[96:97]
v_mfma_f32_16x16x32_bf16 v[80:83], v[148:151], a[152:155], v[80:83]
s_waitcnt vmcnt(4)
buffer_load_dwordx4 v30, s[12:15], s56 offen offset:2048 nt lds
v_cvt_pk_bf16_f32 v48, v96, v97
v_mfma_f32_16x16x32_bf16 v[84:87], v[148:151], a[168:171], v[84:87]
ds_read_b64_tr_b16 v[180:181], v230 offset:32768
v_exp_f32 v100, v100
v_mfma_f32_16x16x32_bf16 v[60:63], v[136:139], a[140:143], v[60:63]
ds_read_b64_tr_b16 v[182:183], v230 offset:36864
v_exp_f32 v101, v101
v_pk_add_f32 v[250:251], v[250:251], v[98:99]
v_mfma_f32_16x16x32_bf16 v[64:67], v[136:139], a[156:159], v[64:67]
ds_read_b64_tr_b16 v[184:185], v231 offset:32768
v_cvt_pk_bf16_f32 v49, v98, v99
v_mfma_f32_16x16x32_bf16 v[68:71], v[136:139], a[172:175], v[68:71]
v_exp_f32 v102, v102
v_mfma_f32_16x16x32_bf16 v[76:79], v[152:155], a[140:143], v[76:79]
s_waitcnt lgkmcnt(11)
ds_read_b64_tr_b16 v[186:187], v231 offset:36864
v_exp_f32 v103, v103
v_mfma_f32_16x16x32_bf16 v[80:83], v[152:155], a[156:159], v[80:83]
s_waitcnt vmcnt(4)
buffer_load_dwordx4 v31, s[12:15], s56 offen offset:3072 nt lds
s_add_u32 s56, s56, 12288
v_pk_add_f32 v[250:251], v[250:251], v[112:113]
v_cvt_pk_bf16_f32 v50, v112, v113
v_mfma_f32_16x16x32_bf16 v[84:87], v[152:155], a[172:175], v[84:87]
v_exp_f32 v116, v116
v_mfma_f32_16x16x32_bf16 a[0:3], v[156:159], v[44:47], a[0:3]
v_exp_f32 v117, v117
v_mfma_f32_16x16x32_bf16 a[16:19], v[160:163], v[44:47], a[16:19]
v_pk_add_f32 v[250:251], v[250:251], v[114:115]
s_waitcnt lgkmcnt(10)
v_mfma_f32_16x16x32_bf16 a[32:35], v[164:167], v[44:47], a[32:35]
v_cvt_pk_bf16_f32 v51, v114, v115
v_exp_f32 v118, v118
s_waitcnt vmcnt(8) lgkmcnt(0)
s_barrier
v_mfma_f32_16x16x32_bf16 a[48:51], v[168:171], v[44:47], a[48:51]
ds_read_b128 v[124:127], v208 offset:0
v_mfma_f32_16x16x32_bf16 a[64:67], v[172:175], v[44:47], a[64:67]
v_exp_f32 v119, v119
v_pk_add_f32 v[252:253], v[252:253], v[100:101]
v_mfma_f32_16x16x32_bf16 a[80:83], v[176:179], v[44:47], a[80:83]
v_cvt_pk_bf16_f32 v52, v100, v101
ds_read_b128 v[140:143], v208 offset:4096
s_add_u32 m0, s81, 131072
s_nop 0
s_waitcnt vmcnt(4)
buffer_load_dwordx4 v32, s[16:19], s57 offen offset:0 nt lds
v_mfma_f32_16x16x32_bf16 a[96:99], v[180:183], v[44:47], a[96:99]
v_pk_add_f32 v[252:253], v[252:253], v[102:103]
v_cvt_pk_bf16_f32 v53, v102, v103
v_mfma_f32_16x16x32_bf16 a[112:115], v[184:187], v[44:47], a[112:115]
v_pk_add_f32 v[252:253], v[252:253], v[116:117]
v_cvt_pk_bf16_f32 v54, v116, v117
ds_read_b128 v[128:131], v209 offset:0
v_mfma_f32_16x16x32_bf16 a[4:7], v[156:159], v[48:51], a[4:7]
v_pk_add_f32 v[252:253], v[252:253], v[118:119]
v_mfma_f32_16x16x32_bf16 a[20:23], v[160:163], v[48:51], a[20:23]
v_cvt_pk_bf16_f32 v55, v118, v119
v_max3_f32 v2, v60, v61, v62
ds_read_b128 v[144:147], v209 offset:4096
v_mfma_f32_16x16x32_bf16 a[36:39], v[164:167], v[48:51], a[36:39]
v_max3_f32 v2, v2, v63, v64
v_max3_f32 v2, v2, v65, v66
s_waitcnt vmcnt(4)
buffer_load_dwordx4 v33, s[16:19], s57 offen offset:1024 nt lds
v_mfma_f32_16x16x32_bf16 a[52:55], v[168:171], v[48:51], a[52:55]
v_max3_f32 v2, v2, v67, v68
ds_read_b128 v[132:135], v210 offset:0
v_mfma_f32_16x16x32_bf16 a[68:71], v[172:175], v[48:51], a[68:71]
v_max3_f32 v2, v2, v69, v70
v_max3_f32 v2, v2, v71, v76
v_mfma_f32_16x16x32_bf16 a[84:87], v[176:179], v[48:51], a[84:87]
v_max3_f32 v2, v2, v77, v78
v_max3_f32 v2, v2, v79, v80
ds_read_b128 v[148:151], v210 offset:4096
v_mfma_f32_16x16x32_bf16 a[100:103], v[180:183], v[48:51], a[100:103]
v_max3_f32 v2, v2, v81, v82
v_max3_f32 v2, v2, v83, v84
v_mfma_f32_16x16x32_bf16 a[116:119], v[184:187], v[48:51], a[116:119]
v_max3_f32 v2, v2, v85, v86
ds_read_b128 v[136:139], v211 offset:0
v_mfma_f32_16x16x32_bf16 a[8:11], v[156:159], v[52:55], a[8:11]
v_max_f32 v2, v2, v87
s_waitcnt vmcnt(4)
buffer_load_dwordx4 v32, s[16:19], s57 offen offset:2048 nt lds
v_mfma_f32_16x16x32_bf16 a[24:27], v[160:163], v[52:55], a[24:27]
v_cmp_lt_f32 vcc, s59, v2
s_cbranch_vccnz L_r1_47
L_b1_48:
ds_read_b128 v[152:155], v211 offset:4096
v_mfma_f32_16x16x32_bf16 a[40:43], v[164:167], v[52:55], a[40:43]
v_exp_f32 v60, v60
v_mfma_f32_16x16x32_bf16 a[56:59], v[168:171], v[52:55], a[56:59]
v_exp_f32 v61, v61
v_mfma_f32_16x16x32_bf16 a[72:75], v[172:175], v[52:55], a[72:75]
v_exp_f32 v62, v62
v_mfma_f32_16x16x32_bf16 a[88:91], v[176:179], v[52:55], a[88:91]
v_exp_f32 v63, v63
s_waitcnt vmcnt(4)
buffer_load_dwordx4 v33, s[16:19], s57 offen offset:3072 nt lds
s_add_u32 s57, s57, 4096
v_mfma_f32_16x16x32_bf16 a[104:107], v[180:183], v[52:55], a[104:107]
v_exp_f32 v76, v76
v_mfma_f32_16x16x32_bf16 a[120:123], v[184:187], v[52:55], a[120:123]
v_exp_f32 v77, v77
s_sub_u32 s53, s53, 1
s_cmp_lg_u32 s53, 0
s_cbranch_scc1 L_aloop_3
s_waitcnt lgkmcnt(0)
v_mfma_f32_16x16x32_bf16 v[92:95], v[124:127], a[128:131], v[232:235]
ds_read_b64_tr_b16 v[156:157], v216 offset:0
v_exp_f32 v78, v78
v_mfma_f32_16x16x32_bf16 v[96:99], v[124:127], a[144:147], v[236:239]
v_exp_f32 v79, v79
v_mfma_f32_16x16x32_bf16 v[100:103], v[124:127], a[160:163], v[240:243]
ds_read_b64_tr_b16 v[158:159], v216 offset:4096
v_pk_add_f32 v[248:249], v[248:249], v[60:61]
v_mfma_f32_16x16x32_bf16 v[108:111], v[140:143], a[128:131], v[232:235]
ds_read_b64_tr_b16 v[160:161], v217 offset:0
s_add_u32 m0, s81, 135168
s_nop 0
s_waitcnt vmcnt(4)
buffer_load_dwordx4 v32, s[16:19], s57 offen offset:0 nt lds
v_cvt_pk_bf16_f32 v44, v60, v61
v_exp_f32 v64, v64
v_mfma_f32_16x16x32_bf16 v[112:115], v[140:143], a[144:147], v[236:239]
ds_read_b64_tr_b16 v[162:163], v217 offset:4096
s_cmp_lg_u32 s82, 0
s_cbranch_scc1 L_r2_49
L_b2_50:
v_exp_f32 v65, v65
v_mfma_f32_16x16x32_bf16 v[116:119], v[140:143], a[160:163], v[240:243]
v_pk_add_f32 v[248:249], v[248:249], v[62:63]
v_mfma_f32_16x16x32_bf16 v[92:95], v[128:131], a[132:135], v[92:95]
ds_read_b64_tr_b16 v[164:165], v218 offset:0
v_cvt_pk_bf16_f32 v45, v62, v63
v_mfma_f32_16x16x32_bf16 v[96:99], v[128:131], a[148:151], v[96:99]
ds_read_b64_tr_b16 v[166:167], v218 offset:4096
v_exp_f32 v66, v66
v_mfma_f32_16x16x32_bf16 v[100:103], v[128:131], a[164:167], v[100:103]
ds_read_b64_tr_b16 v[168:169], v219 offset:0
v_exp_f32 v67, v67
v_mfma_f32_16x16x32_bf16 v[108:111], v[144:147], a[132:135], v[108:111]
s_waitcnt vmcnt(4)
buffer_load_dwordx4 v33, s[16:19], s57 offen offset:1024 nt lds
v_pk_add_f32 v[248:249], v[248:249], v[76:77]
v_cvt_pk_bf16_f32 v46, v76, v77
v_mfma_f32_16x16x32_bf16 v[112:115], v[144:147], a[148:151], v[112:115]
ds_read_b64_tr_b16 v[170:171], v219 offset:4096
v_exp_f32 v80, v80
v_mfma_f32_16x16x32_bf16 v[116:119], v[144:147], a[164:167], v[116:119]
ds_read_b64_tr_b16 v[172:173], v220 offset:0
v_exp_f32 v81, v81
v_mfma_f32_16x16x32_bf16 v[92:95], v[132:135], a[136:139], v[92:95]
v_pk_add_f32 v[248:249], v[248:249], v[78:79]
v_cvt_pk_bf16_f32 v47, v78, v79
v_mfma_f32_16x16x32_bf16 v[96:99], v[132:135], a[152:155], v[96:99]
ds_read_b64_tr_b16 v[174:175], v220 offset:4096
v_exp_f32 v82, v82
v_mfma_f32_16x16x32_bf16 v[100:103], v[132:135], a[168:171], v[100:103]
ds_read_b64_tr_b16 v[176:177], v221 offset:0
v_exp_f32 v83, v83
v_mfma_f32_16x16x32_bf16 v[108:111], v[148:151], a[136:139], v[108:111]
ds_read_b64_tr_b16 v[178:179], v221 offset:4096
v_pk_add_f32 v[250:251], v[250:251], v[64:65]
v_mfma_f32_16x16x32_bf16 v[112:115], v[148:151], a[152:155], v[112:115]
s_waitcnt vmcnt(4)
buffer_load_dwordx4 v32, s[16:19], s57 offen offset:2048 nt lds
v_cvt_pk_bf16_f32 v48, v64, v65
v_mfma_f32_16x16x32_bf16 v[116:119], v[148:151], a[168:171], v[116:119]
ds_read_b64_tr_b16 v[180:181], v222 offset:0
v_exp_f32 v68, v68
v_mfma_f32_16x16x32_bf16 v[92:95], v[136:139], a[140:143], v[92:95]
ds_read_b64_tr_b16 v[182:183], v222 offset:4096
v_exp_f32 v69, v69
v_pk_add_f32 v[250:251], v[250:251], v[66:67]
v_mfma_f32_16x16x32_bf16 v[96:99], v[136:139], a[156:159], v[96:99]
ds_read_b64_tr_b16 v[184:185], v223 offset:0
v_cvt_pk_bf16_f32 v49, v66, v67
v_mfma_f32_16x16x32_bf16 v[100:103], v[136:139], a[172:175], v[100:103]
v_exp_f32 v70, v70
v_mfma_f32_16x16x32_bf16 v[108:111], v[152:155], a[140:143], v[108:111]
s_waitcnt lgkmcnt(11)
ds_read_b64_tr_b16 v[186:187], v223 offset:4096
v_exp_f32 v71, v71
v_mfma_f32_16x16x32_bf16 v[112:115], v[152:155], a[156:159], v[112:115]
s_waitcnt vmcnt(4)
buffer_load_dwordx4 v33, s[16:19], s57 offen offset:3072 nt lds
s_add_u32 s57, s57, 12288
v_pk_add_f32 v[250:251], v[250:251], v[80:81]
v_cvt_pk_bf16_f32 v50, v80, v81
v_mfma_f32_16x16x32_bf16 v[116:119], v[152:155], a[172:175], v[116:119]
v_exp_f32 v84, v84
v_mfma_f32_16x16x32_bf16 a[0:3], v[156:159], v[44:47], a[0:3]
v_exp_f32 v85, v85
v_mfma_f32_16x16x32_bf16 a[16:19], v[160:163], v[44:47], a[16:19]
v_pk_add_f32 v[250:251], v[250:251], v[82:83]
s_waitcnt lgkmcnt(10)
v_mfma_f32_16x16x32_bf16 a[32:35], v[164:167], v[44:47], a[32:35]
v_cvt_pk_bf16_f32 v51, v82, v83
v_exp_f32 v86, v86
s_waitcnt vmcnt(8) lgkmcnt(0)
s_barrier
v_mfma_f32_16x16x32_bf16 a[48:51], v[168:171], v[44:47], a[48:51]
ds_read_b128 v[124:127], v208 offset:32768
v_mfma_f32_16x16x32_bf16 a[64:67], v[172:175], v[44:47], a[64:67]
v_exp_f32 v87, v87
v_pk_add_f32 v[252:253], v[252:253], v[68:69]
s_add_u32 m0, s52, 0
s_add_u32 s86, s55, 65536
buffer_load_dwordx4 v14, s[8:11], s55 offen offset:0 lds
v_mfma_f32_16x16x32_bf16 a[80:83], v[176:179], v[44:47], a[80:83]
v_cvt_pk_bf16_f32 v52, v68, v69
ds_read_b128 v[140:143], v208 offset:36864
v_mfma_f32_16x16x32_bf16 a[96:99], v[180:183], v[44:47], a[96:99]
v_pk_add_f32 v[252:253], v[252:253], v[70:71]
v_cvt_pk_bf16_f32 v53, v70, v71
buffer_load_dwordx4 v15, s[8:11], s55 offen offset:1024 lds
v_mfma_f32_16x16x32_bf16 a[112:115], v[184:187], v[44:47], a[112:115]
v_pk_add_f32 v[252:253], v[252:253], v[84:85]
v_cvt_pk_bf16_f32 v54, v84, v85
ds_read_b128 v[128:131], v209 offset:32768
v_mfma_f32_16x16x32_bf16 a[4:7], v[156:159], v[48:51], a[4:7]
v_pk_add_f32 v[252:253], v[252:253], v[86:87]
v_mfma_f32_16x16x32_bf16 a[20:23], v[160:163], v[48:51], a[20:23]
v_cvt_pk_bf16_f32 v55, v86, v87
v_max3_f32 v2, v92, v93, v94
ds_read_b128 v[144:147], v209 offset:36864
buffer_load_dwordx4 v16, s[8:11], s55 offen offset:2048 lds
v_mfma_f32_16x16x32_bf16 a[36:39], v[164:167], v[48:51], a[36:39]
v_max3_f32 v2, v2, v95, v96
v_max3_f32 v2, v2, v97, v98
v_mfma_f32_16x16x32_bf16 a[52:55], v[168:171], v[48:51], a[52:55]
v_max3_f32 v2, v2, v99, v100
ds_read_b128 v[132:135], v210 offset:32768
v_mfma_f32_16x16x32_bf16 a[68:71], v[172:175], v[48:51], a[68:71]
v_max3_f32 v2, v2, v101, v102
v_max3_f32 v2, v2, v103, v108
buffer_load_dwordx4 v17, s[8:11], s55 offen offset:3072 lds
s_lshr_b64 s[96:97], s[96:97], 4
s_and_b32 s55, s96, 15
s_lshl_b32 s55, s55, 17
v_mfma_f32_16x16x32_bf16 a[84:87], v[176:179], v[48:51], a[84:87]
v_max3_f32 v2, v2, v109, v110
v_max3_f32 v2, v2, v111, v112
ds_read_b128 v[148:151], v210 offset:36864
v_mfma_f32_16x16x32_bf16 a[100:103], v[180:183], v[48:51], a[100:103]
v_max3_f32 v2, v2, v113, v114
v_max3_f32 v2, v2, v115, v116
s_add_u32 m0, s52, 4096
s_nop 0
buffer_load_dwordx4 v14, s[8:11], s86 offen offset:0 lds
v_mfma_f32_16x16x32_bf16 a[116:119], v[184:187], v[48:51], a[116:119]
v_max3_f32 v2, v2, v117, v118
ds_read_b128 v[136:139], v211 offset:32768
v_mfma_f32_16x16x32_bf16 a[8:11], v[156:159], v[52:55], a[8:11]
v_max_f32 v2, v2, v119
v_mfma_f32_16x16x32_bf16 a[24:27], v[160:163], v[52:55], a[24:27]
v_cmp_lt_f32 vcc, s59, v2
s_cbranch_vccnz L_r1_51
L_b1_52:
ds_read_b128 v[152:155], v211 offset:36864
buffer_load_dwordx4 v15, s[8:11], s86 offen offset:1024 lds
v_mfma_f32_16x16x32_bf16 a[40:43], v[164:167], v[52:55], a[40:43]
v_exp_f32 v92, v92
v_mfma_f32_16x16x32_bf16 a[56:59], v[168:171], v[52:55], a[56:59]
v_exp_f32 v93, v93
v_mfma_f32_16x16x32_bf16 a[72:75], v[172:175], v[52:55], a[72:75]
v_exp_f32 v94, v94
buffer_load_dwordx4 v16, s[8:11], s86 offen offset:2048 lds
v_mfma_f32_16x16x32_bf16 a[88:91], v[176:179], v[52:55], a[88:91]
v_exp_f32 v95, v95
v_mfma_f32_16x16x32_bf16 a[104:107], v[180:183], v[52:55], a[104:107]
v_exp_f32 v108, v108
buffer_load_dwordx4 v17, s[8:11], s86 offen offset:3072 lds
v_mfma_f32_16x16x32_bf16 a[120:123], v[184:187], v[52:55], a[120:123]
v_exp_f32 v109, v109
s_waitcnt lgkmcnt(0)
v_mfma_f32_16x16x32_bf16 v[60:63], v[124:127], a[128:131], v[232:235]
ds_read_b64_tr_b16 v[156:157], v216 offset:32768
v_exp_f32 v110, v110
v_mfma_f32_16x16x32_bf16 v[64:67], v[124:127], a[144:147], v[236:239]
v_exp_f32 v111, v111
v_mfma_f32_16x16x32_bf16 v[68:71], v[124:127], a[160:163], v[240:243]
ds_read_b64_tr_b16 v[158:159], v216 offset:36864
v_pk_add_f32 v[248:249], v[248:249], v[92:93]
v_mfma_f32_16x16x32_bf16 v[76:79], v[140:143], a[128:131], v[232:235]
ds_read_b64_tr_b16 v[160:161], v217 offset:32768
v_cvt_pk_bf16_f32 v44, v92, v93
v_exp_f32 v96, v96
v_mfma_f32_16x16x32_bf16 v[80:83], v[140:143], a[144:147], v[236:239]
ds_read_b64_tr_b16 v[162:163], v217 offset:36864
s_cmp_lg_u32 s82, 0
s_cbranch_scc1 L_r2_53
L_b2_54:
v_exp_f32 v97, v97
v_mfma_f32_16x16x32_bf16 v[84:87], v[140:143], a[160:163], v[240:243]
v_pk_add_f32 v[248:249], v[248:249], v[94:95]
v_mfma_f32_16x16x32_bf16 v[60:63], v[128:131], a[132:135], v[60:63]
ds_read_b64_tr_b16 v[164:165], v218 offset:32768
v_cvt_pk_bf16_f32 v45, v94, v95
v_mfma_f32_16x16x32_bf16 v[64:67], v[128:131], a[148:151], v[64:67]
ds_read_b64_tr_b16 v[166:167], v218 offset:36864
v_exp_f32 v98, v98
v_mfma_f32_16x16x32_bf16 v[68:71], v[128:131], a[164:167], v[68:71]
ds_read_b64_tr_b16 v[168:169], v219 offset:32768
v_exp_f32 v99, v99
v_mfma_f32_16x16x32_bf16 v[76:79], v[144:147], a[132:135], v[76:79]
v_pk_add_f32 v[248:249], v[248:249], v[108:109]
v_cvt_pk_bf16_f32 v46, v108, v109
v_mfma_f32_16x16x32_bf16 v[80:83], v[144:147], a[148:151], v[80:83]
ds_read_b64_tr_b16 v[170:171], v219 offset:36864
v_exp_f32 v112, v112
v_mfma_f32_16x16x32_bf16 v[84:87], v[144:147], a[164:167], v[84:87]
ds_read_b64_tr_b16 v[172:173], v220 offset:32768
v_exp_f32 v113, v113
v_mfma_f32_16x16x32_bf16 v[60:63], v[132:135], a[136:139], v[60:63]
v_pk_add_f32 v[248:249], v[248:249], v[110:111]
v_cvt_pk_bf16_f32 v47, v110, v111
v_mfma_f32_16x16x32_bf16 v[64:67], v[132:135], a[152:155], v[64:67]
ds_read_b64_tr_b16 v[174:175], v220 offset:36864
v_exp_f32 v114, v114
v_mfma_f32_16x16x32_bf16 v[68:71], v[132:135], a[168:171], v[68:71]
ds_read_b64_tr_b16 v[176:177], v221 offset:32768
v_exp_f32 v115, v115
v_mfma_f32_16x16x32_bf16 v[76:79], v[148:151], a[136:139], v[76:79]
ds_read_b64_tr_b16 v[178:179], v221 offset:36864
v_pk_add_f32 v[250:251], v[250:251], v[96:97]
v_mfma_f32_16x16x32_bf16 v[80:83], v[148:151], a[152:155], v[80:83]
v_cvt_pk_bf16_f32 v48, v96, v97
v_mfma_f32_16x16x32_bf16 v[84:87], v[148:151], a[168:171], v[84:87]
ds_read_b64_tr_b16 v[180:181], v222 offset:32768
v_exp_f32 v100, v100
v_mfma_f32_16x16x32_bf16 v[60:63], v[136:139], a[140:143], v[60:63]
ds_read_b64_tr_b16 v[182:183], v222 offset:36864
v_exp_f32 v101, v101
v_pk_add_f32 v[250:251], v[250:251], v[98:99]
v_mfma_f32_16x16x32_bf16 v[64:67], v[136:139], a[156:159], v[64:67]
ds_read_b64_tr_b16 v[184:185], v223 offset:32768
v_cvt_pk_bf16_f32 v49, v98, v99
v_mfma_f32_16x16x32_bf16 v[68:71], v[136:139], a[172:175], v[68:71]
v_exp_f32 v102, v102
v_mfma_f32_16x16x32_bf16 v[76:79], v[152:155], a[140:143], v[76:79]
s_waitcnt lgkmcnt(11)
ds_read_b64_tr_b16 v[186:187], v223 offset:36864
v_exp_f32 v103, v103
v_mfma_f32_16x16x32_bf16 v[80:83], v[152:155], a[156:159], v[80:83]
v_pk_add_f32 v[250:251], v[250:251], v[112:113]
v_cvt_pk_bf16_f32 v50, v112, v113
v_mfma_f32_16x16x32_bf16 v[84:87], v[152:155], a[172:175], v[84:87]
v_exp_f32 v116, v116
v_mfma_f32_16x16x32_bf16 a[0:3], v[156:159], v[44:47], a[0:3]
v_exp_f32 v117, v117
v_mfma_f32_16x16x32_bf16 a[16:19], v[160:163], v[44:47], a[16:19]
v_pk_add_f32 v[250:251], v[250:251], v[114:115]
s_waitcnt lgkmcnt(10)
v_mfma_f32_16x16x32_bf16 a[32:35], v[164:167], v[44:47], a[32:35]
v_cvt_pk_bf16_f32 v51, v114, v115
v_exp_f32 v118, v118
s_waitcnt vmcnt(8) lgkmcnt(0)
s_barrier
v_mfma_f32_16x16x32_bf16 a[48:51], v[168:171], v[44:47], a[48:51]
ds_read_b128 v[124:127], v212 offset:0
v_mfma_f32_16x16x32_bf16 a[64:67], v[172:175], v[44:47], a[64:67]
v_exp_f32 v119, v119
v_pk_add_f32 v[252:253], v[252:253], v[100:101]
s_add_u32 m0, s52, 32768
s_add_u32 s86, s55, 65536
buffer_load_dwordx4 v14, s[8:11], s55 offen offset:0 lds
v_mfma_f32_16x16x32_bf16 a[80:83], v[176:179], v[44:47], a[80:83]
v_cvt_pk_bf16_f32 v52, v100, v101
ds_read_b128 v[140:143], v212 offset:4096
v_mfma_f32_16x16x32_bf16 a[96:99], v[180:183], v[44:47], a[96:99]
v_pk_add_f32 v[252:253], v[252:253], v[102:103]
v_cvt_pk_bf16_f32 v53, v102, v103
buffer_load_dwordx4 v15, s[8:11], s55 offen offset:1024 lds
v_mfma_f32_16x16x32_bf16 a[112:115], v[184:187], v[44:47], a[112:115]
v_pk_add_f32 v[252:253], v[252:253], v[116:117]
v_cvt_pk_bf16_f32 v54, v116, v117
ds_read_b128 v[128:131], v213 offset:0
v_mfma_f32_16x16x32_bf16 a[4:7], v[156:159], v[48:51], a[4:7]
v_pk_add_f32 v[252:253], v[252:253], v[118:119]
v_mfma_f32_16x16x32_bf16 a[20:23], v[160:163], v[48:51], a[20:23]
v_cvt_pk_bf16_f32 v55, v118, v119
v_max3_f32 v2, v60, v61, v62
ds_read_b128 v[144:147], v213 offset:4096
buffer_load_dwordx4 v16, s[8:11], s55 offen offset:2048 lds
v_mfma_f32_16x16x32_bf16 a[36:39], v[164:167], v[48:51], a[36:39]
v_max3_f32 v2, v2, v63, v64
v_max3_f32 v2, v2, v65, v66
v_mfma_f32_16x16x32_bf16 a[52:55], v[168:171], v[48:51], a[52:55]
v_max3_f32 v2, v2, v67, v68
ds_read_b128 v[132:135], v214 offset:0
v_mfma_f32_16x16x32_bf16 a[68:71], v[172:175], v[48:51], a[68:71]
v_max3_f32 v2, v2, v69, v70
v_max3_f32 v2, v2, v71, v76
buffer_load_dwordx4 v17, s[8:11], s55 offen offset:3072 lds
s_lshr_b64 s[96:97], s[96:97], 4
s_and_b32 s55, s96, 15
s_lshl_b32 s55, s55, 17
v_mfma_f32_16x16x32_bf16 a[84:87], v[176:179], v[48:51], a[84:87]
v_max3_f32 v2, v2, v77, v78
v_max3_f32 v2, v2, v79, v80
ds_read_b128 v[148:151], v214 offset:4096
v_mfma_f32_16x16x32_bf16 a[100:103], v[180:183], v[48:51], a[100:103]
v_max3_f32 v2, v2, v81, v82
v_max3_f32 v2, v2, v83, v84
s_add_u32 m0, s52, 36864
s_nop 0
buffer_load_dwordx4 v14, s[8:11], s86 offen offset:0 lds
v_mfma_f32_16x16x32_bf16 a[116:119], v[184:187], v[48:51], a[116:119]
v_max3_f32 v2, v2, v85, v86
ds_read_b128 v[136:139], v215 offset:0
v_mfma_f32_16x16x32_bf16 a[8:11], v[156:159], v[52:55], a[8:11]
v_max_f32 v2, v2, v87
v_mfma_f32_16x16x32_bf16 a[24:27], v[160:163], v[52:55], a[24:27]
v_cmp_lt_f32 vcc, s59, v2
s_cbranch_vccnz L_r1_55
L_b1_56:
ds_read_b128 v[152:155], v215 offset:4096
buffer_load_dwordx4 v15, s[8:11], s86 offen offset:1024 lds
v_mfma_f32_16x16x32_bf16 a[40:43], v[164:167], v[52:55], a[40:43]
v_exp_f32 v60, v60
v_mfma_f32_16x16x32_bf16 a[56:59], v[168:171], v[52:55], a[56:59]
v_exp_f32 v61, v61
v_mfma_f32_16x16x32_bf16 a[72:75], v[172:175], v[52:55], a[72:75]
v_exp_f32 v62, v62
buffer_load_dwordx4 v16, s[8:11], s86 offen offset:2048 lds
v_mfma_f32_16x16x32_bf16 a[88:91], v[176:179], v[52:55], a[88:91]
v_exp_f32 v63, v63
v_mfma_f32_16x16x32_bf16 a[104:107], v[180:183], v[52:55], a[104:107]
v_exp_f32 v76, v76
buffer_load_dwordx4 v17, s[8:11], s86 offen offset:3072 lds
v_mfma_f32_16x16x32_bf16 a[120:123], v[184:187], v[52:55], a[120:123]
v_exp_f32 v77, v77
s_waitcnt lgkmcnt(0)
v_mfma_f32_16x16x32_bf16 v[92:95], v[124:127], a[128:131], v[232:235]
ds_read_b64_tr_b16 v[156:157], v224 offset:0
v_exp_f32 v78, v78
v_mfma_f32_16x16x32_bf16 v[96:99], v[124:127], a[144:147], v[236:239]
v_exp_f32 v79, v79
v_mfma_f32_16x16x32_bf16 v[100:103], v[124:127], a[160:163], v[240:243]
ds_read_b64_tr_b16 v[158:159], v224 offset:4096
v_pk_add_f32 v[248:249], v[248:249], v[60:61]
v_mfma_f32_16x16x32_bf16 v[108:111], v[140:143], a[128:131], v[232:235]
ds_read_b64_tr_b16 v[160:161], v225 offset:0
v_cvt_pk_bf16_f32 v44, v60, v61
v_exp_f32 v64, v64
v_mfma_f32_16x16x32_bf16 v[112:115], v[140:143], a[144:147], v[236:239]
ds_read_b64_tr_b16 v[162:163], v225 offset:4096
s_cmp_lg_u32 s82, 0
s_cbranch_scc1 L_r2_57
L_b2_58:
v_exp_f32 v65, v65
v_mfma_f32_16x16x32_bf16 v[116:119], v[140:143], a[160:163], v[240:243]
v_pk_add_f32 v[248:249], v[248:249], v[62:63]
v_mfma_f32_16x16x32_bf16 v[92:95], v[128:131], a[132:135], v[92:95]
ds_read_b64_tr_b16 v[164:165], v226 offset:0
v_cvt_pk_bf16_f32 v45, v62, v63
v_mfma_f32_16x16x32_bf16 v[96:99], v[128:131], a[148:151], v[96:99]
ds_read_b64_tr_b16 v[166:167], v226 offset:4096
v_exp_f32 v66, v66
v_mfma_f32_16x16x32_bf16 v[100:103], v[128:131], a[164:167], v[100:103]
ds_read_b64_tr_b16 v[168:169], v227 offset:0
v_exp_f32 v67, v67
v_mfma_f32_16x16x32_bf16 v[108:111], v[144:147], a[132:135], v[108:111]
v_pk_add_f32 v[248:249], v[248:249], v[76:77]
v_cvt_pk_bf16_f32 v46, v76, v77
v_mfma_f32_16x16x32_bf16 v[112:115], v[144:147], a[148:151], v[112:115]
ds_read_b64_tr_b16 v[170:171], v227 offset:4096
v_exp_f32 v80, v80
v_mfma_f32_16x16x32_bf16 v[116:119], v[144:147], a[164:167], v[116:119]
ds_read_b64_tr_b16 v[172:173], v228 offset:0
v_exp_f32 v81, v81
v_mfma_f32_16x16x32_bf16 v[92:95], v[132:135], a[136:139], v[92:95]
v_pk_add_f32 v[248:249], v[248:249], v[78:79]
v_cvt_pk_bf16_f32 v47, v78, v79
v_mfma_f32_16x16x32_bf16 v[96:99], v[132:135], a[152:155], v[96:99]
ds_read_b64_tr_b16 v[174:175], v228 offset:4096
v_exp_f32 v82, v82
v_mfma_f32_16x16x32_bf16 v[100:103], v[132:135], a[168:171], v[100:103]
ds_read_b64_tr_b16 v[176:177], v229 offset:0
v_exp_f32 v83, v83
v_mfma_f32_16x16x32_bf16 v[108:111], v[148:151], a[136:139], v[108:111]
ds_read_b64_tr_b16 v[178:179], v229 offset:4096
v_pk_add_f32 v[250:251], v[250:251], v[64:65]
v_mfma_f32_16x16x32_bf16 v[112:115], v[148:151], a[152:155], v[112:115]
v_cvt_pk_bf16_f32 v48, v64, v65
v_mfma_f32_16x16x32_bf16 v[116:119], v[148:151], a[168:171], v[116:119]
ds_read_b64_tr_b16 v[180:181], v230 offset:0
v_exp_f32 v68, v68
v_mfma_f32_16x16x32_bf16 v[92:95], v[136:139], a[140:143], v[92:95]
ds_read_b64_tr_b16 v[182:183], v230 offset:4096
v_exp_f32 v69, v69
v_pk_add_f32 v[250:251], v[250:251], v[66:67]
v_mfma_f32_16x16x32_bf16 v[96:99], v[136:139], a[156:159], v[96:99]
ds_read_b64_tr_b16 v[184:185], v231 offset:0
v_cvt_pk_bf16_f32 v49, v66, v67
v_mfma_f32_16x16x32_bf16 v[100:103], v[136:139], a[172:175], v[100:103]
v_exp_f32 v70, v70
v_mfma_f32_16x16x32_bf16 v[108:111], v[152:155], a[140:143], v[108:111]
s_waitcnt lgkmcnt(11)
ds_read_b64_tr_b16 v[186:187], v231 offset:4096
v_exp_f32 v71, v71
v_mfma_f32_16x16x32_bf16 v[112:115], v[152:155], a[156:159], v[112:115]
v_pk_add_f32 v[250:251], v[250:251], v[80:81]
v_cvt_pk_bf16_f32 v50, v80, v81
v_mfma_f32_16x16x32_bf16 v[116:119], v[152:155], a[172:175], v[116:119]
v_exp_f32 v84, v84
v_mfma_f32_16x16x32_bf16 a[0:3], v[156:159], v[44:47], a[0:3]
v_exp_f32 v85, v85
v_mfma_f32_16x16x32_bf16 a[16:19], v[160:163], v[44:47], a[16:19]
v_pk_add_f32 v[250:251], v[250:251], v[82:83]
s_waitcnt lgkmcnt(10)
v_mfma_f32_16x16x32_bf16 a[32:35], v[164:167], v[44:47], a[32:35]
v_cvt_pk_bf16_f32 v51, v82, v83
v_exp_f32 v86, v86
s_waitcnt vmcnt(63) lgkmcnt(0)
s_barrier
v_mfma_f32_16x16x32_bf16 a[48:51], v[168:171], v[44:47], a[48:51]
v_mfma_f32_16x16x32_bf16 a[64:67], v[172:175], v[44:47], a[64:67]
v_exp_f32 v87, v87
v_pk_add_f32 v[252:253], v[252:253], v[68:69]
v_mfma_f32_16x16x32_bf16 a[80:83], v[176:179], v[44:47], a[80:83]
v_cvt_pk_bf16_f32 v52, v68, v69
v_mfma_f32_16x16x32_bf16 a[96:99], v[180:183], v[44:47], a[96:99]
v_pk_add_f32 v[252:253], v[252:253], v[70:71]
v_cvt_pk_bf16_f32 v53, v70, v71
v_mfma_f32_16x16x32_bf16 a[112:115], v[184:187], v[44:47], a[112:115]
v_pk_add_f32 v[252:253], v[252:253], v[84:85]
v_cvt_pk_bf16_f32 v54, v84, v85
v_mfma_f32_16x16x32_bf16 a[4:7], v[156:159], v[48:51], a[4:7]
v_pk_add_f32 v[252:253], v[252:253], v[86:87]
v_mfma_f32_16x16x32_bf16 a[20:23], v[160:163], v[48:51], a[20:23]
v_cvt_pk_bf16_f32 v55, v86, v87
v_max3_f32 v2, v92, v93, v94
v_mfma_f32_16x16x32_bf16 a[36:39], v[164:167], v[48:51], a[36:39]
v_max3_f32 v2, v2, v95, v96
v_max3_f32 v2, v2, v97, v98
v_mfma_f32_16x16x32_bf16 a[52:55], v[168:171], v[48:51], a[52:55]
v_max3_f32 v2, v2, v99, v100
v_mfma_f32_16x16x32_bf16 a[68:71], v[172:175], v[48:51], a[68:71]
v_max3_f32 v2, v2, v101, v102
v_max3_f32 v2, v2, v103, v108
v_mfma_f32_16x16x32_bf16 a[84:87], v[176:179], v[48:51], a[84:87]
v_max3_f32 v2, v2, v109, v110
v_max3_f32 v2, v2, v111, v112
v_mfma_f32_16x16x32_bf16 a[100:103], v[180:183], v[48:51], a[100:103]
v_max3_f32 v2, v2, v113, v114
v_max3_f32 v2, v2, v115, v116
v_mfma_f32_16x16x32_bf16 a[116:119], v[184:187], v[48:51], a[116:119]
v_max3_f32 v2, v2, v117, v118
v_mfma_f32_16x16x32_bf16 a[8:11], v[156:159], v[52:55], a[8:11]
v_max_f32 v2, v2, v119
v_mfma_f32_16x16x32_bf16 a[24:27], v[160:163], v[52:55], a[24:27]
v_cmp_lt_f32 vcc, s59, v2
s_cbranch_vccnz L_r1_59
L_b1_60:
v_mfma_f32_16x16x32_bf16 a[40:43], v[164:167], v[52:55], a[40:43]
v_exp_f32 v92, v92
v_mfma_f32_16x16x32_bf16 a[56:59], v[168:171], v[52:55], a[56:59]
v_exp_f32 v93, v93
v_mfma_f32_16x16x32_bf16 a[72:75], v[172:175], v[52:55], a[72:75]
v_exp_f32 v94, v94
v_mfma_f32_16x16x32_bf16 a[88:91], v[176:179], v[52:55], a[88:91]
v_exp_f32 v95, v95
v_mfma_f32_16x16x32_bf16 a[104:107], v[180:183], v[52:55], a[104:107]
v_exp_f32 v108, v108
v_mfma_f32_16x16x32_bf16 a[120:123], v[184:187], v[52:55], a[120:123]
v_exp_f32 v109, v109
ds_read_b64_tr_b16 v[156:157], v224 offset:32768
ds_read_b64_tr_b16 v[158:159], v224 offset:36864
ds_read_b64_tr_b16 v[160:161], v225 offset:32768
ds_read_b64_tr_b16 v[162:163], v225 offset:36864
ds_read_b64_tr_b16 v[164:165], v226 offset:32768
ds_read_b64_tr_b16 v[166:167], v226 offset:36864
ds_read_b64_tr_b16 v[168:169], v227 offset:32768
ds_read_b64_tr_b16 v[170:171], v227 offset:36864
ds_read_b64_tr_b16 v[172:173], v228 offset:32768
ds_read_b64_tr_b16 v[174:175], v228 offset:36864
ds_read_b64_tr_b16 v[176:177], v229 offset:32768
ds_read_b64_tr_b16 v[178:179], v229 offset:36864
ds_read_b64_tr_b16 v[180:181], v230 offset:32768
ds_read_b64_tr_b16 v[182:183], v230 offset:36864
ds_read_b64_tr_b16 v[184:185], v231 offset:32768
s_waitcnt lgkmcnt(11)
ds_read_b64_tr_b16 v[186:187], v231 offset:36864
s_cmp_lg_u32 s82, 0
s_cbranch_scc1 L_r2_61
L_b2_62:
v_exp_f32 v110, v110
v_exp_f32 v111, v111
v_pk_add_f32 v[248:249], v[248:249], v[92:93]
v_cvt_pk_bf16_f32 v44, v92, v93
v_exp_f32 v96, v96
v_exp_f32 v97, v97
v_pk_add_f32 v[248:249], v[248:249], v[94:95]
v_cvt_pk_bf16_f32 v45, v94, v95
v_exp_f32 v98, v98
v_exp_f32 v99, v99
v_pk_add_f32 v[248:249], v[248:249], v[108:109]
v_cvt_pk_bf16_f32 v46, v108, v109
v_exp_f32 v112, v112
v_exp_f32 v113, v113
v_pk_add_f32 v[248:249], v[248:249], v[110:111]
v_cvt_pk_bf16_f32 v47, v110, v111
s_nop 1
v_mfma_f32_16x16x32_bf16 a[0:3], v[156:159], v[44:47], a[0:3]
v_exp_f32 v114, v114
v_exp_f32 v115, v115
v_pk_add_f32 v[250:251], v[250:251], v[96:97]
v_cvt_pk_bf16_f32 v48, v96, v97
v_mfma_f32_16x16x32_bf16 a[16:19], v[160:163], v[44:47], a[16:19]
v_exp_f32 v100, v100
v_exp_f32 v101, v101
v_pk_add_f32 v[250:251], v[250:251], v[98:99]
v_cvt_pk_bf16_f32 v49, v98, v99
v_exp_f32 v102, v102
s_waitcnt lgkmcnt(10)
v_mfma_f32_16x16x32_bf16 a[32:35], v[164:167], v[44:47], a[32:35]
v_exp_f32 v103, v103
v_pk_add_f32 v[250:251], v[250:251], v[112:113]
v_cvt_pk_bf16_f32 v50, v112, v113
v_exp_f32 v116, v116
s_waitcnt lgkmcnt(8)
v_mfma_f32_16x16x32_bf16 a[48:51], v[168:171], v[44:47], a[48:51]
v_exp_f32 v117, v117
v_pk_add_f32 v[250:251], v[250:251], v[114:115]
v_cvt_pk_bf16_f32 v51, v114, v115
v_add_f32 v248, v248, v249
s_waitcnt lgkmcnt(6)
v_mfma_f32_16x16x32_bf16 a[64:67], v[172:175], v[44:47], a[64:67]
v_mov_b32 v249, v248
s_nop 1
v_permlane16_swap_b32 v248, v249
s_nop 1
s_waitcnt lgkmcnt(4)
v_mfma_f32_16x16x32_bf16 a[80:83], v[176:179], v[44:47], a[80:83]
v_add_f32 v248, v248, v249
v_mov_b32 v249, v248
s_nop 1
v_permlane32_swap_b32 v248, v249
s_nop 1
s_waitcnt lgkmcnt(2)
v_mfma_f32_16x16x32_bf16 a[96:99], v[180:183], v[44:47], a[96:99]
v_add_f32 v248, v248, v249
v_rcp_f32 v248, v248
s_nop 0
v_mov_b32 v249, v248
s_waitcnt lgkmcnt(0)
v_mfma_f32_16x16x32_bf16 a[112:115], v[184:187], v[44:47], a[112:115]
s_nop 1
s_barrier
v_mfma_f32_16x16x32_bf16 a[4:7], v[156:159], v[48:51], a[4:7]
v_exp_f32 v118, v118
v_exp_f32 v119, v119
v_pk_add_f32 v[252:253], v[252:253], v[100:101]
v_mfma_f32_16x16x32_bf16 a[20:23], v[160:163], v[48:51], a[20:23]
v_cvt_pk_bf16_f32 v52, v100, v101
v_pk_add_f32 v[252:253], v[252:253], v[102:103]
v_cvt_pk_bf16_f32 v53, v102, v103
v_pk_add_f32 v[252:253], v[252:253], v[116:117]
v_mfma_f32_16x16x32_bf16 a[36:39], v[164:167], v[48:51], a[36:39]
v_cvt_pk_bf16_f32 v54, v116, v117
v_pk_add_f32 v[252:253], v[252:253], v[118:119]
v_cvt_pk_bf16_f32 v55, v118, v119
v_mfma_f32_16x16x32_bf16 a[52:55], v[168:171], v[48:51], a[52:55]
v_add_f32 v250, v250, v251
v_mov_b32 v251, v250
s_nop 1
v_permlane16_swap_b32 v250, v251
v_mfma_f32_16x16x32_bf16 a[68:71], v[172:175], v[48:51], a[68:71]
s_nop 1
v_add_f32 v250, v250, v251
v_mov_b32 v251, v250
v_mfma_f32_16x16x32_bf16 a[84:87], v[176:179], v[48:51], a[84:87]
s_nop 1
v_permlane32_swap_b32 v250, v251
s_nop 1
v_add_f32 v250, v250, v251
v_mfma_f32_16x16x32_bf16 a[100:103], v[180:183], v[48:51], a[100:103]
v_rcp_f32 v250, v250
s_nop 0
v_mov_b32 v251, v250
v_mfma_f32_16x16x32_bf16 a[116:119], v[184:187], v[48:51], a[116:119]
s_nop 1
v_mfma_f32_16x16x32_bf16 a[8:11], v[156:159], v[52:55], a[8:11]
v_add_f32 v252, v252, v253
v_mov_b32 v253, v252
v_mfma_f32_16x16x32_bf16 a[24:27], v[160:163], v[52:55], a[24:27]
s_nop 1
v_permlane16_swap_b32 v252, v253
v_mfma_f32_16x16x32_bf16 a[40:43], v[164:167], v[52:55], a[40:43]
s_nop 1
v_add_f32 v252, v252, v253
v_mfma_f32_16x16x32_bf16 a[56:59], v[168:171], v[52:55], a[56:59]
v_mov_b32 v253, v252
s_nop 1
v_mfma_f32_16x16x32_bf16 a[72:75], v[172:175], v[52:55], a[72:75]
v_permlane32_swap_b32 v252, v253
s_nop 1
v_mfma_f32_16x16x32_bf16 a[88:91], v[176:179], v[52:55], a[88:91]
v_add_f32 v252, v252, v253
v_rcp_f32 v252, v252
v_mfma_f32_16x16x32_bf16 a[104:107], v[180:183], v[52:55], a[104:107]
s_nop 0
v_mov_b32 v253, v252
v_mfma_f32_16x16x32_bf16 a[120:123], v[184:187], v[52:55], a[120:123]
s_nop 1
s_nop 3
v_accvgpr_read_b32 v60, a0
v_accvgpr_read_b32 v61, a1
v_accvgpr_read_b32 v62, a2
v_accvgpr_read_b32 v63, a3
v_accvgpr_read_b32 v64, a16
v_accvgpr_read_b32 v65, a17
v_accvgpr_read_b32 v66, a18
v_accvgpr_read_b32 v67, a19
v_pk_mul_f32 v[60:61], v[60:61], v[248:249]
v_pk_mul_f32 v[62:63], v[62:63], v[248:249]
v_pk_mul_f32 v[64:65], v[64:65], v[248:249]
v_pk_mul_f32 v[66:67], v[66:67], v[248:249]
v_cvt_pk_bf16_f32 v124, v60, v61
v_cvt_pk_bf16_f32 v125, v62, v63
v_cvt_pk_bf16_f32 v126, v64, v65
v_cvt_pk_bf16_f32 v127, v66, v67
ds_write_b128 v37, v[124:127] offset:0
buffer_store_dwordx4 v[124:127], v36, s[24:27], s89 offen offset:0 sc1
v_accvgpr_read_b32 v68, a32
v_accvgpr_read_b32 v69, a33
v_accvgpr_read_b32 v70, a34
v_accvgpr_read_b32 v71, a35
v_accvgpr_read_b32 v72, a48
v_accvgpr_read_b32 v73, a49
v_accvgpr_read_b32 v74, a50
v_accvgpr_read_b32 v75, a51
v_pk_mul_f32 v[68:69], v[68:69], v[248:249]
v_pk_mul_f32 v[70:71], v[70:71], v[248:249]
v_pk_mul_f32 v[72:73], v[72:73], v[248:249]
v_pk_mul_f32 v[74:75], v[74:75], v[248:249]
v_cvt_pk_bf16_f32 v128, v68, v69
v_cvt_pk_bf16_f32 v129, v70, v71
v_cvt_pk_bf16_f32 v130, v72, v73
v_cvt_pk_bf16_f32 v131, v74, v75
ds_write_b128 v37, v[128:131] offset:1024
buffer_store_dwordx4 v[128:131], v36, s[24:27], s89 offen offset:1024 sc1
v_accvgpr_read_b32 v76, a64
v_accvgpr_read_b32 v77, a65
v_accvgpr_read_b32 v78, a66
v_accvgpr_read_b32 v79, a67
v_accvgpr_read_b32 v80, a80
v_accvgpr_read_b32 v81, a81
v_accvgpr_read_b32 v82, a82
v_accvgpr_read_b32 v83, a83
v_pk_mul_f32 v[76:77], v[76:77], v[248:249]
v_pk_mul_f32 v[78:79], v[78:79], v[248:249]
v_pk_mul_f32 v[80:81], v[80:81], v[248:249]
v_pk_mul_f32 v[82:83], v[82:83], v[248:249]
v_cvt_pk_bf16_f32 v132, v76, v77
v_cvt_pk_bf16_f32 v133, v78, v79
v_cvt_pk_bf16_f32 v134, v80, v81
v_cvt_pk_bf16_f32 v135, v82, v83
ds_write_b128 v37, v[132:135] offset:16384
buffer_store_dwordx4 v[132:135], v36, s[24:27], s89 offen offset:2048 sc1
v_accvgpr_read_b32 v84, a96
v_accvgpr_read_b32 v85, a97
v_accvgpr_read_b32 v86, a98
v_accvgpr_read_b32 v87, a99
v_accvgpr_read_b32 v88, a112
v_accvgpr_read_b32 v89, a113
v_accvgpr_read_b32 v90, a114
v_accvgpr_read_b32 v91, a115
v_pk_mul_f32 v[84:85], v[84:85], v[248:249]
v_pk_mul_f32 v[86:87], v[86:87], v[248:249]
v_pk_mul_f32 v[88:89], v[88:89], v[248:249]
v_pk_mul_f32 v[90:91], v[90:91], v[248:249]
v_cvt_pk_bf16_f32 v136, v84, v85
v_cvt_pk_bf16_f32 v137, v86, v87
v_cvt_pk_bf16_f32 v138, v88, v89
v_cvt_pk_bf16_f32 v139, v90, v91
ds_write_b128 v37, v[136:139] offset:17408
buffer_store_dwordx4 v[136:139], v36, s[24:27], s89 offen offset:3072 sc1
s_add_u32 s89, s89, 0x20000
v_accvgpr_read_b32 v60, a4
v_accvgpr_read_b32 v61, a5
v_accvgpr_read_b32 v62, a6
v_accvgpr_read_b32 v63, a7
v_accvgpr_read_b32 v64, a20
v_accvgpr_read_b32 v65, a21
v_accvgpr_read_b32 v66, a22
v_accvgpr_read_b32 v67, a23
v_pk_mul_f32 v[60:61], v[60:61], v[250:251]
v_pk_mul_f32 v[62:63], v[62:63], v[250:251]
v_pk_mul_f32 v[64:65], v[64:65], v[250:251]
v_pk_mul_f32 v[66:67], v[66:67], v[250:251]
v_cvt_pk_bf16_f32 v140, v60, v61
v_cvt_pk_bf16_f32 v141, v62, v63
v_cvt_pk_bf16_f32 v142, v64, v65
v_cvt_pk_bf16_f32 v143, v66, v67
ds_write_b128 v37, v[140:143] offset:2048
buffer_store_dwordx4 v[140:143], v36, s[24:27], s89 offen offset:0 sc1
v_accvgpr_read_b32 v68, a36
v_accvgpr_read_b32 v69, a37
v_accvgpr_read_b32 v70, a38
v_accvgpr_read_b32 v71, a39
v_accvgpr_read_b32 v72, a52
v_accvgpr_read_b32 v73, a53
v_accvgpr_read_b32 v74, a54
v_accvgpr_read_b32 v75, a55
v_pk_mul_f32 v[68:69], v[68:69], v[250:251]
v_pk_mul_f32 v[70:71], v[70:71], v[250:251]
v_pk_mul_f32 v[72:73], v[72:73], v[250:251]
v_pk_mul_f32 v[74:75], v[74:75], v[250:251]
v_cvt_pk_bf16_f32 v144, v68, v69
v_cvt_pk_bf16_f32 v145, v70, v71
v_cvt_pk_bf16_f32 v146, v72, v73
v_cvt_pk_bf16_f32 v147, v74, v75
ds_write_b128 v37, v[144:147] offset:3072
buffer_store_dwordx4 v[144:147], v36, s[24:27], s89 offen offset:1024 sc1
v_accvgpr_read_b32 v76, a68
v_accvgpr_read_b32 v77, a69
v_accvgpr_read_b32 v78, a70
v_accvgpr_read_b32 v79, a71
v_accvgpr_read_b32 v80, a84
v_accvgpr_read_b32 v81, a85
v_accvgpr_read_b32 v82, a86
v_accvgpr_read_b32 v83, a87
v_pk_mul_f32 v[76:77], v[76:77], v[250:251]
v_pk_mul_f32 v[78:79], v[78:79], v[250:251]
v_pk_mul_f32 v[80:81], v[80:81], v[250:251]
v_pk_mul_f32 v[82:83], v[82:83], v[250:251]
v_cvt_pk_bf16_f32 v148, v76, v77
v_cvt_pk_bf16_f32 v149, v78, v79
v_cvt_pk_bf16_f32 v150, v80, v81
v_cvt_pk_bf16_f32 v151, v82, v83
ds_write_b128 v37, v[148:151] offset:18432
buffer_store_dwordx4 v[148:151], v36, s[24:27], s89 offen offset:2048 sc1
v_accvgpr_read_b32 v84, a100
v_accvgpr_read_b32 v85, a101
v_accvgpr_read_b32 v86, a102
v_accvgpr_read_b32 v87, a103
v_accvgpr_read_b32 v88, a116
v_accvgpr_read_b32 v89, a117
v_accvgpr_read_b32 v90, a118
v_accvgpr_read_b32 v91, a119
v_pk_mul_f32 v[84:85], v[84:85], v[250:251]
v_pk_mul_f32 v[86:87], v[86:87], v[250:251]
v_pk_mul_f32 v[88:89], v[88:89], v[250:251]
v_pk_mul_f32 v[90:91], v[90:91], v[250:251]
v_cvt_pk_bf16_f32 v152, v84, v85
v_cvt_pk_bf16_f32 v153, v86, v87
v_cvt_pk_bf16_f32 v154, v88, v89
v_cvt_pk_bf16_f32 v155, v90, v91
ds_write_b128 v37, v[152:155] offset:19456
buffer_store_dwordx4 v[152:155], v36, s[24:27], s89 offen offset:3072 sc1
s_add_u32 s89, s89, 0x20000
v_accvgpr_read_b32 v60, a8
v_accvgpr_read_b32 v61, a9
v_accvgpr_read_b32 v62, a10
v_accvgpr_read_b32 v63, a11
v_accvgpr_read_b32 v64, a24
v_accvgpr_read_b32 v65, a25
v_accvgpr_read_b32 v66, a26
v_accvgpr_read_b32 v67, a27
v_pk_mul_f32 v[60:61], v[60:61], v[252:253]
v_pk_mul_f32 v[62:63], v[62:63], v[252:253]
v_pk_mul_f32 v[64:65], v[64:65], v[252:253]
v_pk_mul_f32 v[66:67], v[66:67], v[252:253]
v_cvt_pk_bf16_f32 v124, v60, v61
v_cvt_pk_bf16_f32 v125, v62, v63
v_cvt_pk_bf16_f32 v126, v64, v65
v_cvt_pk_bf16_f32 v127, v66, v67
ds_write_b128 v37, v[124:127] offset:4096
buffer_store_dwordx4 v[124:127], v36, s[24:27], s89 offen offset:0 sc1
v_accvgpr_read_b32 v68, a40
v_accvgpr_read_b32 v69, a41
v_accvgpr_read_b32 v70, a42
v_accvgpr_read_b32 v71, a43
v_accvgpr_read_b32 v72, a56
v_accvgpr_read_b32 v73, a57
v_accvgpr_read_b32 v74, a58
v_accvgpr_read_b32 v75, a59
v_pk_mul_f32 v[68:69], v[68:69], v[252:253]
v_pk_mul_f32 v[70:71], v[70:71], v[252:253]
v_pk_mul_f32 v[72:73], v[72:73], v[252:253]
v_pk_mul_f32 v[74:75], v[74:75], v[252:253]
v_cvt_pk_bf16_f32 v128, v68, v69
v_cvt_pk_bf16_f32 v129, v70, v71
v_cvt_pk_bf16_f32 v130, v72, v73
v_cvt_pk_bf16_f32 v131, v74, v75
ds_write_b128 v37, v[128:131] offset:5120
buffer_store_dwordx4 v[128:131], v36, s[24:27], s89 offen offset:1024 sc1
v_accvgpr_read_b32 v76, a72
v_accvgpr_read_b32 v77, a73
v_accvgpr_read_b32 v78, a74
v_accvgpr_read_b32 v79, a75
v_accvgpr_read_b32 v80, a88
v_accvgpr_read_b32 v81, a89
v_accvgpr_read_b32 v82, a90
v_accvgpr_read_b32 v83, a91
v_pk_mul_f32 v[76:77], v[76:77], v[252:253]
v_pk_mul_f32 v[78:79], v[78:79], v[252:253]
v_pk_mul_f32 v[80:81], v[80:81], v[252:253]
v_pk_mul_f32 v[82:83], v[82:83], v[252:253]
v_cvt_pk_bf16_f32 v132, v76, v77
v_cvt_pk_bf16_f32 v133, v78, v79
v_cvt_pk_bf16_f32 v134, v80, v81
v_cvt_pk_bf16_f32 v135, v82, v83
ds_write_b128 v37, v[132:135] offset:20480
buffer_store_dwordx4 v[132:135], v36, s[24:27], s89 offen offset:2048 sc1
v_accvgpr_read_b32 v84, a104
v_accvgpr_read_b32 v85, a105
v_accvgpr_read_b32 v86, a106
v_accvgpr_read_b32 v87, a107
v_accvgpr_read_b32 v88, a120
v_accvgpr_read_b32 v89, a121
v_accvgpr_read_b32 v90, a122
v_accvgpr_read_b32 v91, a123
v_pk_mul_f32 v[84:85], v[84:85], v[252:253]
v_pk_mul_f32 v[86:87], v[86:87], v[252:253]
v_pk_mul_f32 v[88:89], v[88:89], v[252:253]
v_pk_mul_f32 v[90:91], v[90:91], v[252:253]
v_cvt_pk_bf16_f32 v136, v84, v85
v_cvt_pk_bf16_f32 v137, v86, v87
v_cvt_pk_bf16_f32 v138, v88, v89
v_cvt_pk_bf16_f32 v139, v90, v91
ds_write_b128 v37, v[136:139] offset:21504
buffer_store_dwordx4 v[136:139], v36, s[24:27], s89 offen offset:3072 sc1
s_add_u32 s89, s89, 0x20000
s_waitcnt vmcnt(12)
L_attdone:
s_waitcnt vmcnt(63) lgkmcnt(0)
s_barrier
ds_read_b64_tr_b16 a[192:193], v20 offset:0
ds_read_b64_tr_b16 a[194:195], v20 offset:2048
ds_read_b128 v[152:155], v18 offset:0
ds_read_b128 v[156:159], v18 offset:2048
ds_read_b128 v[160:163], v18 offset:4096
ds_read_b128 v[164:167], v18 offset:6144
ds_read_b128 v[168:171], v18 offset:8192
ds_read_b128 v[172:175], v18 offset:10240
ds_read_b128 v[176:179], v18 offset:12288
ds_read_b64_tr_b16 a[196:197], v21 offset:0
ds_read_b64_tr_b16 a[198:199], v21 offset:2048
s_waitcnt lgkmcnt(8)
v_mfma_f32_16x16x32_bf16 v[40:43], a[192:195], v[152:155], 0
s_waitcnt lgkmcnt(7)
v_mfma_f32_16x16x32_bf16 v[44:47], a[192:195], v[156:159], 0
s_waitcnt lgkmcnt(6)
v_mfma_f32_16x16x32_bf16 v[48:51], a[192:195], v[160:163], 0
ds_read_b64_tr_b16 a[200:201], v22 offset:0
s_add_u32 m0, s52, 65536
s_add_u32 s86, s55, 65536
buffer_load_dwordx4 v14, s[8:11], s55 offen offset:0 lds
s_waitcnt lgkmcnt(6)
v_mfma_f32_16x16x32_bf16 v[52:55], a[192:195], v[164:167], 0
s_waitcnt lgkmcnt(5)
v_mfma_f32_16x16x32_bf16 v[56:59], a[192:195], v[168:171], 0
ds_read_b64_tr_b16 a[202:203], v22 offset:2048
s_waitcnt lgkmcnt(2)
v_mfma_f32_16x16x32_bf16 v[60:63], a[192:195], v[172:175], 0
ds_read_b64_tr_b16 a[204:205], v23 offset:0
v_mfma_f32_16x16x32_bf16 v[64:67], a[192:195], v[176:179], 0
v_mfma_f32_16x16x32_bf16 v[68:71], a[196:199], v[152:155], 0
ds_read_b64_tr_b16 a[206:207], v23 offset:2048
buffer_load_dwordx4 v15, s[8:11], s55 offen offset:1024 lds
v_mfma_f32_16x16x32_bf16 v[72:75], a[196:199], v[156:159], 0
ds_read_b64_tr_b16 a[208:209], v20 offset:4096
v_mfma_f32_16x16x32_bf16 v[76:79], a[196:199], v[160:163], 0
v_mfma_f32_16x16x32_bf16 v[80:83], a[196:199], v[164:167], 0
ds_read_b64_tr_b16 a[210:211], v20 offset:6144
v_mfma_f32_16x16x32_bf16 v[84:87], a[196:199], v[168:171], 0
ds_read_b128 v[180:183], v19 offset:0
buffer_load_dwordx4 v16, s[8:11], s55 offen offset:2048 lds
v_mfma_f32_16x16x32_bf16 v[88:91], a[196:199], v[172:175], 0
v_mfma_f32_16x16x32_bf16 v[92:95], a[196:199], v[176:179], 0
ds_read_b128 v[184:187], v19 offset:2048
s_waitcnt lgkmcnt(4)
v_mfma_f32_16x16x32_bf16 v[96:99], a[200:203], v[152:155], 0
ds_read_b128 v[188:191], v19 offset:4096
v_mfma_f32_16x16x32_bf16 v[100:103], a[200:203], v[156:159], 0
v_mfma_f32_16x16x32_bf16 v[104:107], a[200:203], v[160:163], 0
ds_read_b128 v[192:195], v19 offset:6144
buffer_load_dwordx4 v17, s[8:11], s55 offen offset:3072 lds
s_lshr_b64 s[96:97], s[96:97], 4
s_and_b32 s55, s96, 15
s_lshl_b32 s55, s55, 17
v_mfma_f32_16x16x32_bf16 v[108:111], a[200:203], v[164:167], 0
ds_read_b128 v[196:199], v19 offset:8192
v_mfma_f32_16x16x32_bf16 v[112:115], a[200:203], v[168:171], 0
ds_read_b128 v[200:203], v19 offset:10240
v_mfma_f32_16x16x32_bf16 v[116:119], a[200:203], v[172:175], 0
v_mfma_f32_16x16x32_bf16 v[120:123], a[200:203], v[176:179], 0
ds_read_b128 v[204:207], v19 offset:12288
v_mfma_f32_16x16x32_bf16 v[124:127], a[204:207], v[152:155], 0
ds_read_b64_tr_b16 a[212:213], v21 offset:4096
s_add_u32 m0, s52, 69632
s_nop 0
buffer_load_dwordx4 v14, s[8:11], s86 offen offset:0 lds
v_mfma_f32_16x16x32_bf16 v[128:131], a[204:207], v[156:159], 0
v_mfma_f32_16x16x32_bf16 v[132:135], a[204:207], v[160:163], 0
ds_read_b64_tr_b16 a[214:215], v21 offset:6144
v_mfma_f32_16x16x32_bf16 v[136:139], a[204:207], v[164:167], 0
ds_read_b64_tr_b16 a[216:217], v22 offset:4096
v_mfma_f32_16x16x32_bf16 v[140:143], a[204:207], v[168:171], 0
v_mfma_f32_16x16x32_bf16 v[144:147], a[204:207], v[172:175], 0
ds_read_b64_tr_b16 a[218:219], v22 offset:6144
buffer_load_dwordx4 v15, s[8:11], s86 offen offset:1024 lds
v_mfma_f32_16x16x32_bf16 v[148:151], a[204:207], v[176:179], 0
ds_read_b64_tr_b16 a[220:221], v23 offset:4096
s_waitcnt lgkmcnt(5)
v_mfma_f32_16x16x32_bf16 v[40:43], a[208:211], v[180:183], v[40:43]
v_mfma_f32_16x16x32_bf16 v[44:47], a[208:211], v[184:187], v[44:47]
ds_read_b64_tr_b16 a[222:223], v23 offset:6144
v_mfma_f32_16x16x32_bf16 v[48:51], a[208:211], v[188:191], v[48:51]
buffer_load_dwordx4 v16, s[8:11], s86 offen offset:2048 lds
v_mfma_f32_16x16x32_bf16 v[52:55], a[208:211], v[192:195], v[52:55]
v_mfma_f32_16x16x32_bf16 v[56:59], a[208:211], v[196:199], v[56:59]
v_mfma_f32_16x16x32_bf16 v[60:63], a[208:211], v[200:203], v[60:63]
v_mfma_f32_16x16x32_bf16 v[64:67], a[208:211], v[204:207], v[64:67]
s_waitcnt lgkmcnt(0)
v_mfma_f32_16x16x32_bf16 v[68:71], a[212:215], v[180:183], v[68:71]
buffer_load_dwordx4 v17, s[8:11], s86 offen offset:3072 lds
v_mfma_f32_16x16x32_bf16 v[72:75], a[212:215], v[184:187], v[72:75]
v_mfma_f32_16x16x32_bf16 v[76:79], a[212:215], v[188:191], v[76:79]
v_mfma_f32_16x16x32_bf16 v[80:83], a[212:215], v[192:195], v[80:83]
v_mfma_f32_16x16x32_bf16 v[84:87], a[212:215], v[196:199], v[84:87]
v_mfma_f32_16x16x32_bf16 v[88:91], a[212:215], v[200:203], v[88:91]
s_waitcnt vmcnt(8) lgkmcnt(0)
s_barrier
s_cmp_lg_u32 s32, 0
s_cbranch_scc1 L_sig_63
s_lshl_b32 s45, s39, 3
s_add_u32 s45, s45, s92
v_lshlrev_b32 v7, 3, v1
v_add_u32 v7, s92, v7
s_mov_b64 exec, 1
s_cmp_lg_u32 s91, 0
s_cbranch_scc1 L_tagok_65
v_mov_b32 v6, 0
s_mov_b32 s83, 0
L_tag_64:
global_load_dwordx2 v[4:5], v6, s[40:41] sc1
s_waitcnt vmcnt(0)
v_readfirstlane_b32 s90, v4
v_readfirstlane_b32 s91, v5
s_add_u32 s83, s83, 1
s_cmp_lg_u32 s91, 0
s_cbranch_scc1 L_tagok_65
s_sleep 4
s_cmp_lt_u32 s83, 0x4000
s_cbranch_scc1 L_tag_64
L_tagok_65:
v_mov_b32 v6, s45
v_mov_b32 v4, s90
v_mov_b32 v5, s91
global_store_dwordx2 v6, v[4:5], s[42:43] sc1
s_mov_b64 exec, -1
L_sig_63:
ds_read_b64_tr_b16 a[192:193], v20 offset:32768
v_mfma_f32_16x16x32_bf16 v[92:95], a[212:215], v[204:207], v[92:95]
ds_read_b64_tr_b16 a[194:195], v20 offset:34816
v_mfma_f32_16x16x32_bf16 v[96:99], a[216:219], v[180:183], v[96:99]
ds_read_b128 v[152:155], v18 offset:16384
v_mfma_f32_16x16x32_bf16 v[100:103], a[216:219], v[184:187], v[100:103]
s_add_u32 m0, s52, 0
s_add_u32 s86, s55, 65536
buffer_load_dwordx4 v14, s[8:11], s55 offen offset:0 lds
v_mfma_f32_16x16x32_bf16 v[104:107], a[216:219], v[188:191], v[104:107]
ds_read_b128 v[156:159], v18 offset:18432
v_mfma_f32_16x16x32_bf16 v[108:111], a[216:219], v[192:195], v[108:111]
ds_read_b128 v[160:163], v18 offset:20480
v_mfma_f32_16x16x32_bf16 v[112:115], a[216:219], v[196:199], v[112:115]
ds_read_b128 v[164:167], v18 offset:22528
v_mfma_f32_16x16x32_bf16 v[116:119], a[216:219], v[200:203], v[116:119]
ds_read_b128 v[168:171], v18 offset:24576
v_mfma_f32_16x16x32_bf16 v[120:123], a[216:219], v[204:207], v[120:123]
ds_read_b128 v[172:175], v18 offset:26624
buffer_load_dwordx4 v15, s[8:11], s55 offen offset:1024 lds
v_mfma_f32_16x16x32_bf16 v[124:127], a[220:223], v[180:183], v[124:127]
v_mfma_f32_16x16x32_bf16 v[128:131], a[220:223], v[184:187], v[128:131]
ds_read_b128 v[176:179], v18 offset:28672
v_mfma_f32_16x16x32_bf16 v[132:135], a[220:223], v[188:191], v[132:135]
ds_read_b64_tr_b16 a[196:197], v21 offset:32768
v_mfma_f32_16x16x32_bf16 v[136:139], a[220:223], v[192:195], v[136:139]
ds_read_b64_tr_b16 a[198:199], v21 offset:34816
v_mfma_f32_16x16x32_bf16 v[140:143], a[220:223], v[196:199], v[140:143]
buffer_load_dwordx4 v16, s[8:11], s55 offen offset:2048 lds
v_mfma_f32_16x16x32_bf16 v[144:147], a[220:223], v[200:203], v[144:147]
v_mfma_f32_16x16x32_bf16 v[148:151], a[220:223], v[204:207], v[148:151]
s_waitcnt lgkmcnt(2)
v_mfma_f32_16x16x32_bf16 v[40:43], a[192:195], v[152:155], v[40:43]
v_mfma_f32_16x16x32_bf16 v[44:47], a[192:195], v[156:159], v[44:47]
v_mfma_f32_16x16x32_bf16 v[48:51], a[192:195], v[160:163], v[48:51]
ds_read_b64_tr_b16 a[200:201], v22 offset:32768
v_mfma_f32_16x16x32_bf16 v[52:55], a[192:195], v[164:167], v[52:55]
buffer_load_dwordx4 v17, s[8:11], s55 offen offset:3072 lds
s_lshr_b64 s[96:97], s[96:97], 4
s_and_b32 s55, s96, 15
s_lshl_b32 s55, s55, 17
v_mfma_f32_16x16x32_bf16 v[56:59], a[192:195], v[168:171], v[56:59]
ds_read_b64_tr_b16 a[202:203], v22 offset:34816
v_mfma_f32_16x16x32_bf16 v[60:63], a[192:195], v[172:175], v[60:63]
ds_read_b64_tr_b16 a[204:205], v23 offset:32768
v_mfma_f32_16x16x32_bf16 v[64:67], a[192:195], v[176:179], v[64:67]
s_waitcnt lgkmcnt(3)
v_mfma_f32_16x16x32_bf16 v[68:71], a[196:199], v[152:155], v[68:71]
ds_read_b64_tr_b16 a[206:207], v23 offset:34816
v_mfma_f32_16x16x32_bf16 v[72:75], a[196:199], v[156:159], v[72:75]
ds_read_b64_tr_b16 a[208:209], v20 offset:36864
v_mfma_f32_16x16x32_bf16 v[76:79], a[196:199], v[160:163], v[76:79]
v_mfma_f32_16x16x32_bf16 v[80:83], a[196:199], v[164:167], v[80:83]
ds_read_b64_tr_b16 a[210:211], v20 offset:38912
v_mfma_f32_16x16x32_bf16 v[84:87], a[196:199], v[168:171], v[84:87]
ds_read_b128 v[180:183], v19 offset:16384
s_add_u32 m0, s52, 4096
s_nop 0
buffer_load_dwordx4 v14, s[8:11], s86 offen offset:0 lds
v_mfma_f32_16x16x32_bf16 v[88:91], a[196:199], v[172:175], v[88:91]
v_mfma_f32_16x16x32_bf16 v[92:95], a[196:199], v[176:179], v[92:95]
ds_read_b128 v[184:187], v19 offset:18432
s_waitcnt lgkmcnt(4)
v_mfma_f32_16x16x32_bf16 v[96:99], a[200:203], v[152:155], v[96:99]
ds_read_b128 v[188:191], v19 offset:20480
v_mfma_f32_16x16x32_bf16 v[100:103], a[200:203], v[156:159], v[100:103]
v_mfma_f32_16x16x32_bf16 v[104:107], a[200:203], v[160:163], v[104:107]
ds_read_b128 v[192:195], v19 offset:22528
v_mfma_f32_16x16x32_bf16 v[108:111], a[200:203], v[164:167], v[108:111]
ds_read_b128 v[196:199], v19 offset:24576
v_mfma_f32_16x16x32_bf16 v[112:115], a[200:203], v[168:171], v[112:115]
ds_read_b128 v[200:203], v19 offset:26624
v_mfma_f32_16x16x32_bf16 v[116:119], a[200:203], v[172:175], v[116:119]
buffer_load_dwordx4 v15, s[8:11], s86 offen offset:1024 lds
v_mfma_f32_16x16x32_bf16 v[120:123], a[200:203], v[176:179], v[120:123]
ds_read_b128 v[204:207], v19 offset:28672
v_mfma_f32_16x16x32_bf16 v[124:127], a[204:207], v[152:155], v[124:127]
ds_read_b64_tr_b16 a[212:213], v21 offset:36864
v_mfma_f32_16x16x32_bf16 v[128:131], a[204:207], v[156:159], v[128:131]
v_mfma_f32_16x16x32_bf16 v[132:135], a[204:207], v[160:163], v[132:135]
ds_read_b64_tr_b16 a[214:215], v21 offset:38912
v_mfma_f32_16x16x32_bf16 v[136:139], a[204:207], v[164:167], v[136:139]
ds_read_b64_tr_b16 a[216:217], v22 offset:36864
v_mfma_f32_16x16x32_bf16 v[140:143], a[204:207], v[168:171], v[140:143]
v_mfma_f32_16x16x32_bf16 v[144:147], a[204:207], v[172:175], v[144:147]
ds_read_b64_tr_b16 a[218:219], v22 offset:38912
buffer_load_dwordx4 v16, s[8:11], s86 offen offset:2048 lds
v_mfma_f32_16x16x32_bf16 v[148:151], a[204:207], v[176:179], v[148:151]
ds_read_b64_tr_b16 a[220:221], v23 offset:36864
s_waitcnt lgkmcnt(5)
v_mfma_f32_16x16x32_bf16 v[40:43], a[208:211], v[180:183], v[40:43]
v_mfma_f32_16x16x32_bf16 v[44:47], a[208:211], v[184:187], v[44:47]
ds_read_b64_tr_b16 a[222:223], v23 offset:38912
v_mfma_f32_16x16x32_bf16 v[48:51], a[208:211], v[188:191], v[48:51]
v_mfma_f32_16x16x32_bf16 v[52:55], a[208:211], v[192:195], v[52:55]
v_mfma_f32_16x16x32_bf16 v[56:59], a[208:211], v[196:199], v[56:59]
v_mfma_f32_16x16x32_bf16 v[60:63], a[208:211], v[200:203], v[60:63]
v_mfma_f32_16x16x32_bf16 v[64:67], a[208:211], v[204:207], v[64:67]
buffer_load_dwordx4 v17, s[8:11], s86 offen offset:3072 lds
s_waitcnt lgkmcnt(0)
v_mfma_f32_16x16x32_bf16 v[68:71], a[212:215], v[180:183], v[68:71]
v_mfma_f32_16x16x32_bf16 v[72:75], a[212:215], v[184:187], v[72:75]
v_mfma_f32_16x16x32_bf16 v[76:79], a[212:215], v[188:191], v[76:79]
v_mfma_f32_16x16x32_bf16 v[80:83], a[212:215], v[192:195], v[80:83]
v_mfma_f32_16x16x32_bf16 v[84:87], a[212:215], v[196:199], v[84:87]
v_mfma_f32_16x16x32_bf16 v[88:91], a[212:215], v[200:203], v[88:91]
s_cmp_lg_u32 s32, 0
s_cbranch_scc1 L_wend_66
s_mov_b64 exec, 15
s_lshl_b32 s47, 1, s39
s_mov_b32 s83, 0
global_load_dwordx2 v[8:9], v7, s[42:43] sc1
s_sleep 4
L_spin_67:
global_load_dwordx2 v[4:5], v7, s[42:43] sc1
s_waitcnt vmcnt(1)
v_cmp_eq_u64 vcc, s[90:91], v[8:9]
s_add_u32 s83, s83, 1
s_or_b32 s46, vcc_lo, s47
s_cmp_eq_u32 s46, 15
s_cbranch_scc1 L_go_68
global_load_dwordx2 v[8:9], v7, s[42:43] sc1
s_waitcnt vmcnt(1)
v_cmp_eq_u64 vcc, s[90:91], v[4:5]
s_add_u32 s83, s83, 1
s_or_b32 s46, vcc_lo, s47
s_cmp_eq_u32 s46, 15
s_cbranch_scc1 L_go_68
s_cmp_lt_u32 s83, 0x8000
s_cbranch_scc1 L_spin_67
L_go_68:
s_mov_b64 exec, -1
L_wend_66:
s_waitcnt vmcnt(8) lgkmcnt(0)
s_barrier
ds_read_b64_tr_b16 a[192:193], v24 offset:0
v_mfma_f32_16x16x32_bf16 v[92:95], a[212:215], v[204:207], v[92:95]
ds_read_b64_tr_b16 a[194:195], v24 offset:2048
v_mfma_f32_16x16x32_bf16 v[96:99], a[216:219], v[180:183], v[96:99]
ds_read_b128 v[152:155], v18 offset:32768
v_mfma_f32_16x16x32_bf16 v[100:103], a[216:219], v[184:187], v[100:103]
s_add_u32 m0, s52, 32768
s_add_u32 s86, s55, 65536
buffer_load_dwordx4 v14, s[8:11], s55 offen offset:0 lds
v_mfma_f32_16x16x32_bf16 v[104:107], a[216:219], v[188:191], v[104:107]
ds_read_b128 v[156:159], v18 offset:34816
v_mfma_f32_16x16x32_bf16 v[108:111], a[216:219], v[192:195], v[108:111]
ds_read_b128 v[160:163], v18 offset:36864
v_mfma_f32_16x16x32_bf16 v[112:115], a[216:219], v[196:199], v[112:115]
ds_read_b128 v[164:167], v18 offset:38912
v_mfma_f32_16x16x32_bf16 v[116:119], a[216:219], v[200:203], v[116:119]
ds_read_b128 v[168:171], v18 offset:40960
v_mfma_f32_16x16x32_bf16 v[120:123], a[216:219], v[204:207], v[120:123]
ds_read_b128 v[172:175], v18 offset:43008
buffer_load_dwordx4 v15, s[8:11], s55 offen offset:1024 lds
v_mfma_f32_16x16x32_bf16 v[124:127], a[220:223], v[180:183], v[124:127]
v_mfma_f32_16x16x32_bf16 v[128:131], a[220:223], v[184:187], v[128:131]
ds_read_b128 v[176:179], v18 offset:45056
v_mfma_f32_16x16x32_bf16 v[132:135], a[220:223], v[188:191], v[132:135]
ds_read_b64_tr_b16 a[196:197], v25 offset:0
v_mfma_f32_16x16x32_bf16 v[136:139], a[220:223], v[192:195], v[136:139]
ds_read_b64_tr_b16 a[198:199], v25 offset:2048
v_mfma_f32_16x16x32_bf16 v[140:143], a[220:223], v[196:199], v[140:143]
buffer_load_dwordx4 v16, s[8:11], s55 offen offset:2048 lds
v_mfma_f32_16x16x32_bf16 v[144:147], a[220:223], v[200:203], v[144:147]
v_mfma_f32_16x16x32_bf16 v[148:151], a[220:223], v[204:207], v[148:151]
s_waitcnt lgkmcnt(2)
v_mfma_f32_16x16x32_bf16 v[40:43], a[192:195], v[152:155], v[40:43]
v_mfma_f32_16x16x32_bf16 v[44:47], a[192:195], v[156:159], v[44:47]
v_mfma_f32_16x16x32_bf16 v[48:51], a[192:195], v[160:163], v[48:51]
ds_read_b64_tr_b16 a[200:201], v26 offset:0
buffer_load_dwordx4 v17, s[8:11], s55 offen offset:3072 lds
s_lshr_b64 s[96:97], s[96:97], 4
s_and_b32 s55, s96, 15
s_lshl_b32 s55, s55, 17
v_mfma_f32_16x16x32_bf16 v[52:55], a[192:195], v[164:167], v[52:55]
v_mfma_f32_16x16x32_bf16 v[56:59], a[192:195], v[168:171], v[56:59]
ds_read_b64_tr_b16 a[202:203], v26 offset:2048
v_mfma_f32_16x16x32_bf16 v[60:63], a[192:195], v[172:175], v[60:63]
ds_read_b64_tr_b16 a[204:205], v27 offset:0
v_mfma_f32_16x16x32_bf16 v[64:67], a[192:195], v[176:179], v[64:67]
s_add_u32 m0, s52, 36864
s_nop 0
buffer_load_dwordx4 v14, s[8:11], s86 offen offset:0 lds
s_waitcnt lgkmcnt(3)
v_mfma_f32_16x16x32_bf16 v[68:71], a[196:199], v[152:155], v[68:71]
ds_read_b64_tr_b16 a[206:207], v27 offset:2048
v_mfma_f32_16x16x32_bf16 v[72:75], a[196:199], v[156:159], v[72:75]
ds_read_b64_tr_b16 a[208:209], v24 offset:4096
v_mfma_f32_16x16x32_bf16 v[76:79], a[196:199], v[160:163], v[76:79]
v_mfma_f32_16x16x32_bf16 v[80:83], a[196:199], v[164:167], v[80:83]
ds_read_b64_tr_b16 a[210:211], v24 offset:6144
buffer_load_dwordx4 v15, s[8:11], s86 offen offset:1024 lds
v_mfma_f32_16x16x32_bf16 v[84:87], a[196:199], v[168:171], v[84:87]
ds_read_b128 v[180:183], v19 offset:32768
v_mfma_f32_16x16x32_bf16 v[88:91], a[196:199], v[172:175], v[88:91]
v_mfma_f32_16x16x32_bf16 v[92:95], a[196:199], v[176:179], v[92:95]
ds_read_b128 v[184:187], v19 offset:34816
s_waitcnt lgkmcnt(4)
v_mfma_f32_16x16x32_bf16 v[96:99], a[200:203], v[152:155], v[96:99]
ds_read_b128 v[188:191], v19 offset:36864
buffer_load_dwordx4 v16, s[8:11], s86 offen offset:2048 lds
v_mfma_f32_16x16x32_bf16 v[100:103], a[200:203], v[156:159], v[100:103]
v_mfma_f32_16x16x32_bf16 v[104:107], a[200:203], v[160:163], v[104:107]
ds_read_b128 v[192:195], v19 offset:38912
v_mfma_f32_16x16x32_bf16 v[108:111], a[200:203], v[164:167], v[108:111]
ds_read_b128 v[196:199], v19 offset:40960
v_mfma_f32_16x16x32_bf16 v[112:115], a[200:203], v[168:171], v[112:115]
ds_read_b128 v[200:203], v19 offset:43008
v_mfma_f32_16x16x32_bf16 v[116:119], a[200:203], v[172:175], v[116:119]
buffer_load_dwordx4 v17, s[8:11], s86 offen offset:3072 lds
v_mfma_f32_16x16x32_bf16 v[120:123], a[200:203], v[176:179], v[120:123]
ds_read_b128 v[204:207], v19 offset:45056
v_mfma_f32_16x16x32_bf16 v[124:127], a[204:207], v[152:155], v[124:127]
ds_read_b64_tr_b16 a[212:213], v25 offset:4096
v_mfma_f32_16x16x32_bf16 v[128:131], a[204:207], v[156:159], v[128:131]
v_mfma_f32_16x16x32_bf16 v[132:135], a[204:207], v[160:163], v[132:135]
ds_read_b64_tr_b16 a[214:215], v25 offset:6144
s_add_u32 m0, s80, 114688
s_nop 0
buffer_load_dwordx4 v10, s[20:23], s54 offen offset:0 sc1 lds
v_mfma_f32_16x16x32_bf16 v[136:139], a[204:207], v[164:167], v[136:139]
ds_read_b64_tr_b16 a[216:217], v26 offset:4096
v_mfma_f32_16x16x32_bf16 v[140:143], a[204:207], v[168:171], v[140:143]
v_mfma_f32_16x16x32_bf16 v[144:147], a[204:207], v[172:175], v[144:147]
ds_read_b64_tr_b16 a[218:219], v26 offset:6144
v_mfma_f32_16x16x32_bf16 v[148:151], a[204:207], v[176:179], v[148:151]
ds_read_b64_tr_b16 a[220:221], v27 offset:4096
buffer_load_dwordx4 v11, s[20:23], s54 offen offset:1024 sc1 lds
s_waitcnt lgkmcnt(5)
v_mfma_f32_16x16x32_bf16 v[40:43], a[208:211], v[180:183], v[40:43]
v_mfma_f32_16x16x32_bf16 v[44:47], a[208:211], v[184:187], v[44:47]
ds_read_b64_tr_b16 a[222:223], v27 offset:6144
v_mfma_f32_16x16x32_bf16 v[48:51], a[208:211], v[188:191], v[48:51]
v_mfma_f32_16x16x32_bf16 v[52:55], a[208:211], v[192:195], v[52:55]
buffer_load_dwordx4 v12, s[20:23], s54 offen offset:2048 sc1 lds
v_mfma_f32_16x16x32_bf16 v[56:59], a[208:211], v[196:199], v[56:59]
v_mfma_f32_16x16x32_bf16 v[60:63], a[208:211], v[200:203], v[60:63]
v_mfma_f32_16x16x32_bf16 v[64:67], a[208:211], v[204:207], v[64:67]
s_waitcnt lgkmcnt(0)
v_mfma_f32_16x16x32_bf16 v[68:71], a[212:215], v[180:183], v[68:71]
buffer_load_dwordx4 v13, s[20:23], s54 offen offset:3072 sc1 lds
s_lshr_b64 s[98:99], s[98:99], 4
s_and_b32 s54, s98, 15
s_lshl_b32 s54, s54, 11
v_mfma_f32_16x16x32_bf16 v[72:75], a[212:215], v[184:187], v[72:75]
v_mfma_f32_16x16x32_bf16 v[76:79], a[212:215], v[188:191], v[76:79]
v_mfma_f32_16x16x32_bf16 v[80:83], a[212:215], v[192:195], v[80:83]
v_mfma_f32_16x16x32_bf16 v[84:87], a[212:215], v[196:199], v[84:87]
v_mfma_f32_16x16x32_bf16 v[88:91], a[212:215], v[200:203], v[88:91]
s_waitcnt vmcnt(12) lgkmcnt(0)
s_barrier
ds_read_b64_tr_b16 a[192:193], v20 offset:0
v_mfma_f32_16x16x32_bf16 v[92:95], a[212:215], v[204:207], v[92:95]
ds_read_b64_tr_b16 a[194:195], v20 offset:2048
v_mfma_f32_16x16x32_bf16 v[96:99], a[216:219], v[180:183], v[96:99]
ds_read_b128 v[152:155], v18 offset:49152
v_mfma_f32_16x16x32_bf16 v[100:103], a[216:219], v[184:187], v[100:103]
s_add_u32 m0, s52, 65536
s_add_u32 s86, s55, 65536
buffer_load_dwordx4 v14, s[8:11], s55 offen offset:0 lds
v_mfma_f32_16x16x32_bf16 v[104:107], a[216:219], v[188:191], v[104:107]
ds_read_b128 v[156:159], v18 offset:51200
v_mfma_f32_16x16x32_bf16 v[108:111], a[216:219], v[192:195], v[108:111]
ds_read_b128 v[160:163], v18 offset:53248
v_mfma_f32_16x16x32_bf16 v[112:115], a[216:219], v[196:199], v[112:115]
ds_read_b128 v[164:167], v18 offset:55296
v_mfma_f32_16x16x32_bf16 v[116:119], a[216:219], v[200:203], v[116:119]
ds_read_b128 v[168:171], v18 offset:57344
v_mfma_f32_16x16x32_bf16 v[120:123], a[216:219], v[204:207], v[120:123]
ds_read_b128 v[172:175], v18 offset:59392
buffer_load_dwordx4 v15, s[8:11], s55 offen offset:1024 lds
v_mfma_f32_16x16x32_bf16 v[124:127], a[220:223], v[180:183], v[124:127]
v_mfma_f32_16x16x32_bf16 v[128:131], a[220:223], v[184:187], v[128:131]
ds_read_b128 v[176:179], v18 offset:61440
v_mfma_f32_16x16x32_bf16 v[132:135], a[220:223], v[188:191], v[132:135]
ds_read_b64_tr_b16 a[196:197], v21 offset:0
v_mfma_f32_16x16x32_bf16 v[136:139], a[220:223], v[192:195], v[136:139]
ds_read_b64_tr_b16 a[198:199], v21 offset:2048
v_mfma_f32_16x16x32_bf16 v[140:143], a[220:223], v[196:199], v[140:143]
buffer_load_dwordx4 v16, s[8:11], s55 offen offset:2048 lds
v_mfma_f32_16x16x32_bf16 v[144:147], a[220:223], v[200:203], v[144:147]
v_mfma_f32_16x16x32_bf16 v[148:151], a[220:223], v[204:207], v[148:151]
s_waitcnt lgkmcnt(2)
v_mfma_f32_16x16x32_bf16 v[40:43], a[192:195], v[152:155], v[40:43]
v_mfma_f32_16x16x32_bf16 v[44:47], a[192:195], v[156:159], v[44:47]
v_mfma_f32_16x16x32_bf16 v[48:51], a[192:195], v[160:163], v[48:51]
ds_read_b64_tr_b16 a[200:201], v22 offset:0
buffer_load_dwordx4 v17, s[8:11], s55 offen offset:3072 lds
s_lshr_b64 s[96:97], s[96:97], 4
s_and_b32 s55, s96, 15
s_lshl_b32 s55, s55, 17
v_mfma_f32_16x16x32_bf16 v[52:55], a[192:195], v[164:167], v[52:55]
v_mfma_f32_16x16x32_bf16 v[56:59], a[192:195], v[168:171], v[56:59]
ds_read_b64_tr_b16 a[202:203], v22 offset:2048
v_mfma_f32_16x16x32_bf16 v[60:63], a[192:195], v[172:175], v[60:63]
ds_read_b64_tr_b16 a[204:205], v23 offset:0
v_mfma_f32_16x16x32_bf16 v[64:67], a[192:195], v[176:179], v[64:67]
s_add_u32 m0, s52, 69632
s_nop 0
buffer_load_dwordx4 v14, s[8:11], s86 offen offset:0 lds
s_waitcnt lgkmcnt(3)
v_mfma_f32_16x16x32_bf16 v[68:71], a[196:199], v[152:155], v[68:71]
ds_read_b64_tr_b16 a[206:207], v23 offset:2048
v_mfma_f32_16x16x32_bf16 v[72:75], a[196:199], v[156:159], v[72:75]
ds_read_b64_tr_b16 a[208:209], v20 offset:4096
v_mfma_f32_16x16x32_bf16 v[76:79], a[196:199], v[160:163], v[76:79]
v_mfma_f32_16x16x32_bf16 v[80:83], a[196:199], v[164:167], v[80:83]
ds_read_b64_tr_b16 a[210:211], v20 offset:6144
buffer_load_dwordx4 v15, s[8:11], s86 offen offset:1024 lds
v_mfma_f32_16x16x32_bf16 v[84:87], a[196:199], v[168:171], v[84:87]
ds_read_b128 v[180:183], v19 offset:49152
v_mfma_f32_16x16x32_bf16 v[88:91], a[196:199], v[172:175], v[88:91]
v_mfma_f32_16x16x32_bf16 v[92:95], a[196:199], v[176:179], v[92:95]
ds_read_b128 v[184:187], v19 offset:51200
s_waitcnt lgkmcnt(4)
v_mfma_f32_16x16x32_bf16 v[96:99], a[200:203], v[152:155], v[96:99]
ds_read_b128 v[188:191], v19 offset:53248
buffer_load_dwordx4 v16, s[8:11], s86 offen offset:2048 lds
v_mfma_f32_16x16x32_bf16 v[100:103], a[200:203], v[156:159], v[100:103]
v_mfma_f32_16x16x32_bf16 v[104:107], a[200:203], v[160:163], v[104:107]
ds_read_b128 v[192:195], v19 offset:55296
v_mfma_f32_16x16x32_bf16 v[108:111], a[200:203], v[164:167], v[108:111]
ds_read_b128 v[196:199], v19 offset:57344
v_mfma_f32_16x16x32_bf16 v[112:115], a[200:203], v[168:171], v[112:115]
ds_read_b128 v[200:203], v19 offset:59392
v_mfma_f32_16x16x32_bf16 v[116:119], a[200:203], v[172:175], v[116:119]
buffer_load_dwordx4 v17, s[8:11], s86 offen offset:3072 lds
v_mfma_f32_16x16x32_bf16 v[120:123], a[200:203], v[176:179], v[120:123]
ds_read_b128 v[204:207], v19 offset:61440
v_mfma_f32_16x16x32_bf16 v[124:127], a[204:207], v[152:155], v[124:127]
ds_read_b64_tr_b16 a[212:213], v21 offset:4096
v_mfma_f32_16x16x32_bf16 v[128:131], a[204:207], v[156:159], v[128:131]
v_mfma_f32_16x16x32_bf16 v[132:135], a[204:207], v[160:163], v[132:135]
ds_read_b64_tr_b16 a[214:215], v21 offset:6144
s_add_u32 m0, s80, 131072
s_nop 0
buffer_load_dwordx4 v10, s[20:23], s54 offen offset:0 sc1 lds
v_mfma_f32_16x16x32_bf16 v[136:139], a[204:207], v[164:167], v[136:139]
ds_read_b64_tr_b16 a[216:217], v22 offset:4096
v_mfma_f32_16x16x32_bf16 v[140:143], a[204:207], v[168:171], v[140:143]
v_mfma_f32_16x16x32_bf16 v[144:147], a[204:207], v[172:175], v[144:147]
ds_read_b64_tr_b16 a[218:219], v22 offset:6144
v_mfma_f32_16x16x32_bf16 v[148:151], a[204:207], v[176:179], v[148:151]
ds_read_b64_tr_b16 a[220:221], v23 offset:4096
buffer_load_dwordx4 v11, s[20:23], s54 offen offset:1024 sc1 lds
s_waitcnt lgkmcnt(5)
v_mfma_f32_16x16x32_bf16 v[40:43], a[208:211], v[180:183], v[40:43]
v_mfma_f32_16x16x32_bf16 v[44:47], a[208:211], v[184:187], v[44:47]
ds_read_b64_tr_b16 a[222:223], v23 offset:6144
v_mfma_f32_16x16x32_bf16 v[48:51], a[208:211], v[188:191], v[48:51]
v_mfma_f32_16x16x32_bf16 v[52:55], a[208:211], v[192:195], v[52:55]
buffer_load_dwordx4 v12, s[20:23], s54 offen offset:2048 sc1 lds
v_mfma_f32_16x16x32_bf16 v[56:59], a[208:211], v[196:199], v[56:59]
v_mfma_f32_16x16x32_bf16 v[60:63], a[208:211], v[200:203], v[60:63]
v_mfma_f32_16x16x32_bf16 v[64:67], a[208:211], v[204:207], v[64:67]
s_waitcnt lgkmcnt(0)
v_mfma_f32_16x16x32_bf16 v[68:71], a[212:215], v[180:183], v[68:71]
buffer_load_dwordx4 v13, s[20:23], s54 offen offset:3072 sc1 lds
s_lshr_b64 s[98:99], s[98:99], 4
s_and_b32 s54, s98, 15
s_lshl_b32 s54, s54, 11
v_mfma_f32_16x16x32_bf16 v[72:75], a[212:215], v[184:187], v[72:75]
v_mfma_f32_16x16x32_bf16 v[76:79], a[212:215], v[188:191], v[76:79]
v_mfma_f32_16x16x32_bf16 v[80:83], a[212:215], v[192:195], v[80:83]
v_mfma_f32_16x16x32_bf16 v[84:87], a[212:215], v[196:199], v[84:87]
v_mfma_f32_16x16x32_bf16 v[88:91], a[212:215], v[200:203], v[88:91]
s_waitcnt vmcnt(12) lgkmcnt(0)
s_barrier
ds_read_b64_tr_b16 a[192:193], v20 offset:32768
v_mfma_f32_16x16x32_bf16 v[92:95], a[212:215], v[204:207], v[92:95]
ds_read_b64_tr_b16 a[194:195], v20 offset:34816
v_mfma_f32_16x16x32_bf16 v[96:99], a[216:219], v[180:183], v[96:99]
ds_read_b128 v[152:155], v18 offset:16384
v_mfma_f32_16x16x32_bf16 v[100:103], a[216:219], v[184:187], v[100:103]
s_add_u32 m0, s52, 0
s_add_u32 s86, s55, 65536
buffer_load_dwordx4 v14, s[8:11], s55 offen offset:0 lds
v_mfma_f32_16x16x32_bf16 v[104:107], a[216:219], v[188:191], v[104:107]
ds_read_b128 v[156:159], v18 offset:18432
v_mfma_f32_16x16x32_bf16 v[108:111], a[216:219], v[192:195], v[108:111]
ds_read_b128 v[160:163], v18 offset:20480
v_mfma_f32_16x16x32_bf16 v[112:115], a[216:219], v[196:199], v[112:115]
ds_read_b128 v[164:167], v18 offset:22528
v_mfma_f32_16x16x32_bf16 v[116:119], a[216:219], v[200:203], v[116:119]
ds_read_b128 v[168:171], v18 offset:24576
v_mfma_f32_16x16x32_bf16 v[120:123], a[216:219], v[204:207], v[120:123]
ds_read_b128 v[172:175], v18 offset:26624
buffer_load_dwordx4 v15, s[8:11], s55 offen offset:1024 lds
v_mfma_f32_16x16x32_bf16 v[124:127], a[220:223], v[180:183], v[124:127]
v_mfma_f32_16x16x32_bf16 v[128:131], a[220:223], v[184:187], v[128:131]
ds_read_b128 v[176:179], v18 offset:28672
v_mfma_f32_16x16x32_bf16 v[132:135], a[220:223], v[188:191], v[132:135]
ds_read_b64_tr_b16 a[196:197], v21 offset:32768
v_mfma_f32_16x16x32_bf16 v[136:139], a[220:223], v[192:195], v[136:139]
ds_read_b64_tr_b16 a[198:199], v21 offset:34816
v_mfma_f32_16x16x32_bf16 v[140:143], a[220:223], v[196:199], v[140:143]
buffer_load_dwordx4 v16, s[8:11], s55 offen offset:2048 lds
v_mfma_f32_16x16x32_bf16 v[144:147], a[220:223], v[200:203], v[144:147]
v_mfma_f32_16x16x32_bf16 v[148:151], a[220:223], v[204:207], v[148:151]
s_mov_b32 s53, 3
L_gl_69:
s_waitcnt lgkmcnt(2)
v_mfma_f32_16x16x32_bf16 v[40:43], a[192:195], v[152:155], v[40:43]
v_mfma_f32_16x16x32_bf16 v[44:47], a[192:195], v[156:159], v[44:47]
v_mfma_f32_16x16x32_bf16 v[48:51], a[192:195], v[160:163], v[48:51]
ds_read_b64_tr_b16 a[200:201], v22 offset:32768
buffer_load_dwordx4 v17, s[8:11], s55 offen offset:3072 lds
s_lshr_b64 s[96:97], s[96:97], 4
s_and_b32 s55, s96, 15
s_lshl_b32 s55, s55, 17
v_mfma_f32_16x16x32_bf16 v[52:55], a[192:195], v[164:167], v[52:55]
v_mfma_f32_16x16x32_bf16 v[56:59], a[192:195], v[168:171], v[56:59]
ds_read_b64_tr_b16 a[202:203], v22 offset:34816
v_mfma_f32_16x16x32_bf16 v[60:63], a[192:195], v[172:175], v[60:63]
ds_read_b64_tr_b16 a[204:205], v23 offset:32768
v_mfma_f32_16x16x32_bf16 v[64:67], a[192:195], v[176:179], v[64:67]
s_add_u32 m0, s52, 4096
s_nop 0
buffer_load_dwordx4 v14, s[8:11], s86 offen offset:0 lds
s_waitcnt lgkmcnt(3)
v_mfma_f32_16x16x32_bf16 v[68:71], a[196:199], v[152:155], v[68:71]
ds_read_b64_tr_b16 a[206:207], v23 offset:34816
v_mfma_f32_16x16x32_bf16 v[72:75], a[196:199], v[156:159], v[72:75]
ds_read_b64_tr_b16 a[208:209], v20 offset:36864
v_mfma_f32_16x16x32_bf16 v[76:79], a[196:199], v[160:163], v[76:79]
v_mfma_f32_16x16x32_bf16 v[80:83], a[196:199], v[164:167], v[80:83]
ds_read_b64_tr_b16 a[210:211], v20 offset:38912
buffer_load_dwordx4 v15, s[8:11], s86 offen offset:1024 lds
v_mfma_f32_16x16x32_bf16 v[84:87], a[196:199], v[168:171], v[84:87]
ds_read_b128 v[180:183], v19 offset:16384
v_mfma_f32_16x16x32_bf16 v[88:91], a[196:199], v[172:175], v[88:91]
v_mfma_f32_16x16x32_bf16 v[92:95], a[196:199], v[176:179], v[92:95]
ds_read_b128 v[184:187], v19 offset:18432
s_waitcnt lgkmcnt(4)
v_mfma_f32_16x16x32_bf16 v[96:99], a[200:203], v[152:155], v[96:99]
ds_read_b128 v[188:191], v19 offset:20480
buffer_load_dwordx4 v16, s[8:11], s86 offen offset:2048 lds
v_mfma_f32_16x16x32_bf16 v[100:103], a[200:203], v[156:159], v[100:103]
v_mfma_f32_16x16x32_bf16 v[104:107], a[200:203], v[160:163], v[104:107]
ds_read_b128 v[192:195], v19 offset:22528
v_mfma_f32_16x16x32_bf16 v[108:111], a[200:203], v[164:167], v[108:111]
ds_read_b128 v[196:199], v19 offset:24576
v_mfma_f32_16x16x32_bf16 v[112:115], a[200:203], v[168:171], v[112:115]
ds_read_b128 v[200:203], v19 offset:26624
v_mfma_f32_16x16x32_bf16 v[116:119], a[200:203], v[172:175], v[116:119]
buffer_load_dwordx4 v17, s[8:11], s86 offen offset:3072 lds
v_mfma_f32_16x16x32_bf16 v[120:123], a[200:203], v[176:179], v[120:123]
ds_read_b128 v[204:207], v19 offset:28672
v_mfma_f32_16x16x32_bf16 v[124:127], a[204:207], v[152:155], v[124:127]
ds_read_b64_tr_b16 a[212:213], v21 offset:36864
v_mfma_f32_16x16x32_bf16 v[128:131], a[204:207], v[156:159], v[128:131]
v_mfma_f32_16x16x32_bf16 v[132:135], a[204:207], v[160:163], v[132:135]
ds_read_b64_tr_b16 a[214:215], v21 offset:38912
s_add_u32 m0, s80, 98304
s_nop 0
buffer_load_dwordx4 v10, s[20:23], s54 offen offset:0 sc1 lds
v_mfma_f32_16x16x32_bf16 v[136:139], a[204:207], v[164:167], v[136:139]
ds_read_b64_tr_b16 a[216:217], v22 offset:36864
v_mfma_f32_16x16x32_bf16 v[140:143], a[204:207], v[168:171], v[140:143]
v_mfma_f32_16x16x32_bf16 v[144:147], a[204:207], v[172:175], v[144:147]
ds_read_b64_tr_b16 a[218:219], v22 offset:38912
v_mfma_f32_16x16x32_bf16 v[148:151], a[204:207], v[176:179], v[148:151]
ds_read_b64_tr_b16 a[220:221], v23 offset:36864
buffer_load_dwordx4 v11, s[20:23], s54 offen offset:1024 sc1 lds
s_waitcnt lgkmcnt(5)
v_mfma_f32_16x16x32_bf16 v[40:43], a[208:211], v[180:183], v[40:43]
v_mfma_f32_16x16x32_bf16 v[44:47], a[208:211], v[184:187], v[44:47]
ds_read_b64_tr_b16 a[222:223], v23 offset:38912
v_mfma_f32_16x16x32_bf16 v[48:51], a[208:211], v[188:191], v[48:51]
v_mfma_f32_16x16x32_bf16 v[52:55], a[208:211], v[192:195], v[52:55]
buffer_load_dwordx4 v12, s[20:23], s54 offen offset:2048 sc1 lds
v_mfma_f32_16x16x32_bf16 v[56:59], a[208:211], v[196:199], v[56:59]
v_mfma_f32_16x16x32_bf16 v[60:63], a[208:211], v[200:203], v[60:63]
v_mfma_f32_16x16x32_bf16 v[64:67], a[208:211], v[204:207], v[64:67]
s_waitcnt lgkmcnt(0)
v_mfma_f32_16x16x32_bf16 v[68:71], a[212:215], v[180:183], v[68:71]
buffer_load_dwordx4 v13, s[20:23], s54 offen offset:3072 sc1 lds
s_lshr_b64 s[98:99], s[98:99], 4
s_and_b32 s54, s98, 15
s_lshl_b32 s54, s54, 11
v_mfma_f32_16x16x32_bf16 v[72:75], a[212:215], v[184:187], v[72:75]
v_mfma_f32_16x16x32_bf16 v[76:79], a[212:215], v[188:191], v[76:79]
v_mfma_f32_16x16x32_bf16 v[80:83], a[212:215], v[192:195], v[80:83]
v_mfma_f32_16x16x32_bf16 v[84:87], a[212:215], v[196:199], v[84:87]
v_mfma_f32_16x16x32_bf16 v[88:91], a[212:215], v[200:203], v[88:91]
s_waitcnt vmcnt(12) lgkmcnt(0)
s_barrier
ds_read_b64_tr_b16 a[192:193], v24 offset:0
v_mfma_f32_16x16x32_bf16 v[92:95], a[212:215], v[204:207], v[92:95]
ds_read_b64_tr_b16 a[194:195], v24 offset:2048
v_mfma_f32_16x16x32_bf16 v[96:99], a[216:219], v[180:183], v[96:99]
ds_read_b128 v[152:155], v18 offset:32768
v_mfma_f32_16x16x32_bf16 v[100:103], a[216:219], v[184:187], v[100:103]
s_add_u32 m0, s52, 32768
s_add_u32 s86, s55, 65536
buffer_load_dwordx4 v14, s[8:11], s55 offen offset:0 lds
v_mfma_f32_16x16x32_bf16 v[104:107], a[216:219], v[188:191], v[104:107]
ds_read_b128 v[156:159], v18 offset:34816
v_mfma_f32_16x16x32_bf16 v[108:111], a[216:219], v[192:195], v[108:111]
ds_read_b128 v[160:163], v18 offset:36864
v_mfma_f32_16x16x32_bf16 v[112:115], a[216:219], v[196:199], v[112:115]
ds_read_b128 v[164:167], v18 offset:38912
v_mfma_f32_16x16x32_bf16 v[116:119], a[216:219], v[200:203], v[116:119]
ds_read_b128 v[168:171], v18 offset:40960
v_mfma_f32_16x16x32_bf16 v[120:123], a[216:219], v[204:207], v[120:123]
ds_read_b128 v[172:175], v18 offset:43008
buffer_load_dwordx4 v15, s[8:11], s55 offen offset:1024 lds
v_mfma_f32_16x16x32_bf16 v[124:127], a[220:223], v[180:183], v[124:127]
v_mfma_f32_16x16x32_bf16 v[128:131], a[220:223], v[184:187], v[128:131]
ds_read_b128 v[176:179], v18 offset:45056
v_mfma_f32_16x16x32_bf16 v[132:135], a[220:223], v[188:191], v[132:135]
ds_read_b64_tr_b16 a[196:197], v25 offset:0
v_mfma_f32_16x16x32_bf16 v[136:139], a[220:223], v[192:195], v[136:139]
ds_read_b64_tr_b16 a[198:199], v25 offset:2048
v_mfma_f32_16x16x32_bf16 v[140:143], a[220:223], v[196:199], v[140:143]
buffer_load_dwordx4 v16, s[8:11], s55 offen offset:2048 lds
v_mfma_f32_16x16x32_bf16 v[144:147], a[220:223], v[200:203], v[144:147]
v_mfma_f32_16x16x32_bf16 v[148:151], a[220:223], v[204:207], v[148:151]
s_waitcnt lgkmcnt(2)
v_mfma_f32_16x16x32_bf16 v[40:43], a[192:195], v[152:155], v[40:43]
v_mfma_f32_16x16x32_bf16 v[44:47], a[192:195], v[156:159], v[44:47]
v_mfma_f32_16x16x32_bf16 v[48:51], a[192:195], v[160:163], v[48:51]
ds_read_b64_tr_b16 a[200:201], v26 offset:0
buffer_load_dwordx4 v17, s[8:11], s55 offen offset:3072 lds
s_lshr_b64 s[96:97], s[96:97], 4
s_and_b32 s55, s96, 15
s_lshl_b32 s55, s55, 17
v_mfma_f32_16x16x32_bf16 v[52:55], a[192:195], v[164:167], v[52:55]
v_mfma_f32_16x16x32_bf16 v[56:59], a[192:195], v[168:171], v[56:59]
ds_read_b64_tr_b16 a[202:203], v26 offset:2048
v_mfma_f32_16x16x32_bf16 v[60:63], a[192:195], v[172:175], v[60:63]
ds_read_b64_tr_b16 a[204:205], v27 offset:0
v_mfma_f32_16x16x32_bf16 v[64:67], a[192:195], v[176:179], v[64:67]
s_add_u32 m0, s52, 36864
s_nop 0
buffer_load_dwordx4 v14, s[8:11], s86 offen offset:0 lds
s_waitcnt lgkmcnt(3)
v_mfma_f32_16x16x32_bf16 v[68:71], a[196:199], v[152:155], v[68:71]
ds_read_b64_tr_b16 a[206:207], v27 offset:2048
v_mfma_f32_16x16x32_bf16 v[72:75], a[196:199], v[156:159], v[72:75]
ds_read_b64_tr_b16 a[208:209], v24 offset:4096
v_mfma_f32_16x16x32_bf16 v[76:79], a[196:199], v[160:163], v[76:79]
v_mfma_f32_16x16x32_bf16 v[80:83], a[196:199], v[164:167], v[80:83]
ds_read_b64_tr_b16 a[210:211], v24 offset:6144
buffer_load_dwordx4 v15, s[8:11], s86 offen offset:1024 lds
v_mfma_f32_16x16x32_bf16 v[84:87], a[196:199], v[168:171], v[84:87]
ds_read_b128 v[180:183], v19 offset:32768
v_mfma_f32_16x16x32_bf16 v[88:91], a[196:199], v[172:175], v[88:91]
v_mfma_f32_16x16x32_bf16 v[92:95], a[196:199], v[176:179], v[92:95]
ds_read_b128 v[184:187], v19 offset:34816
s_waitcnt lgkmcnt(4)
v_mfma_f32_16x16x32_bf16 v[96:99], a[200:203], v[152:155], v[96:99]
ds_read_b128 v[188:191], v19 offset:36864
buffer_load_dwordx4 v16, s[8:11], s86 offen offset:2048 lds
v_mfma_f32_16x16x32_bf16 v[100:103], a[200:203], v[156:159], v[100:103]
v_mfma_f32_16x16x32_bf16 v[104:107], a[200:203], v[160:163], v[104:107]
ds_read_b128 v[192:195], v19 offset:38912
v_mfma_f32_16x16x32_bf16 v[108:111], a[200:203], v[164:167], v[108:111]
ds_read_b128 v[196:199], v19 offset:40960
v_mfma_f32_16x16x32_bf16 v[112:115], a[200:203], v[168:171], v[112:115]
ds_read_b128 v[200:203], v19 offset:43008
v_mfma_f32_16x16x32_bf16 v[116:119], a[200:203], v[172:175], v[116:119]
buffer_load_dwordx4 v17, s[8:11], s86 offen offset:3072 lds
v_mfma_f32_16x16x32_bf16 v[120:123], a[200:203], v[176:179], v[120:123]
ds_read_b128 v[204:207], v19 offset:45056
v_mfma_f32_16x16x32_bf16 v[124:127], a[204:207], v[152:155], v[124:127]
ds_read_b64_tr_b16 a[212:213], v25 offset:4096
v_mfma_f32_16x16x32_bf16 v[128:131], a[204:207], v[156:159], v[128:131]
v_mfma_f32_16x16x32_bf16 v[132:135], a[204:207], v[160:163], v[132:135]
ds_read_b64_tr_b16 a[214:215], v25 offset:6144
s_add_u32 m0, s80, 114688
s_nop 0
buffer_load_dwordx4 v10, s[20:23], s54 offen offset:0 sc1 lds
v_mfma_f32_16x16x32_bf16 v[136:139], a[204:207], v[164:167], v[136:139]
ds_read_b64_tr_b16 a[216:217], v26 offset:4096
v_mfma_f32_16x16x32_bf16 v[140:143], a[204:207], v[168:171], v[140:143]
v_mfma_f32_16x16x32_bf16 v[144:147], a[204:207], v[172:175], v[144:147]
ds_read_b64_tr_b16 a[218:219], v26 offset:6144
v_mfma_f32_16x16x32_bf16 v[148:151], a[204:207], v[176:179], v[148:151]
ds_read_b64_tr_b16 a[220:221], v27 offset:4096
buffer_load_dwordx4 v11, s[20:23], s54 offen offset:1024 sc1 lds
s_waitcnt lgkmcnt(5)
v_mfma_f32_16x16x32_bf16 v[40:43], a[208:211], v[180:183], v[40:43]
v_mfma_f32_16x16x32_bf16 v[44:47], a[208:211], v[184:187], v[44:47]
ds_read_b64_tr_b16 a[222:223], v27 offset:6144
v_mfma_f32_16x16x32_bf16 v[48:51], a[208:211], v[188:191], v[48:51]
v_mfma_f32_16x16x32_bf16 v[52:55], a[208:211], v[192:195], v[52:55]
buffer_load_dwordx4 v12, s[20:23], s54 offen offset:2048 sc1 lds
v_mfma_f32_16x16x32_bf16 v[56:59], a[208:211], v[196:199], v[56:59]
v_mfma_f32_16x16x32_bf16 v[60:63], a[208:211], v[200:203], v[60:63]
v_mfma_f32_16x16x32_bf16 v[64:67], a[208:211], v[204:207], v[64:67]
s_waitcnt lgkmcnt(0)
v_mfma_f32_16x16x32_bf16 v[68:71], a[212:215], v[180:183], v[68:71]
buffer_load_dwordx4 v13, s[20:23], s54 offen offset:3072 sc1 lds
s_lshr_b64 s[98:99], s[98:99], 4
s_and_b32 s54, s98, 15
s_lshl_b32 s54, s54, 11
v_mfma_f32_16x16x32_bf16 v[72:75], a[212:215], v[184:187], v[72:75]
v_mfma_f32_16x16x32_bf16 v[76:79], a[212:215], v[188:191], v[76:79]
v_mfma_f32_16x16x32_bf16 v[80:83], a[212:215], v[192:195], v[80:83]
v_mfma_f32_16x16x32_bf16 v[84:87], a[212:215], v[196:199], v[84:87]
v_mfma_f32_16x16x32_bf16 v[88:91], a[212:215], v[200:203], v[88:91]
s_waitcnt vmcnt(12) lgkmcnt(0)
s_barrier
ds_read_b64_tr_b16 a[192:193], v20 offset:0
v_mfma_f32_16x16x32_bf16 v[92:95], a[212:215], v[204:207], v[92:95]
ds_read_b64_tr_b16 a[194:195], v20 offset:2048
v_mfma_f32_16x16x32_bf16 v[96:99], a[216:219], v[180:183], v[96:99]
ds_read_b128 v[152:155], v18 offset:0
v_mfma_f32_16x16x32_bf16 v[100:103], a[216:219], v[184:187], v[100:103]
s_add_u32 m0, s52, 65536
s_add_u32 s86, s55, 65536
buffer_load_dwordx4 v14, s[8:11], s55 offen offset:0 lds
v_mfma_f32_16x16x32_bf16 v[104:107], a[216:219], v[188:191], v[104:107]
ds_read_b128 v[156:159], v18 offset:2048
v_mfma_f32_16x16x32_bf16 v[108:111], a[216:219], v[192:195], v[108:111]
ds_read_b128 v[160:163], v18 offset:4096
v_mfma_f32_16x16x32_bf16 v[112:115], a[216:219], v[196:199], v[112:115]
ds_read_b128 v[164:167], v18 offset:6144
v_mfma_f32_16x16x32_bf16 v[116:119], a[216:219], v[200:203], v[116:119]
ds_read_b128 v[168:171], v18 offset:8192
v_mfma_f32_16x16x32_bf16 v[120:123], a[216:219], v[204:207], v[120:123]
ds_read_b128 v[172:175], v18 offset:10240
buffer_load_dwordx4 v15, s[8:11], s55 offen offset:1024 lds
v_mfma_f32_16x16x32_bf16 v[124:127], a[220:223], v[180:183], v[124:127]
v_mfma_f32_16x16x32_bf16 v[128:131], a[220:223], v[184:187], v[128:131]
ds_read_b128 v[176:179], v18 offset:12288
v_mfma_f32_16x16x32_bf16 v[132:135], a[220:223], v[188:191], v[132:135]
ds_read_b64_tr_b16 a[196:197], v21 offset:0
v_mfma_f32_16x16x32_bf16 v[136:139], a[220:223], v[192:195], v[136:139]
ds_read_b64_tr_b16 a[198:199], v21 offset:2048
v_mfma_f32_16x16x32_bf16 v[140:143], a[220:223], v[196:199], v[140:143]
buffer_load_dwordx4 v16, s[8:11], s55 offen offset:2048 lds
v_mfma_f32_16x16x32_bf16 v[144:147], a[220:223], v[200:203], v[144:147]
v_mfma_f32_16x16x32_bf16 v[148:151], a[220:223], v[204:207], v[148:151]
s_waitcnt lgkmcnt(2)
v_mfma_f32_16x16x32_bf16 v[40:43], a[192:195], v[152:155], v[40:43]
v_mfma_f32_16x16x32_bf16 v[44:47], a[192:195], v[156:159], v[44:47]
v_mfma_f32_16x16x32_bf16 v[48:51], a[192:195], v[160:163], v[48:51]
ds_read_b64_tr_b16 a[200:201], v22 offset:0
buffer_load_dwordx4 v17, s[8:11], s55 offen offset:3072 lds
s_lshr_b64 s[96:97], s[96:97], 4
s_and_b32 s55, s96, 15
s_lshl_b32 s55, s55, 17
v_mfma_f32_16x16x32_bf16 v[52:55], a[192:195], v[164:167], v[52:55]
v_mfma_f32_16x16x32_bf16 v[56:59], a[192:195], v[168:171], v[56:59]
ds_read_b64_tr_b16 a[202:203], v22 offset:2048
v_mfma_f32_16x16x32_bf16 v[60:63], a[192:195], v[172:175], v[60:63]
ds_read_b64_tr_b16 a[204:205], v23 offset:0
v_mfma_f32_16x16x32_bf16 v[64:67], a[192:195], v[176:179], v[64:67]
s_add_u32 m0, s52, 69632
s_nop 0
buffer_load_dwordx4 v14, s[8:11], s86 offen offset:0 lds
s_waitcnt lgkmcnt(3)
v_mfma_f32_16x16x32_bf16 v[68:71], a[196:199], v[152:155], v[68:71]
ds_read_b64_tr_b16 a[206:207], v23 offset:2048
v_mfma_f32_16x16x32_bf16 v[72:75], a[196:199], v[156:159], v[72:75]
ds_read_b64_tr_b16 a[208:209], v20 offset:4096
v_mfma_f32_16x16x32_bf16 v[76:79], a[196:199], v[160:163], v[76:79]
v_mfma_f32_16x16x32_bf16 v[80:83], a[196:199], v[164:167], v[80:83]
ds_read_b64_tr_b16 a[210:211], v20 offset:6144
buffer_load_dwordx4 v15, s[8:11], s86 offen offset:1024 lds
v_mfma_f32_16x16x32_bf16 v[84:87], a[196:199], v[168:171], v[84:87]
ds_read_b128 v[180:183], v19 offset:0
v_mfma_f32_16x16x32_bf16 v[88:91], a[196:199], v[172:175], v[88:91]
v_mfma_f32_16x16x32_bf16 v[92:95], a[196:199], v[176:179], v[92:95]
ds_read_b128 v[184:187], v19 offset:2048
s_waitcnt lgkmcnt(4)
v_mfma_f32_16x16x32_bf16 v[96:99], a[200:203], v[152:155], v[96:99]
ds_read_b128 v[188:191], v19 offset:4096
buffer_load_dwordx4 v16, s[8:11], s86 offen offset:2048 lds
v_mfma_f32_16x16x32_bf16 v[100:103], a[200:203], v[156:159], v[100:103]
v_mfma_f32_16x16x32_bf16 v[104:107], a[200:203], v[160:163], v[104:107]
ds_read_b128 v[192:195], v19 offset:6144
v_mfma_f32_16x16x32_bf16 v[108:111], a[200:203], v[164:167], v[108:111]
ds_read_b128 v[196:199], v19 offset:8192
v_mfma_f32_16x16x32_bf16 v[112:115], a[200:203], v[168:171], v[112:115]
ds_read_b128 v[200:203], v19 offset:10240
v_mfma_f32_16x16x32_bf16 v[116:119], a[200:203], v[172:175], v[116:119]
buffer_load_dwordx4 v17, s[8:11], s86 offen offset:3072 lds
v_mfma_f32_16x16x32_bf16 v[120:123], a[200:203], v[176:179], v[120:123]
ds_read_b128 v[204:207], v19 offset:12288
v_mfma_f32_16x16x32_bf16 v[124:127], a[204:207], v[152:155], v[124:127]
ds_read_b64_tr_b16 a[212:213], v21 offset:4096
v_mfma_f32_16x16x32_bf16 v[128:131], a[204:207], v[156:159], v[128:131]
v_mfma_f32_16x16x32_bf16 v[132:135], a[204:207], v[160:163], v[132:135]
ds_read_b64_tr_b16 a[214:215], v21 offset:6144
s_add_u32 m0, s80, 131072
s_nop 0
buffer_load_dwordx4 v10, s[20:23], s54 offen offset:0 sc1 lds
v_mfma_f32_16x16x32_bf16 v[136:139], a[204:207], v[164:167], v[136:139]
ds_read_b64_tr_b16 a[216:217], v22 offset:4096
v_mfma_f32_16x16x32_bf16 v[140:143], a[204:207], v[168:171], v[140:143]
v_mfma_f32_16x16x32_bf16 v[144:147], a[204:207], v[172:175], v[144:147]
ds_read_b64_tr_b16 a[218:219], v22 offset:6144
v_mfma_f32_16x16x32_bf16 v[148:151], a[204:207], v[176:179], v[148:151]
ds_read_b64_tr_b16 a[220:221], v23 offset:4096
buffer_load_dwordx4 v11, s[20:23], s54 offen offset:1024 sc1 lds
s_waitcnt lgkmcnt(5)
v_mfma_f32_16x16x32_bf16 v[40:43], a[208:211], v[180:183], v[40:43]
v_mfma_f32_16x16x32_bf16 v[44:47], a[208:211], v[184:187], v[44:47]
ds_read_b64_tr_b16 a[222:223], v23 offset:6144
v_mfma_f32_16x16x32_bf16 v[48:51], a[208:211], v[188:191], v[48:51]
v_mfma_f32_16x16x32_bf16 v[52:55], a[208:211], v[192:195], v[52:55]
buffer_load_dwordx4 v12, s[20:23], s54 offen offset:2048 sc1 lds
v_mfma_f32_16x16x32_bf16 v[56:59], a[208:211], v[196:199], v[56:59]
v_mfma_f32_16x16x32_bf16 v[60:63], a[208:211], v[200:203], v[60:63]
v_mfma_f32_16x16x32_bf16 v[64:67], a[208:211], v[204:207], v[64:67]
s_waitcnt lgkmcnt(0)
v_mfma_f32_16x16x32_bf16 v[68:71], a[212:215], v[180:183], v[68:71]
buffer_load_dwordx4 v13, s[20:23], s54 offen offset:3072 sc1 lds
s_lshr_b64 s[98:99], s[98:99], 4
s_and_b32 s54, s98, 15
s_lshl_b32 s54, s54, 11
v_mfma_f32_16x16x32_bf16 v[72:75], a[212:215], v[184:187], v[72:75]
v_mfma_f32_16x16x32_bf16 v[76:79], a[212:215], v[188:191], v[76:79]
v_mfma_f32_16x16x32_bf16 v[80:83], a[212:215], v[192:195], v[80:83]
v_mfma_f32_16x16x32_bf16 v[84:87], a[212:215], v[196:199], v[84:87]
v_mfma_f32_16x16x32_bf16 v[88:91], a[212:215], v[200:203], v[88:91]
s_waitcnt vmcnt(12) lgkmcnt(0)
s_barrier
ds_read_b64_tr_b16 a[192:193], v20 offset:32768
v_mfma_f32_16x16x32_bf16 v[92:95], a[212:215], v[204:207], v[92:95]
ds_read_b64_tr_b16 a[194:195], v20 offset:34816
v_mfma_f32_16x16x32_bf16 v[96:99], a[216:219], v[180:183], v[96:99]
ds_read_b128 v[152:155], v18 offset:16384
v_mfma_f32_16x16x32_bf16 v[100:103], a[216:219], v[184:187], v[100:103]
s_add_u32 m0, s52, 0
s_add_u32 s86, s55, 65536
buffer_load_dwordx4 v14, s[8:11], s55 offen offset:0 lds
v_mfma_f32_16x16x32_bf16 v[104:107], a[216:219], v[188:191], v[104:107]
ds_read_b128 v[156:159], v18 offset:18432
v_mfma_f32_16x16x32_bf16 v[108:111], a[216:219], v[192:195], v[108:111]
ds_read_b128 v[160:163], v18 offset:20480
v_mfma_f32_16x16x32_bf16 v[112:115], a[216:219], v[196:199], v[112:115]
ds_read_b128 v[164:167], v18 offset:22528
v_mfma_f32_16x16x32_bf16 v[116:119], a[216:219], v[200:203], v[116:119]
ds_read_b128 v[168:171], v18 offset:24576
v_mfma_f32_16x16x32_bf16 v[120:123], a[216:219], v[204:207], v[120:123]
ds_read_b128 v[172:175], v18 offset:26624
buffer_load_dwordx4 v15, s[8:11], s55 offen offset:1024 lds
v_mfma_f32_16x16x32_bf16 v[124:127], a[220:223], v[180:183], v[124:127]
v_mfma_f32_16x16x32_bf16 v[128:131], a[220:223], v[184:187], v[128:131]
ds_read_b128 v[176:179], v18 offset:28672
v_mfma_f32_16x16x32_bf16 v[132:135], a[220:223], v[188:191], v[132:135]
ds_read_b64_tr_b16 a[196:197], v21 offset:32768
v_mfma_f32_16x16x32_bf16 v[136:139], a[220:223], v[192:195], v[136:139]
ds_read_b64_tr_b16 a[198:199], v21 offset:34816
v_mfma_f32_16x16x32_bf16 v[140:143], a[220:223], v[196:199], v[140:143]
buffer_load_dwordx4 v16, s[8:11], s55 offen offset:2048 lds
v_mfma_f32_16x16x32_bf16 v[144:147], a[220:223], v[200:203], v[144:147]
v_mfma_f32_16x16x32_bf16 v[148:151], a[220:223], v[204:207], v[148:151]
s_sub_u32 s53, s53, 1
s_cmp_lg_u32 s53, 0
s_cbranch_scc1 L_gl_69
s_waitcnt lgkmcnt(2)
v_mfma_f32_16x16x32_bf16 v[40:43], a[192:195], v[152:155], v[40:43]
v_mfma_f32_16x16x32_bf16 v[44:47], a[192:195], v[156:159], v[44:47]
v_mfma_f32_16x16x32_bf16 v[48:51], a[192:195], v[160:163], v[48:51]
ds_read_b64_tr_b16 a[200:201], v22 offset:32768
buffer_load_dwordx4 v17, s[8:11], s55 offen offset:3072 lds
s_lshr_b64 s[96:97], s[96:97], 4
s_and_b32 s55, s96, 15
s_lshl_b32 s55, s55, 17
v_mfma_f32_16x16x32_bf16 v[52:55], a[192:195], v[164:167], v[52:55]
v_mfma_f32_16x16x32_bf16 v[56:59], a[192:195], v[168:171], v[56:59]
ds_read_b64_tr_b16 a[202:203], v22 offset:34816
v_mfma_f32_16x16x32_bf16 v[60:63], a[192:195], v[172:175], v[60:63]
ds_read_b64_tr_b16 a[204:205], v23 offset:32768
v_mfma_f32_16x16x32_bf16 v[64:67], a[192:195], v[176:179], v[64:67]
s_add_u32 m0, s52, 4096
s_nop 0
buffer_load_dwordx4 v14, s[8:11], s86 offen offset:0 lds
s_waitcnt lgkmcnt(3)
v_mfma_f32_16x16x32_bf16 v[68:71], a[196:199], v[152:155], v[68:71]
ds_read_b64_tr_b16 a[206:207], v23 offset:34816
v_mfma_f32_16x16x32_bf16 v[72:75], a[196:199], v[156:159], v[72:75]
ds_read_b64_tr_b16 a[208:209], v20 offset:36864
v_mfma_f32_16x16x32_bf16 v[76:79], a[196:199], v[160:163], v[76:79]
v_mfma_f32_16x16x32_bf16 v[80:83], a[196:199], v[164:167], v[80:83]
ds_read_b64_tr_b16 a[210:211], v20 offset:38912
buffer_load_dwordx4 v15, s[8:11], s86 offen offset:1024 lds
v_mfma_f32_16x16x32_bf16 v[84:87], a[196:199], v[168:171], v[84:87]
ds_read_b128 v[180:183], v19 offset:16384
v_mfma_f32_16x16x32_bf16 v[88:91], a[196:199], v[172:175], v[88:91]
v_mfma_f32_16x16x32_bf16 v[92:95], a[196:199], v[176:179], v[92:95]
ds_read_b128 v[184:187], v19 offset:18432
s_waitcnt lgkmcnt(4)
v_mfma_f32_16x16x32_bf16 v[96:99], a[200:203], v[152:155], v[96:99]
ds_read_b128 v[188:191], v19 offset:20480
buffer_load_dwordx4 v16, s[8:11], s86 offen offset:2048 lds
v_mfma_f32_16x16x32_bf16 v[100:103], a[200:203], v[156:159], v[100:103]
v_mfma_f32_16x16x32_bf16 v[104:107], a[200:203], v[160:163], v[104:107]
ds_read_b128 v[192:195], v19 offset:22528
v_mfma_f32_16x16x32_bf16 v[108:111], a[200:203], v[164:167], v[108:111]
ds_read_b128 v[196:199], v19 offset:24576
v_mfma_f32_16x16x32_bf16 v[112:115], a[200:203], v[168:171], v[112:115]
ds_read_b128 v[200:203], v19 offset:26624
v_mfma_f32_16x16x32_bf16 v[116:119], a[200:203], v[172:175], v[116:119]
buffer_load_dwordx4 v17, s[8:11], s86 offen offset:3072 lds
v_mfma_f32_16x16x32_bf16 v[120:123], a[200:203], v[176:179], v[120:123]
ds_read_b128 v[204:207], v19 offset:28672
v_mfma_f32_16x16x32_bf16 v[124:127], a[204:207], v[152:155], v[124:127]
ds_read_b64_tr_b16 a[212:213], v21 offset:36864
v_mfma_f32_16x16x32_bf16 v[128:131], a[204:207], v[156:159], v[128:131]
v_mfma_f32_16x16x32_bf16 v[132:135], a[204:207], v[160:163], v[132:135]
ds_read_b64_tr_b16 a[214:215], v21 offset:38912
s_add_u32 m0, s80, 98304
s_nop 0
buffer_load_dwordx4 v10, s[20:23], s54 offen offset:0 sc1 lds
v_mfma_f32_16x16x32_bf16 v[136:139], a[204:207], v[164:167], v[136:139]
ds_read_b64_tr_b16 a[216:217], v22 offset:36864
v_mfma_f32_16x16x32_bf16 v[140:143], a[204:207], v[168:171], v[140:143]
v_mfma_f32_16x16x32_bf16 v[144:147], a[204:207], v[172:175], v[144:147]
ds_read_b64_tr_b16 a[218:219], v22 offset:38912
v_mfma_f32_16x16x32_bf16 v[148:151], a[204:207], v[176:179], v[148:151]
ds_read_b64_tr_b16 a[220:221], v23 offset:36864
buffer_load_dwordx4 v11, s[20:23], s54 offen offset:1024 sc1 lds
s_waitcnt lgkmcnt(5)
v_mfma_f32_16x16x32_bf16 v[40:43], a[208:211], v[180:183], v[40:43]
v_mfma_f32_16x16x32_bf16 v[44:47], a[208:211], v[184:187], v[44:47]
ds_read_b64_tr_b16 a[222:223], v23 offset:38912
v_mfma_f32_16x16x32_bf16 v[48:51], a[208:211], v[188:191], v[48:51]
v_mfma_f32_16x16x32_bf16 v[52:55], a[208:211], v[192:195], v[52:55]
buffer_load_dwordx4 v12, s[20:23], s54 offen offset:2048 sc1 lds
v_mfma_f32_16x16x32_bf16 v[56:59], a[208:211], v[196:199], v[56:59]
v_mfma_f32_16x16x32_bf16 v[60:63], a[208:211], v[200:203], v[60:63]
v_mfma_f32_16x16x32_bf16 v[64:67], a[208:211], v[204:207], v[64:67]
s_waitcnt lgkmcnt(0)
v_mfma_f32_16x16x32_bf16 v[68:71], a[212:215], v[180:183], v[68:71]
buffer_load_dwordx4 v13, s[20:23], s54 offen offset:3072 sc1 lds
s_lshr_b64 s[98:99], s[98:99], 4
s_and_b32 s54, s98, 15
s_lshl_b32 s54, s54, 11
v_mfma_f32_16x16x32_bf16 v[72:75], a[212:215], v[184:187], v[72:75]
v_mfma_f32_16x16x32_bf16 v[76:79], a[212:215], v[188:191], v[76:79]
v_mfma_f32_16x16x32_bf16 v[80:83], a[212:215], v[192:195], v[80:83]
v_mfma_f32_16x16x32_bf16 v[84:87], a[212:215], v[196:199], v[84:87]
v_mfma_f32_16x16x32_bf16 v[88:91], a[212:215], v[200:203], v[88:91]
s_waitcnt vmcnt(12) lgkmcnt(0)
s_barrier
ds_read_b64_tr_b16 a[192:193], v24 offset:0
v_mfma_f32_16x16x32_bf16 v[92:95], a[212:215], v[204:207], v[92:95]
ds_read_b64_tr_b16 a[194:195], v24 offset:2048
v_mfma_f32_16x16x32_bf16 v[96:99], a[216:219], v[180:183], v[96:99]
ds_read_b128 v[152:155], v18 offset:32768
v_mfma_f32_16x16x32_bf16 v[100:103], a[216:219], v[184:187], v[100:103]
v_mfma_f32_16x16x32_bf16 v[104:107], a[216:219], v[188:191], v[104:107]
ds_read_b128 v[156:159], v18 offset:34816
v_mfma_f32_16x16x32_bf16 v[108:111], a[216:219], v[192:195], v[108:111]
ds_read_b128 v[160:163], v18 offset:36864
v_mfma_f32_16x16x32_bf16 v[112:115], a[216:219], v[196:199], v[112:115]
ds_read_b128 v[164:167], v18 offset:38912
v_mfma_f32_16x16x32_bf16 v[116:119], a[216:219], v[200:203], v[116:119]
ds_read_b128 v[168:171], v18 offset:40960
v_mfma_f32_16x16x32_bf16 v[120:123], a[216:219], v[204:207], v[120:123]
ds_read_b128 v[172:175], v18 offset:43008
v_mfma_f32_16x16x32_bf16 v[124:127], a[220:223], v[180:183], v[124:127]
v_mfma_f32_16x16x32_bf16 v[128:131], a[220:223], v[184:187], v[128:131]
ds_read_b128 v[176:179], v18 offset:45056
v_mfma_f32_16x16x32_bf16 v[132:135], a[220:223], v[188:191], v[132:135]
ds_read_b64_tr_b16 a[196:197], v25 offset:0
v_mfma_f32_16x16x32_bf16 v[136:139], a[220:223], v[192:195], v[136:139]
ds_read_b64_tr_b16 a[198:199], v25 offset:2048
v_mfma_f32_16x16x32_bf16 v[140:143], a[220:223], v[196:199], v[140:143]
v_mfma_f32_16x16x32_bf16 v[144:147], a[220:223], v[200:203], v[144:147]
v_mfma_f32_16x16x32_bf16 v[148:151], a[220:223], v[204:207], v[148:151]
s_waitcnt lgkmcnt(2)
v_mfma_f32_16x16x32_bf16 v[40:43], a[192:195], v[152:155], v[40:43]
v_mfma_f32_16x16x32_bf16 v[44:47], a[192:195], v[156:159], v[44:47]
v_mfma_f32_16x16x32_bf16 v[48:51], a[192:195], v[160:163], v[48:51]
ds_read_b64_tr_b16 a[200:201], v26 offset:0
v_mfma_f32_16x16x32_bf16 v[52:55], a[192:195], v[164:167], v[52:55]
v_mfma_f32_16x16x32_bf16 v[56:59], a[192:195], v[168:171], v[56:59]
ds_read_b64_tr_b16 a[202:203], v26 offset:2048
v_mfma_f32_16x16x32_bf16 v[60:63], a[192:195], v[172:175], v[60:63]
ds_read_b64_tr_b16 a[204:205], v27 offset:0
v_mfma_f32_16x16x32_bf16 v[64:67], a[192:195], v[176:179], v[64:67]
s_waitcnt lgkmcnt(3)
v_mfma_f32_16x16x32_bf16 v[68:71], a[196:199], v[152:155], v[68:71]
ds_read_b64_tr_b16 a[206:207], v27 offset:2048
v_mfma_f32_16x16x32_bf16 v[72:75], a[196:199], v[156:159], v[72:75]
ds_read_b64_tr_b16 a[208:209], v24 offset:4096
v_mfma_f32_16x16x32_bf16 v[76:79], a[196:199], v[160:163], v[76:79]
v_mfma_f32_16x16x32_bf16 v[80:83], a[196:199], v[164:167], v[80:83]
ds_read_b64_tr_b16 a[210:211], v24 offset:6144
v_mfma_f32_16x16x32_bf16 v[84:87], a[196:199], v[168:171], v[84:87]
ds_read_b128 v[180:183], v19 offset:32768
v_mfma_f32_16x16x32_bf16 v[88:91], a[196:199], v[172:175], v[88:91]
v_mfma_f32_16x16x32_bf16 v[92:95], a[196:199], v[176:179], v[92:95]
ds_read_b128 v[184:187], v19 offset:34816
s_waitcnt lgkmcnt(4)
v_mfma_f32_16x16x32_bf16 v[96:99], a[200:203], v[152:155], v[96:99]
ds_read_b128 v[188:191], v19 offset:36864
v_mfma_f32_16x16x32_bf16 v[100:103], a[200:203], v[156:159], v[100:103]
v_mfma_f32_16x16x32_bf16 v[104:107], a[200:203], v[160:163], v[104:107]
ds_read_b128 v[192:195], v19 offset:38912
v_mfma_f32_16x16x32_bf16 v[108:111], a[200:203], v[164:167], v[108:111]
ds_read_b128 v[196:199], v19 offset:40960
v_mfma_f32_16x16x32_bf16 v[112:115], a[200:203], v[168:171], v[112:115]
ds_read_b128 v[200:203], v19 offset:43008
v_mfma_f32_16x16x32_bf16 v[116:119], a[200:203], v[172:175], v[116:119]
v_mfma_f32_16x16x32_bf16 v[120:123], a[200:203], v[176:179], v[120:123]
ds_read_b128 v[204:207], v19 offset:45056
v_mfma_f32_16x16x32_bf16 v[124:127], a[204:207], v[152:155], v[124:127]
ds_read_b64_tr_b16 a[212:213], v25 offset:4096
v_mfma_f32_16x16x32_bf16 v[128:131], a[204:207], v[156:159], v[128:131]
v_mfma_f32_16x16x32_bf16 v[132:135], a[204:207], v[160:163], v[132:135]
ds_read_b64_tr_b16 a[214:215], v25 offset:6144
v_mfma_f32_16x16x32_bf16 v[136:139], a[204:207], v[164:167], v[136:139]
ds_read_b64_tr_b16 a[216:217], v26 offset:4096
v_mfma_f32_16x16x32_bf16 v[140:143], a[204:207], v[168:171], v[140:143]
v_mfma_f32_16x16x32_bf16 v[144:147], a[204:207], v[172:175], v[144:147]
ds_read_b64_tr_b16 a[218:219], v26 offset:6144
v_mfma_f32_16x16x32_bf16 v[148:151], a[204:207], v[176:179], v[148:151]
ds_read_b64_tr_b16 a[220:221], v27 offset:4096
s_waitcnt lgkmcnt(5)
v_mfma_f32_16x16x32_bf16 v[40:43], a[208:211], v[180:183], v[40:43]
v_mfma_f32_16x16x32_bf16 v[44:47], a[208:211], v[184:187], v[44:47]
ds_read_b64_tr_b16 a[222:223], v27 offset:6144
v_mfma_f32_16x16x32_bf16 v[48:51], a[208:211], v[188:191], v[48:51]
v_mfma_f32_16x16x32_bf16 v[52:55], a[208:211], v[192:195], v[52:55]
v_mfma_f32_16x16x32_bf16 v[56:59], a[208:211], v[196:199], v[56:59]
v_mfma_f32_16x16x32_bf16 v[60:63], a[208:211], v[200:203], v[60:63]
v_mfma_f32_16x16x32_bf16 v[64:67], a[208:211], v[204:207], v[64:67]
s_waitcnt lgkmcnt(0)
v_mfma_f32_16x16x32_bf16 v[68:71], a[212:215], v[180:183], v[68:71]
v_mfma_f32_16x16x32_bf16 v[72:75], a[212:215], v[184:187], v[72:75]
v_mfma_f32_16x16x32_bf16 v[76:79], a[212:215], v[188:191], v[76:79]
v_mfma_f32_16x16x32_bf16 v[80:83], a[212:215], v[192:195], v[80:83]
v_mfma_f32_16x16x32_bf16 v[84:87], a[212:215], v[196:199], v[84:87]
v_mfma_f32_16x16x32_bf16 v[88:91], a[212:215], v[200:203], v[88:91]
s_waitcnt vmcnt(0) lgkmcnt(0)
s_barrier
ds_read_b64_tr_b16 a[192:193], v20 offset:0
v_mfma_f32_16x16x32_bf16 v[92:95], a[212:215], v[204:207], v[92:95]
ds_read_b64_tr_b16 a[194:195], v20 offset:2048
v_mfma_f32_16x16x32_bf16 v[96:99], a[216:219], v[180:183], v[96:99]
ds_read_b128 v[152:155], v18 offset:0
v_mfma_f32_16x16x32_bf16 v[100:103], a[216:219], v[184:187], v[100:103]
v_mfma_f32_16x16x32_bf16 v[104:107], a[216:219], v[188:191], v[104:107]
ds_read_b128 v[156:159], v18 offset:2048
v_mfma_f32_16x16x32_bf16 v[108:111], a[216:219], v[192:195], v[108:111]
ds_read_b128 v[160:163], v18 offset:4096
v_mfma_f32_16x16x32_bf16 v[112:115], a[216:219], v[196:199], v[112:115]
ds_read_b128 v[164:167], v18 offset:6144
v_mfma_f32_16x16x32_bf16 v[116:119], a[216:219], v[200:203], v[116:119]
ds_read_b128 v[168:171], v18 offset:8192
v_mfma_f32_16x16x32_bf16 v[120:123], a[216:219], v[204:207], v[120:123]
ds_read_b128 v[172:175], v18 offset:10240
v_mfma_f32_16x16x32_bf16 v[124:127], a[220:223], v[180:183], v[124:127]
v_mfma_f32_16x16x32_bf16 v[128:131], a[220:223], v[184:187], v[128:131]
ds_read_b128 v[176:179], v18 offset:12288
v_mfma_f32_16x16x32_bf16 v[132:135], a[220:223], v[188:191], v[132:135]
ds_read_b64_tr_b16 a[196:197], v21 offset:0
v_mfma_f32_16x16x32_bf16 v[136:139], a[220:223], v[192:195], v[136:139]
ds_read_b64_tr_b16 a[198:199], v21 offset:2048
v_mfma_f32_16x16x32_bf16 v[140:143], a[220:223], v[196:199], v[140:143]
v_mfma_f32_16x16x32_bf16 v[144:147], a[220:223], v[200:203], v[144:147]
v_mfma_f32_16x16x32_bf16 v[148:151], a[220:223], v[204:207], v[148:151]
s_cmp_eq_u32 s32, s38
s_cbranch_scc1 L_own_70
s_waitcnt lgkmcnt(2)
v_mfma_f32_16x16x32_bf16 v[40:43], a[192:195], v[152:155], v[40:43]
v_mfma_f32_16x16x32_bf16 v[44:47], a[192:195], v[156:159], v[44:47]
v_mfma_f32_16x16x32_bf16 v[48:51], a[192:195], v[160:163], v[48:51]
ds_read_b64_tr_b16 a[200:201], v22 offset:0
v_mfma_f32_16x16x32_bf16 v[52:55], a[192:195], v[164:167], v[52:55]
v_mfma_f32_16x16x32_bf16 v[56:59], a[192:195], v[168:171], v[56:59]
ds_read_b64_tr_b16 a[202:203], v22 offset:2048
v_mfma_f32_16x16x32_bf16 v[60:63], a[192:195], v[172:175], v[60:63]
ds_read_b64_tr_b16 a[204:205], v23 offset:0
v_mfma_f32_16x16x32_bf16 v[64:67], a[192:195], v[176:179], v[64:67]
s_waitcnt lgkmcnt(3)
v_mfma_f32_16x16x32_bf16 v[68:71], a[196:199], v[152:155], v[68:71]
ds_read_b64_tr_b16 a[206:207], v23 offset:2048
v_mfma_f32_16x16x32_bf16 v[72:75], a[196:199], v[156:159], v[72:75]
ds_read_b64_tr_b16 a[208:209], v20 offset:4096
v_mfma_f32_16x16x32_bf16 v[76:79], a[196:199], v[160:163], v[76:79]
v_mfma_f32_16x16x32_bf16 v[80:83], a[196:199], v[164:167], v[80:83]
ds_read_b64_tr_b16 a[210:211], v20 offset:6144
v_mfma_f32_16x16x32_bf16 v[84:87], a[196:199], v[168:171], v[84:87]
ds_read_b64_tr_b16 a[212:213], v21 offset:4096
v_mfma_f32_16x16x32_bf16 v[88:91], a[196:199], v[172:175], v[88:91]
v_mfma_f32_16x16x32_bf16 v[92:95], a[196:199], v[176:179], v[92:95]
ds_read_b64_tr_b16 a[214:215], v21 offset:6144
s_waitcnt lgkmcnt(4)
v_mfma_f32_16x16x32_bf16 v[96:99], a[200:203], v[152:155], v[96:99]
ds_read_b64_tr_b16 a[216:217], v22 offset:4096
v_mfma_f32_16x16x32_bf16 v[100:103], a[200:203], v[156:159], v[100:103]
v_mfma_f32_16x16x32_bf16 v[104:107], a[200:203], v[160:163], v[104:107]
ds_read_b64_tr_b16 a[218:219], v22 offset:6144
v_mfma_f32_16x16x32_bf16 v[108:111], a[200:203], v[164:167], v[108:111]
ds_read_b64_tr_b16 a[220:221], v23 offset:4096
v_mfma_f32_16x16x32_bf16 v[112:115], a[200:203], v[168:171], v[112:115]
ds_read_b64_tr_b16 a[222:223], v23 offset:6144
v_mfma_f32_16x16x32_bf16 v[116:119], a[200:203], v[172:175], v[116:119]
v_mfma_f32_16x16x32_bf16 v[120:123], a[200:203], v[176:179], v[120:123]
ds_read_b128 v[180:183], v19 offset:0
v_mfma_f32_16x16x32_bf16 v[124:127], a[204:207], v[152:155], v[124:127]
ds_read_b128 v[184:187], v19 offset:2048
v_mfma_f32_16x16x32_bf16 v[128:131], a[204:207], v[156:159], v[128:131]
v_mfma_f32_16x16x32_bf16 v[132:135], a[204:207], v[160:163], v[132:135]
ds_read_b128 v[188:191], v19 offset:4096
v_mfma_f32_16x16x32_bf16 v[136:139], a[204:207], v[164:167], v[136:139]
ds_read_b128 v[192:195], v19 offset:6144
v_mfma_f32_16x16x32_bf16 v[140:143], a[204:207], v[168:171], v[140:143]
v_mfma_f32_16x16x32_bf16 v[144:147], a[204:207], v[172:175], v[144:147]
ds_read_b128 v[196:199], v19 offset:8192
v_mfma_f32_16x16x32_bf16 v[148:151], a[204:207], v[176:179], v[148:151]
ds_read_b128 v[200:203], v19 offset:10240
s_waitcnt lgkmcnt(4)
v_mfma_f32_16x16x32_bf16 v[40:43], a[208:211], v[180:183], v[40:43]
v_mfma_f32_16x16x32_bf16 v[68:71], a[212:215], v[180:183], v[68:71]
ds_read_b128 v[204:207], v19 offset:12288
v_mfma_f32_16x16x32_bf16 v[96:99], a[216:219], v[180:183], v[96:99]
v_mfma_f32_16x16x32_bf16 v[124:127], a[220:223], v[180:183], v[124:127]
v_mfma_f32_16x16x32_bf16 v[44:47], a[208:211], v[184:187], v[44:47]
v_mfma_f32_16x16x32_bf16 v[72:75], a[212:215], v[184:187], v[72:75]
v_mfma_f32_16x16x32_bf16 v[100:103], a[216:219], v[184:187], v[100:103]
v_mfma_f32_16x16x32_bf16 v[128:131], a[220:223], v[184:187], v[128:131]
s_waitcnt lgkmcnt(0)
v_mfma_f32_16x16x32_bf16 v[48:51], a[208:211], v[188:191], v[48:51]
v_cvt_pk_bf16_f32 v208, v40, v41
v_cvt_pk_bf16_f32 v209, v42, v43
v_mfma_f32_16x16x32_bf16 v[76:79], a[212:215], v[188:191], v[76:79]
v_cvt_pk_bf16_f32 v210, v68, v69
v_cvt_pk_bf16_f32 v211, v70, v71
buffer_store_dwordx4 v[208:211], v36, s[24:27], s48 offen offset:0 sc1
v_mfma_f32_16x16x32_bf16 v[104:107], a[216:219], v[188:191], v[104:107]
v_cvt_pk_bf16_f32 v212, v96, v97
v_cvt_pk_bf16_f32 v213, v98, v99
v_mfma_f32_16x16x32_bf16 v[132:135], a[220:223], v[188:191], v[132:135]
v_cvt_pk_bf16_f32 v214, v124, v125
v_cvt_pk_bf16_f32 v215, v126, v127
buffer_store_dwordx4 v[212:215], v36, s[24:27], s48 offen offset:1024 sc1
v_mfma_f32_16x16x32_bf16 v[52:55], a[208:211], v[192:195], v[52:55]
v_cvt_pk_bf16_f32 v216, v44, v45
v_cvt_pk_bf16_f32 v217, v46, v47
v_cvt_pk_bf16_f32 v218, v72, v73
v_mfma_f32_16x16x32_bf16 v[80:83], a[212:215], v[192:195], v[80:83]
v_cvt_pk_bf16_f32 v219, v74, v75
buffer_store_dwordx4 v[216:219], v36, s[24:27], s48 offen offset:2048 sc1
v_mfma_f32_16x16x32_bf16 v[108:111], a[216:219], v[192:195], v[108:111]
v_cvt_pk_bf16_f32 v220, v100, v101
v_cvt_pk_bf16_f32 v221, v102, v103
v_cvt_pk_bf16_f32 v222, v128, v129
v_mfma_f32_16x16x32_bf16 v[136:139], a[220:223], v[192:195], v[136:139]
v_cvt_pk_bf16_f32 v223, v130, v131
buffer_store_dwordx4 v[220:223], v36, s[24:27], s48 offen offset:3072 sc1
s_add_u32 s48, s48, 4096
v_mfma_f32_16x16x32_bf16 v[56:59], a[208:211], v[196:199], v[56:59]
v_cvt_pk_bf16_f32 v224, v48, v49
v_cvt_pk_bf16_f32 v225, v50, v51
v_mfma_f32_16x16x32_bf16 v[84:87], a[212:215], v[196:199], v[84:87]
v_cvt_pk_bf16_f32 v226, v76, v77
v_cvt_pk_bf16_f32 v227, v78, v79
buffer_store_dwordx4 v[224:227], v36, s[24:27], s48 offen offset:0 sc1
v_mfma_f32_16x16x32_bf16 v[112:115], a[216:219], v[196:199], v[112:115]
v_cvt_pk_bf16_f32 v228, v104, v105
v_cvt_pk_bf16_f32 v229, v106, v107
v_mfma_f32_16x16x32_bf16 v[140:143], a[220:223], v[196:199], v[140:143]
v_cvt_pk_bf16_f32 v230, v132, v133
v_cvt_pk_bf16_f32 v231, v134, v135
buffer_store_dwordx4 v[228:231], v36, s[24:27], s48 offen offset:1024 sc1
v_mfma_f32_16x16x32_bf16 v[60:63], a[208:211], v[200:203], v[60:63]
v_cvt_pk_bf16_f32 v232, v52, v53
v_cvt_pk_bf16_f32 v233, v54, v55
v_cvt_pk_bf16_f32 v234, v80, v81
v_mfma_f32_16x16x32_bf16 v[88:91], a[212:215], v[200:203], v[88:91]
v_cvt_pk_bf16_f32 v235, v82, v83
buffer_store_dwordx4 v[232:235], v36, s[24:27], s48 offen offset:2048 sc1
v_mfma_f32_16x16x32_bf16 v[116:119], a[216:219], v[200:203], v[116:119]
v_cvt_pk_bf16_f32 v236, v108, v109
v_cvt_pk_bf16_f32 v237, v110, v111
v_cvt_pk_bf16_f32 v238, v136, v137
v_mfma_f32_16x16x32_bf16 v[144:147], a[220:223], v[200:203], v[144:147]
v_cvt_pk_bf16_f32 v239, v138, v139
buffer_store_dwordx4 v[236:239], v36, s[24:27], s48 offen offset:3072 sc1
s_add_u32 s48, s48, 4096
v_mfma_f32_16x16x32_bf16 v[64:67], a[208:211], v[204:207], v[64:67]
v_cvt_pk_bf16_f32 v240, v56, v57
v_cvt_pk_bf16_f32 v241, v58, v59
v_mfma_f32_16x16x32_bf16 v[92:95], a[212:215], v[204:207], v[92:95]
v_cvt_pk_bf16_f32 v242, v84, v85
v_cvt_pk_bf16_f32 v243, v86, v87
buffer_store_dwordx4 v[240:243], v36, s[24:27], s48 offen offset:0 sc1
v_mfma_f32_16x16x32_bf16 v[120:123], a[216:219], v[204:207], v[120:123]
v_cvt_pk_bf16_f32 v244, v112, v113
v_cvt_pk_bf16_f32 v245, v114, v115
v_mfma_f32_16x16x32_bf16 v[148:151], a[220:223], v[204:207], v[148:151]
v_cvt_pk_bf16_f32 v246, v140, v141
v_cvt_pk_bf16_f32 v247, v142, v143
buffer_store_dwordx4 v[244:247], v36, s[24:27], s48 offen offset:1024 sc1
v_cvt_pk_bf16_f32 v248, v60, v61
v_cvt_pk_bf16_f32 v249, v62, v63
v_cvt_pk_bf16_f32 v250, v88, v89
v_cvt_pk_bf16_f32 v251, v90, v91
buffer_store_dwordx4 v[248:251], v36, s[24:27], s48 offen offset:2048 sc1
v_cvt_pk_bf16_f32 v252, v116, v117
v_cvt_pk_bf16_f32 v253, v118, v119
v_cvt_pk_bf16_f32 v254, v144, v145
v_cvt_pk_bf16_f32 v255, v146, v147
buffer_store_dwordx4 v[252:255], v36, s[24:27], s48 offen offset:3072 sc1
s_add_u32 s48, s48, 4096
s_nop 1
v_cvt_pk_bf16_f32 v208, v64, v65
v_cvt_pk_bf16_f32 v209, v66, v67
v_cvt_pk_bf16_f32 v210, v92, v93
v_cvt_pk_bf16_f32 v211, v94, v95
buffer_store_dwordx4 v[208:211], v36, s[24:27], s48 offen offset:0 sc1
v_cvt_pk_bf16_f32 v212, v120, v121
v_cvt_pk_bf16_f32 v213, v122, v123
v_cvt_pk_bf16_f32 v214, v148, v149
v_cvt_pk_bf16_f32 v215, v150, v151
buffer_store_dwordx4 v[212:215], v36, s[24:27], s48 offen offset:1024 sc1
s_waitcnt vmcnt(0)
s_mov_b64 exec, 1
s_cmp_lg_u32 s91, 0
s_cbranch_scc1 L_tagok_73
v_mov_b32 v6, 0
s_mov_b32 s83, 0
L_tag_72:
global_load_dwordx2 v[4:5], v6, s[40:41] sc1
s_waitcnt vmcnt(0)
v_readfirstlane_b32 s90, v4
v_readfirstlane_b32 s91, v5
s_add_u32 s83, s83, 1
s_cmp_lg_u32 s91, 0
s_cbranch_scc1 L_tagok_73
s_sleep 4
s_cmp_lt_u32 s83, 0x4000
s_cbranch_scc1 L_tag_72
L_tagok_73:
v_mov_b32 v6, s49
v_mov_b32 v4, s90
v_mov_b32 v5, s91
global_store_dwordx2 v6, v[4:5], s[42:43] sc1
s_mov_b64 exec, -1
s_branch L_sent_71
L_own_70:
s_waitcnt lgkmcnt(0)
v_mfma_f32_16x16x32_bf16 v[40:43], a[192:195], v[152:155], v[40:43]
v_mfma_f32_16x16x32_bf16 v[44:47], a[192:195], v[156:159], v[44:47]
v_mfma_f32_16x16x32_bf16 v[48:51], a[192:195], v[160:163], v[48:51]
ds_read_b64_tr_b16 a[200:201], v22 offset:0
v_mfma_f32_16x16x32_bf16 v[52:55], a[192:195], v[164:167], v[52:55]
v_mfma_f32_16x16x32_bf16 v[56:59], a[192:195], v[168:171], v[56:59]
ds_read_b64_tr_b16 a[202:203], v22 offset:2048
v_mfma_f32_16x16x32_bf16 v[60:63], a[192:195], v[172:175], v[60:63]
ds_read_b64_tr_b16 a[204:205], v23 offset:0
v_mfma_f32_16x16x32_bf16 v[64:67], a[192:195], v[176:179], v[64:67]
v_mfma_f32_16x16x32_bf16 v[68:71], a[196:199], v[152:155], v[68:71]
ds_read_b64_tr_b16 a[206:207], v23 offset:2048
v_mfma_f32_16x16x32_bf16 v[72:75], a[196:199], v[156:159], v[72:75]
ds_read_b64_tr_b16 a[208:209], v20 offset:4096
v_mfma_f32_16x16x32_bf16 v[76:79], a[196:199], v[160:163], v[76:79]
v_mfma_f32_16x16x32_bf16 v[80:83], a[196:199], v[164:167], v[80:83]
ds_read_b64_tr_b16 a[210:211], v20 offset:6144
v_mfma_f32_16x16x32_bf16 v[84:87], a[196:199], v[168:171], v[84:87]
ds_read_b64_tr_b16 a[212:213], v21 offset:4096
v_mfma_f32_16x16x32_bf16 v[88:91], a[196:199], v[172:175], v[88:91]
v_mfma_f32_16x16x32_bf16 v[92:95], a[196:199], v[176:179], v[92:95]
ds_read_b64_tr_b16 a[214:215], v21 offset:6144
s_waitcnt lgkmcnt(4)
v_mfma_f32_16x16x32_bf16 v[96:99], a[200:203], v[152:155], v[96:99]
ds_read_b64_tr_b16 a[216:217], v22 offset:4096
v_mfma_f32_16x16x32_bf16 v[100:103], a[200:203], v[156:159], v[100:103]
v_mfma_f32_16x16x32_bf16 v[104:107], a[200:203], v[160:163], v[104:107]
ds_read_b64_tr_b16 a[218:219], v22 offset:6144
v_mfma_f32_16x16x32_bf16 v[108:111], a[200:203], v[164:167], v[108:111]
ds_read_b64_tr_b16 a[220:221], v23 offset:4096
v_mfma_f32_16x16x32_bf16 v[112:115], a[200:203], v[168:171], v[112:115]
ds_read_b64_tr_b16 a[222:223], v23 offset:6144
v_mfma_f32_16x16x32_bf16 v[116:119], a[200:203], v[172:175], v[116:119]
v_mfma_f32_16x16x32_bf16 v[120:123], a[200:203], v[176:179], v[120:123]
ds_read_b128 v[180:183], v19 offset:0
v_mfma_f32_16x16x32_bf16 v[124:127], a[204:207], v[152:155], v[124:127]
ds_read_b128 v[184:187], v19 offset:2048
v_mfma_f32_16x16x32_bf16 v[128:131], a[204:207], v[156:159], v[128:131]
v_mfma_f32_16x16x32_bf16 v[132:135], a[204:207], v[160:163], v[132:135]
ds_read_b128 v[188:191], v19 offset:4096
v_mfma_f32_16x16x32_bf16 v[136:139], a[204:207], v[164:167], v[136:139]
ds_read_b128 v[192:195], v19 offset:6144
v_mfma_f32_16x16x32_bf16 v[140:143], a[204:207], v[168:171], v[140:143]
v_mfma_f32_16x16x32_bf16 v[144:147], a[204:207], v[172:175], v[144:147]
ds_read_b128 v[196:199], v19 offset:8192
v_mfma_f32_16x16x32_bf16 v[148:151], a[204:207], v[176:179], v[148:151]
ds_read_b128 v[200:203], v19 offset:10240
s_waitcnt lgkmcnt(4)
v_mfma_f32_16x16x32_bf16 v[40:43], a[208:211], v[180:183], v[40:43]
v_mfma_f32_16x16x32_bf16 v[68:71], a[212:215], v[180:183], v[68:71]
ds_read_b128 v[204:207], v19 offset:12288
v_mfma_f32_16x16x32_bf16 v[96:99], a[216:219], v[180:183], v[96:99]
v_mfma_f32_16x16x32_bf16 v[124:127], a[220:223], v[180:183], v[124:127]
v_mfma_f32_16x16x32_bf16 v[44:47], a[208:211], v[184:187], v[44:47]
v_mfma_f32_16x16x32_bf16 v[72:75], a[212:215], v[184:187], v[72:75]
v_mfma_f32_16x16x32_bf16 v[100:103], a[216:219], v[184:187], v[100:103]
v_mfma_f32_16x16x32_bf16 v[128:131], a[220:223], v[184:187], v[128:131]
s_waitcnt lgkmcnt(0)
v_mfma_f32_16x16x32_bf16 v[48:51], a[208:211], v[188:191], v[48:51]
ds_write_b128 v36, v[40:43] offset:32768
v_mfma_f32_16x16x32_bf16 v[76:79], a[212:215], v[188:191], v[76:79]
ds_write_b128 v36, v[68:71] offset:33792
v_mfma_f32_16x16x32_bf16 v[104:107], a[216:219], v[188:191], v[104:107]
ds_write_b128 v36, v[96:99] offset:34816
v_mfma_f32_16x16x32_bf16 v[132:135], a[220:223], v[188:191], v[132:135]
ds_write_b128 v36, v[124:127] offset:35840
v_mfma_f32_16x16x32_bf16 v[52:55], a[208:211], v[192:195], v[52:55]
ds_write_b128 v36, v[44:47] offset:36864
v_mfma_f32_16x16x32_bf16 v[80:83], a[212:215], v[192:195], v[80:83]
ds_write_b128 v36, v[72:75] offset:37888
v_mfma_f32_16x16x32_bf16 v[108:111], a[216:219], v[192:195], v[108:111]
ds_write_b128 v36, v[100:103] offset:38912
v_mfma_f32_16x16x32_bf16 v[136:139], a[220:223], v[192:195], v[136:139]
ds_write_b128 v36, v[128:131] offset:39936
v_mfma_f32_16x16x32_bf16 v[56:59], a[208:211], v[196:199], v[56:59]
ds_write_b128 v36, v[48:51] offset:40960
v_mfma_f32_16x16x32_bf16 v[84:87], a[212:215], v[196:199], v[84:87]
ds_write_b128 v36, v[76:79] offset:41984
v_mfma_f32_16x16x32_bf16 v[112:115], a[216:219], v[196:199], v[112:115]
ds_write_b128 v36, v[104:107] offset:43008
v_mfma_f32_16x16x32_bf16 v[140:143], a[220:223], v[196:199], v[140:143]
ds_write_b128 v36, v[132:135] offset:44032
v_mfma_f32_16x16x32_bf16 v[60:63], a[208:211], v[200:203], v[60:63]
ds_write_b128 v36, v[52:55] offset:45056
v_mfma_f32_16x16x32_bf16 v[88:91], a[212:215], v[200:203], v[88:91]
ds_write_b128 v36, v[80:83] offset:46080
v_mfma_f32_16x16x32_bf16 v[116:119], a[216:219], v[200:203], v[116:119]
ds_write_b128 v36, v[108:111] offset:47104
v_mfma_f32_16x16x32_bf16 v[144:147], a[220:223], v[200:203], v[144:147]
ds_write_b128 v36, v[136:139] offset:48128
v_mfma_f32_16x16x32_bf16 v[64:67], a[208:211], v[204:207], v[64:67]
ds_write_b128 v36, v[56:59] offset:49152
v_mfma_f32_16x16x32_bf16 v[92:95], a[212:215], v[204:207], v[92:95]
ds_write_b128 v36, v[84:87] offset:50176
v_mfma_f32_16x16x32_bf16 v[120:123], a[216:219], v[204:207], v[120:123]
ds_write_b128 v36, v[112:115] offset:51200
v_mfma_f32_16x16x32_bf16 v[148:151], a[220:223], v[204:207], v[148:151]
ds_write_b128 v36, v[140:143] offset:52224
ds_write_b128 v36, v[60:63] offset:53248
ds_write_b128 v36, v[88:91] offset:54272
ds_write_b128 v36, v[116:119] offset:55296
ds_write_b128 v36, v[144:147] offset:56320
s_nop 1
ds_write_b128 v36, v[64:67] offset:57344
ds_write_b128 v36, v[92:95] offset:58368
ds_write_b128 v36, v[120:123] offset:59392
ds_write_b128 v36, v[148:151] offset:60416
L_sent_71:
s_mov_b64 exec, 15
v_lshlrev_b32 v7, 3, v1
v_add_u32 v7, s51, v7
s_mov_b64 exec, -1
s_lshl_b32 s47, 1, s38
v_and_b32 v2, 15, v1
v_lshrrev_b32 v3, 4, v1
v_add_u32 v214, s52, v36
s_waitcnt lgkmcnt(0)
s_barrier
ds_read_b128 v[40:43], v214 offset:32768
ds_read_b128 v[44:47], v214 offset:33792
ds_read_b128 v[48:51], v214 offset:34816
ds_read_b128 v[52:55], v214 offset:35840
ds_read_b128 v[56:59], v214 offset:36864
ds_read_b128 v[60:63], v214 offset:37888
ds_read_b128 v[64:67], v214 offset:38912
ds_read_b128 v[68:71], v214 offset:39936
v_lshrrev_b32 v208, 1, v3
v_and_b32 v212, 7, v2
v_xor_b32 v208, v208, v212
v_lshlrev_b32 v208, 4, v208
v_and_b32 v3, 1, v3
v_lshl_add_u32 v208, v3, 3, v208
v_lshl_add_u32 v208, v2, 7, v208
s_add_u32 s44, s80, 65536
v_add_u32 v208, s44, v208
v_xor_b32 v209, 32, v208
v_xor_b32 v210, 64, v208
v_xor_b32 v211, 96, v208
v_lshrrev_b32 v2, 3, v1
v_and_b32 v3, 7, v1
v_lshlrev_b32 v213, 12, v2
v_lshl_add_u32 v213, v3, 4, v213
v_xor_b32 v212, v3, v2
v_lshlrev_b32 v212, 4, v212
v_lshl_add_u32 v212, v2, 7, v212
v_add_u32 v212, s44, v212
s_mov_b64 exec, 15
s_mov_b32 s83, 0
global_load_dwordx2 v[8:9], v7, s[42:43] sc1
s_sleep 4
L_spin_74:
global_load_dwordx2 v[4:5], v7, s[42:43] sc1
s_waitcnt vmcnt(1)
v_cmp_eq_u64 vcc, s[90:91], v[8:9]
s_add_u32 s83, s83, 1
s_or_b32 s46, vcc_lo, s47
s_cmp_eq_u32 s46, 15
s_cbranch_scc1 L_go_75
global_load_dwordx2 v[8:9], v7, s[42:43] sc1
s_waitcnt vmcnt(1)
v_cmp_eq_u64 vcc, s[90:91], v[4:5]
s_add_u32 s83, s83, 1
s_or_b32 s46, vcc_lo, s47
s_cmp_eq_u32 s46, 15
s_cbranch_scc1 L_go_75
s_cmp_lt_u32 s83, 0x8000
s_cbranch_scc1 L_spin_74
L_go_75:
s_mov_b64 exec, -1
s_cmp_eq_u32 s32, 3
s_cbranch_scc1 L_w3_76
buffer_load_dwordx4 v[152:155], v36, s[24:27], s3 offen offset:0 sc1
buffer_load_dwordx4 v[156:159], v36, s[24:27], s3 offen offset:1024 sc1
buffer_load_dwordx4 v[160:163], v36, s[24:27], s100 offen offset:0 sc1
buffer_load_dwordx4 v[164:167], v36, s[24:27], s100 offen offset:1024 sc1
buffer_load_dwordx4 v[168:171], v36, s[24:27], s101 offen offset:0 sc1
buffer_load_dwordx4 v[172:175], v36, s[24:27], s101 offen offset:1024 sc1
buffer_load_dwordx4 v[176:179], v36, s[24:27], s3 offen offset:2048 sc1
buffer_load_dwordx4 v[180:183], v36, s[24:27], s3 offen offset:3072 sc1
buffer_load_dwordx4 v[184:187], v36, s[24:27], s100 offen offset:2048 sc1
buffer_load_dwordx4 v[188:191], v36, s[24:27], s100 offen offset:3072 sc1
buffer_load_dwordx4 v[192:195], v36, s[24:27], s101 offen offset:2048 sc1
buffer_load_dwordx4 v[196:199], v36, s[24:27], s101 offen offset:3072 sc1
s_waitcnt lgkmcnt(0)
s_waitcnt vmcnt(10)
v_lshlrev_b32 v80, 16, v152
v_and_b32 v81, 0xffff0000, v152
v_pk_add_f32 v[40:41], v[40:41], v[80:81]
v_lshlrev_b32 v82, 16, v153
v_and_b32 v83, 0xffff0000, v153
v_pk_add_f32 v[42:43], v[42:43], v[82:83]
v_lshlrev_b32 v84, 16, v154
v_and_b32 v85, 0xffff0000, v154
v_pk_add_f32 v[44:45], v[44:45], v[84:85]
v_lshlrev_b32 v86, 16, v155
v_and_b32 v87, 0xffff0000, v155
v_pk_add_f32 v[46:47], v[46:47], v[86:87]
v_lshlrev_b32 v80, 16, v156
v_and_b32 v81, 0xffff0000, v156
v_pk_add_f32 v[48:49], v[48:49], v[80:81]
v_lshlrev_b32 v82, 16, v157
v_and_b32 v83, 0xffff0000, v157
v_pk_add_f32 v[50:51], v[50:51], v[82:83]
v_lshlrev_b32 v84, 16, v158
v_and_b32 v85, 0xffff0000, v158
v_pk_add_f32 v[52:53], v[52:53], v[84:85]
v_lshlrev_b32 v86, 16, v159
v_and_b32 v87, 0xffff0000, v159
v_pk_add_f32 v[54:55], v[54:55], v[86:87]
s_waitcnt vmcnt(8)
v_lshlrev_b32 v80, 16, v160
v_and_b32 v81, 0xffff0000, v160
v_pk_add_f32 v[40:41], v[40:41], v[80:81]
v_lshlrev_b32 v82, 16, v161
v_and_b32 v83, 0xffff0000, v161
v_pk_add_f32 v[42:43], v[42:43], v[82:83]
v_lshlrev_b32 v84, 16, v162
v_and_b32 v85, 0xffff0000, v162
v_pk_add_f32 v[44:45], v[44:45], v[84:85]
v_lshlrev_b32 v86, 16, v163
v_and_b32 v87, 0xffff0000, v163
v_pk_add_f32 v[46:47], v[46:47], v[86:87]
v_lshlrev_b32 v80, 16, v164
v_and_b32 v81, 0xffff0000, v164
v_pk_add_f32 v[48:49], v[48:49], v[80:81]
v_lshlrev_b32 v82, 16, v165
v_and_b32 v83, 0xffff0000, v165
v_pk_add_f32 v[50:51], v[50:51], v[82:83]
v_lshlrev_b32 v84, 16, v166
v_and_b32 v85, 0xffff0000, v166
v_pk_add_f32 v[52:53], v[52:53], v[84:85]
v_lshlrev_b32 v86, 16, v167
v_and_b32 v87, 0xffff0000, v167
v_pk_add_f32 v[54:55], v[54:55], v[86:87]
s_waitcnt vmcnt(6)
v_lshlrev_b32 v80, 16, v168
v_and_b32 v81, 0xffff0000, v168
v_pk_add_f32 v[40:41], v[40:41], v[80:81]
v_lshlrev_b32 v82, 16, v169
v_and_b32 v83, 0xffff0000, v169
v_pk_add_f32 v[42:43], v[42:43], v[82:83]
v_lshlrev_b32 v84, 16, v170
v_and_b32 v85, 0xffff0000, v170
v_pk_add_f32 v[44:45], v[44:45], v[84:85]
v_lshlrev_b32 v86, 16, v171
v_and_b32 v87, 0xffff0000, v171
v_pk_add_f32 v[46:47], v[46:47], v[86:87]
v_lshlrev_b32 v80, 16, v172
v_and_b32 v81, 0xffff0000, v172
v_pk_add_f32 v[48:49], v[48:49], v[80:81]
v_lshlrev_b32 v82, 16, v173
v_and_b32 v83, 0xffff0000, v173
v_pk_add_f32 v[50:51], v[50:51], v[82:83]
v_lshlrev_b32 v84, 16, v174
v_and_b32 v85, 0xffff0000, v174
v_pk_add_f32 v[52:53], v[52:53], v[84:85]
v_lshlrev_b32 v86, 16, v175
v_and_b32 v87, 0xffff0000, v175
v_pk_add_f32 v[54:55], v[54:55], v[86:87]
v_cvt_pk_bf16_f32 v40, v40, v41
v_cvt_pk_bf16_f32 v41, v42, v43
ds_write_b64 v208, v[40:41] offset:0
v_cvt_pk_bf16_f32 v44, v44, v45
v_cvt_pk_bf16_f32 v45, v46, v47
ds_write_b64 v209, v[44:45] offset:0
v_cvt_pk_bf16_f32 v48, v48, v49
v_cvt_pk_bf16_f32 v49, v50, v51
ds_write_b64 v210, v[48:49] offset:0
v_cvt_pk_bf16_f32 v52, v52, v53
v_cvt_pk_bf16_f32 v53, v54, v55
ds_write_b64 v211, v[52:53] offset:0
s_waitcnt lgkmcnt(0)
ds_read_b128 v[88:91], v212 offset:0
ds_read_b128 v[92:95], v212 offset:1024
s_waitcnt lgkmcnt(1)
buffer_store_dwordx4 v[88:91], v213, s[28:31], s93 offen sc1
s_add_u32 s93, s93, 32768
s_waitcnt lgkmcnt(0)
buffer_store_dwordx4 v[92:95], v213, s[28:31], s93 offen sc1
s_add_u32 s93, s93, 32768
s_waitcnt vmcnt(6)
v_lshlrev_b32 v80, 16, v176
v_and_b32 v81, 0xffff0000, v176
v_pk_add_f32 v[56:57], v[56:57], v[80:81]
v_lshlrev_b32 v82, 16, v177
v_and_b32 v83, 0xffff0000, v177
v_pk_add_f32 v[58:59], v[58:59], v[82:83]
v_lshlrev_b32 v84, 16, v178
v_and_b32 v85, 0xffff0000, v178
v_pk_add_f32 v[60:61], v[60:61], v[84:85]
v_lshlrev_b32 v86, 16, v179
v_and_b32 v87, 0xffff0000, v179
v_pk_add_f32 v[62:63], v[62:63], v[86:87]
v_lshlrev_b32 v80, 16, v180
v_and_b32 v81, 0xffff0000, v180
v_pk_add_f32 v[64:65], v[64:65], v[80:81]
v_lshlrev_b32 v82, 16, v181
v_and_b32 v83, 0xffff0000, v181
v_pk_add_f32 v[66:67], v[66:67], v[82:83]
v_lshlrev_b32 v84, 16, v182
v_and_b32 v85, 0xffff0000, v182
v_pk_add_f32 v[68:69], v[68:69], v[84:85]
v_lshlrev_b32 v86, 16, v183
v_and_b32 v87, 0xffff0000, v183
v_pk_add_f32 v[70:71], v[70:71], v[86:87]
s_waitcnt vmcnt(4)
v_lshlrev_b32 v80, 16, v184
v_and_b32 v81, 0xffff0000, v184
v_pk_add_f32 v[56:57], v[56:57], v[80:81]
v_lshlrev_b32 v82, 16, v185
v_and_b32 v83, 0xffff0000, v185
v_pk_add_f32 v[58:59], v[58:59], v[82:83]
v_lshlrev_b32 v84, 16, v186
v_and_b32 v85, 0xffff0000, v186
v_pk_add_f32 v[60:61], v[60:61], v[84:85]
v_lshlrev_b32 v86, 16, v187
v_and_b32 v87, 0xffff0000, v187
v_pk_add_f32 v[62:63], v[62:63], v[86:87]
v_lshlrev_b32 v80, 16, v188
v_and_b32 v81, 0xffff0000, v188
v_pk_add_f32 v[64:65], v[64:65], v[80:81]
v_lshlrev_b32 v82, 16, v189
v_and_b32 v83, 0xffff0000, v189
v_pk_add_f32 v[66:67], v[66:67], v[82:83]
v_lshlrev_b32 v84, 16, v190
v_and_b32 v85, 0xffff0000, v190
v_pk_add_f32 v[68:69], v[68:69], v[84:85]
v_lshlrev_b32 v86, 16, v191
v_and_b32 v87, 0xffff0000, v191
v_pk_add_f32 v[70:71], v[70:71], v[86:87]
s_waitcnt vmcnt(2)
v_lshlrev_b32 v80, 16, v192
v_and_b32 v81, 0xffff0000, v192
v_pk_add_f32 v[56:57], v[56:57], v[80:81]
v_lshlrev_b32 v82, 16, v193
v_and_b32 v83, 0xffff0000, v193
v_pk_add_f32 v[58:59], v[58:59], v[82:83]
v_lshlrev_b32 v84, 16, v194
v_and_b32 v85, 0xffff0000, v194
v_pk_add_f32 v[60:61], v[60:61], v[84:85]
v_lshlrev_b32 v86, 16, v195
v_and_b32 v87, 0xffff0000, v195
v_pk_add_f32 v[62:63], v[62:63], v[86:87]
v_lshlrev_b32 v80, 16, v196
v_and_b32 v81, 0xffff0000, v196
v_pk_add_f32 v[64:65], v[64:65], v[80:81]
v_lshlrev_b32 v82, 16, v197
v_and_b32 v83, 0xffff0000, v197
v_pk_add_f32 v[66:67], v[66:67], v[82:83]
v_lshlrev_b32 v84, 16, v198
v_and_b32 v85, 0xffff0000, v198
v_pk_add_f32 v[68:69], v[68:69], v[84:85]
v_lshlrev_b32 v86, 16, v199
v_and_b32 v87, 0xffff0000, v199
v_pk_add_f32 v[70:71], v[70:71], v[86:87]
v_cvt_pk_bf16_f32 v56, v56, v57
v_cvt_pk_bf16_f32 v57, v58, v59
ds_write_b64 v208, v[56:57] offset:2048
v_cvt_pk_bf16_f32 v60, v60, v61
v_cvt_pk_bf16_f32 v61, v62, v63
ds_write_b64 v209, v[60:61] offset:2048
v_cvt_pk_bf16_f32 v64, v64, v65
v_cvt_pk_bf16_f32 v65, v66, v67
ds_write_b64 v210, v[64:65] offset:2048
v_cvt_pk_bf16_f32 v68, v68, v69
v_cvt_pk_bf16_f32 v69, v70, v71
ds_write_b64 v211, v[68:69] offset:2048
s_waitcnt lgkmcnt(0)
ds_read_b128 v[96:99], v212 offset:2048
ds_read_b128 v[100:103], v212 offset:3072
s_waitcnt lgkmcnt(1)
buffer_store_dwordx4 v[96:99], v213, s[28:31], s93 offen sc1
s_add_u32 s93, s93, 32768
s_waitcnt lgkmcnt(0)
buffer_store_dwordx4 v[100:103], v213, s[28:31], s93 offen sc1
s_add_u32 s93, s93, 32768
s_branch L_xj_77
L_w3_76:
buffer_load_dwordx4 v[152:155], v36, s[24:27], s3 offen offset:0 sc1
buffer_load_dwordx4 v[156:159], v36, s[24:27], s3 offen offset:1024 sc1
buffer_load_dwordx4 v[160:163], v36, s[24:27], s100 offen offset:0 sc1
buffer_load_dwordx4 v[164:167], v36, s[24:27], s100 offen offset:1024 sc1
buffer_load_dwordx4 v[168:171], v36, s[24:27], s101 offen offset:0 sc1
buffer_load_dwordx4 v[172:175], v36, s[24:27], s101 offen offset:1024 sc1
s_waitcnt lgkmcnt(0)
s_waitcnt vmcnt(4)
v_lshlrev_b32 v80, 16, v152
v_and_b32 v81, 0xffff0000, v152
v_pk_add_f32 v[40:41], v[40:41], v[80:81]
v_lshlrev_b32 v82, 16, v153
v_and_b32 v83, 0xffff0000, v153
v_pk_add_f32 v[42:43], v[42:43], v[82:83]
v_lshlrev_b32 v84, 16, v154
v_and_b32 v85, 0xffff0000, v154
v_pk_add_f32 v[44:45], v[44:45], v[84:85]
v_lshlrev_b32 v86, 16, v155
v_and_b32 v87, 0xffff0000, v155
v_pk_add_f32 v[46:47], v[46:47], v[86:87]
v_lshlrev_b32 v80, 16, v156
v_and_b32 v81, 0xffff0000, v156
v_pk_add_f32 v[48:49], v[48:49], v[80:81]
v_lshlrev_b32 v82, 16, v157
v_and_b32 v83, 0xffff0000, v157
v_pk_add_f32 v[50:51], v[50:51], v[82:83]
v_lshlrev_b32 v84, 16, v158
v_and_b32 v85, 0xffff0000, v158
v_pk_add_f32 v[52:53], v[52:53], v[84:85]
v_lshlrev_b32 v86, 16, v159
v_and_b32 v87, 0xffff0000, v159
v_pk_add_f32 v[54:55], v[54:55], v[86:87]
s_waitcnt vmcnt(2)
v_lshlrev_b32 v80, 16, v160
v_and_b32 v81, 0xffff0000, v160
v_pk_add_f32 v[40:41], v[40:41], v[80:81]
v_lshlrev_b32 v82, 16, v161
v_and_b32 v83, 0xffff0000, v161
v_pk_add_f32 v[42:43], v[42:43], v[82:83]
v_lshlrev_b32 v84, 16, v162
v_and_b32 v85, 0xffff0000, v162
v_pk_add_f32 v[44:45], v[44:45], v[84:85]
v_lshlrev_b32 v86, 16, v163
v_and_b32 v87, 0xffff0000, v163
v_pk_add_f32 v[46:47], v[46:47], v[86:87]
v_lshlrev_b32 v80, 16, v164
v_and_b32 v81, 0xffff0000, v164
v_pk_add_f32 v[48:49], v[48:49], v[80:81]
v_lshlrev_b32 v82, 16, v165
v_and_b32 v83, 0xffff0000, v165
v_pk_add_f32 v[50:51], v[50:51], v[82:83]
v_lshlrev_b32 v84, 16, v166
v_and_b32 v85, 0xffff0000, v166
v_pk_add_f32 v[52:53], v[52:53], v[84:85]
v_lshlrev_b32 v86, 16, v167
v_and_b32 v87, 0xffff0000, v167
v_pk_add_f32 v[54:55], v[54:55], v[86:87]
s_waitcnt vmcnt(0)
v_lshlrev_b32 v80, 16, v168
v_and_b32 v81, 0xffff0000, v168
v_pk_add_f32 v[40:41], v[40:41], v[80:81]
v_lshlrev_b32 v82, 16, v169
v_and_b32 v83, 0xffff0000, v169
v_pk_add_f32 v[42:43], v[42:43], v[82:83]
v_lshlrev_b32 v84, 16, v170
v_and_b32 v85, 0xffff0000, v170
v_pk_add_f32 v[44:45], v[44:45], v[84:85]
v_lshlrev_b32 v86, 16, v171
v_and_b32 v87, 0xffff0000, v171
v_pk_add_f32 v[46:47], v[46:47], v[86:87]
v_lshlrev_b32 v80, 16, v172
v_and_b32 v81, 0xffff0000, v172
v_pk_add_f32 v[48:49], v[48:49], v[80:81]
v_lshlrev_b32 v82, 16, v173
v_and_b32 v83, 0xffff0000, v173
v_pk_add_f32 v[50:51], v[50:51], v[82:83]
v_lshlrev_b32 v84, 16, v174
v_and_b32 v85, 0xffff0000, v174
v_pk_add_f32 v[52:53], v[52:53], v[84:85]
v_lshlrev_b32 v86, 16, v175
v_and_b32 v87, 0xffff0000, v175
v_pk_add_f32 v[54:55], v[54:55], v[86:87]
v_cvt_pk_bf16_f32 v40, v40, v41
v_cvt_pk_bf16_f32 v41, v42, v43
ds_write_b64 v208, v[40:41] offset:0
v_cvt_pk_bf16_f32 v44, v44, v45
v_cvt_pk_bf16_f32 v45, v46, v47
ds_write_b64 v209, v[44:45] offset:0
v_cvt_pk_bf16_f32 v48, v48, v49
v_cvt_pk_bf16_f32 v49, v50, v51
ds_write_b64 v210, v[48:49] offset:0
v_cvt_pk_bf16_f32 v52, v52, v53
v_cvt_pk_bf16_f32 v53, v54, v55
ds_write_b64 v211, v[52:53] offset:0
s_waitcnt lgkmcnt(0)
ds_read_b128 v[88:91], v212 offset:0
ds_read_b128 v[92:95], v212 offset:1024
s_waitcnt lgkmcnt(1)
buffer_store_dwordx4 v[88:91], v213, s[28:31], s93 offen sc1
s_add_u32 s93, s93, 32768
s_waitcnt lgkmcnt(0)
buffer_store_dwordx4 v[92:95], v213, s[28:31], s93 offen sc1
s_add_u32 s93, s93, 32768
L_xj_77:
L_exit:
s_endpgm
L_r2_3:
s_mov_b32 s82, 0
s_branch L_r2c_4
L_r1_5:
s_mov_b32 s44, 0
s_branch L_r1c_4_92
L_r2_7:
s_mov_b32 s82, 1
s_branch L_r2c_4
L_r1_9:
s_mov_b32 s44, 0
s_branch L_r1c_4_60
L_r2_11:
s_mov_b32 s82, 2
s_branch L_r2c_4
L_r1_13:
s_mov_b32 s44, 1
s_branch L_r1c_4_92
L_r2_15:
s_mov_b32 s82, 3
s_branch L_r2c_4
L_r1_17:
s_mov_b32 s44, 1
s_branch L_r1c_4_60
L_r2_19:
s_mov_b32 s82, 4
s_branch L_r2c_4
L_r1_21:
s_mov_b32 s44, 2
s_branch L_r1c_4_92
L_r2_23:
s_mov_b32 s82, 5
s_branch L_r2c_4
L_r1_25:
s_mov_b32 s44, 2
s_branch L_r1c_4_60
L_r2_27:
s_mov_b32 s82, 6
s_branch L_r2c_4
L_r1_29:
s_mov_b32 s44, 3
s_branch L_r1c_4_92
L_r2_31:
s_mov_b32 s82, 7
s_branch L_r2c_4
L_r2_33:
s_mov_b32 s82, 0
s_branch L_r2c_3
L_r1_35:
s_mov_b32 s44, 0
s_branch L_r1c_3_92
L_r2_37:
s_mov_b32 s82, 1
s_branch L_r2c_3
L_r1_39:
s_mov_b32 s44, 0
s_branch L_r1c_3_60
L_r2_41:
s_mov_b32 s82, 2
s_branch L_r2c_3
L_r1_43:
s_mov_b32 s44, 1
s_branch L_r1c_3_92
L_r2_45:
s_mov_b32 s82, 3
s_branch L_r2c_3
L_r1_47:
s_mov_b32 s44, 1
s_branch L_r1c_3_60
L_r2_49:
s_mov_b32 s82, 4
s_branch L_r2c_3
L_r1_51:
s_mov_b32 s44, 2
s_branch L_r1c_3_92
L_r2_53:
s_mov_b32 s82, 5
s_branch L_r2c_3
L_r1_55:
s_mov_b32 s44, 2
s_branch L_r1c_3_60
L_r2_57:
s_mov_b32 s82, 6
s_branch L_r2c_3
L_r1_59:
s_mov_b32 s44, 3
s_branch L_r1c_3_92
L_r2_61:
s_mov_b32 s82, 7
s_branch L_r2c_3
L_r1c_4_92:
v_max3_f32 v2, v92, v93, v94
v_max3_f32 v2, v2, v95, v108
v_max3_f32 v2, v2, v109, v110
v_max_f32 v2, v2, v111
v_mov_b32 v3, v2
s_nop 1
v_permlane16_swap_b32 v2, v3
s_nop 1
v_max_f32 v2, v2, v3
v_mov_b32 v3, v2
s_nop 1
v_permlane32_swap_b32 v2, v3
s_nop 1
v_max_f32 v2, v2, v3
v_max_f32 v2, 0, v2
v_exp_f32 v40, -v2
v_sub_f32 v92, v92, v2
v_sub_f32 v93, v93, v2
v_sub_f32 v94, v94, v2
v_sub_f32 v95, v95, v2
v_sub_f32 v108, v108, v2
v_sub_f32 v109, v109, v2
v_sub_f32 v110, v110, v2
v_sub_f32 v111, v111, v2
v_sub_f32 v232, v232, v2
v_sub_f32 v233, v233, v2
v_sub_f32 v234, v234, v2
v_sub_f32 v235, v235, v2
v_mul_f32 v248, v248, v40
v_mul_f32 v249, v249, v40
v_max3_f32 v2, v96, v97, v98
v_max3_f32 v2, v2, v99, v112
v_max3_f32 v2, v2, v113, v114
v_max_f32 v2, v2, v115
v_mov_b32 v3, v2
s_nop 1
v_permlane16_swap_b32 v2, v3
s_nop 1
v_max_f32 v2, v2, v3
v_mov_b32 v3, v2
s_nop 1
v_permlane32_swap_b32 v2, v3
s_nop 1
v_max_f32 v2, v2, v3
v_max_f32 v2, 0, v2
v_exp_f32 v41, -v2
v_sub_f32 v96, v96, v2
v_sub_f32 v97, v97, v2
v_sub_f32 v98, v98, v2
v_sub_f32 v99, v99, v2
v_sub_f32 v112, v112, v2
v_sub_f32 v113, v113, v2
v_sub_f32 v114, v114, v2
v_sub_f32 v115, v115, v2
v_sub_f32 v236, v236, v2
v_sub_f32 v237, v237, v2
v_sub_f32 v238, v238, v2
v_sub_f32 v239, v239, v2
v_mul_f32 v250, v250, v41
v_mul_f32 v251, v251, v41
v_max3_f32 v2, v100, v101, v102
v_max3_f32 v2, v2, v103, v116
v_max3_f32 v2, v2, v117, v118
v_max_f32 v2, v2, v119
v_mov_b32 v3, v2
s_nop 1
v_permlane16_swap_b32 v2, v3
s_nop 1
v_max_f32 v2, v2, v3
v_mov_b32 v3, v2
s_nop 1
v_permlane32_swap_b32 v2, v3
s_nop 1
v_max_f32 v2, v2, v3
v_max_f32 v2, 0, v2
v_exp_f32 v42, -v2
v_sub_f32 v100, v100, v2
v_sub_f32 v101, v101, v2
v_sub_f32 v102, v102, v2
v_sub_f32 v103, v103, v2
v_sub_f32 v116, v116, v2
v_sub_f32 v117, v117, v2
v_sub_f32 v118, v118, v2
v_sub_f32 v119, v119, v2
v_sub_f32 v240, v240, v2
v_sub_f32 v241, v241, v2
v_sub_f32 v242, v242, v2
v_sub_f32 v243, v243, v2
v_mul_f32 v252, v252, v42
v_mul_f32 v253, v253, v42
v_max3_f32 v2, v104, v105, v106
v_max3_f32 v2, v2, v107, v120
v_max3_f32 v2, v2, v121, v122
v_max_f32 v2, v2, v123
v_mov_b32 v3, v2
s_nop 1
v_permlane16_swap_b32 v2, v3
s_nop 1
v_max_f32 v2, v2, v3
v_mov_b32 v3, v2
s_nop 1
v_permlane32_swap_b32 v2, v3
s_nop 1
v_max_f32 v2, v2, v3
v_max_f32 v2, 0, v2
v_exp_f32 v43, -v2
v_sub_f32 v104, v104, v2
v_sub_f32 v105, v105, v2
v_sub_f32 v106, v106, v2
v_sub_f32 v107, v107, v2
v_sub_f32 v120, v120, v2
v_sub_f32 v121, v121, v2
v_sub_f32 v122, v122, v2
v_sub_f32 v123, v123, v2
v_sub_f32 v244, v244, v2
v_sub_f32 v245, v245, v2
v_sub_f32 v246, v246, v2
v_sub_f32 v247, v247, v2
v_mul_f32 v254, v254, v43
v_mul_f32 v255, v255, v43
s_mov_b32 s82, 1
s_cmp_eq_u32 s44, 0
s_cbranch_scc1 L_b1_6
s_cmp_eq_u32 s44, 1
s_cbranch_scc1 L_b1_14
s_cmp_eq_u32 s44, 2
s_cbranch_scc1 L_b1_22
s_branch L_b1_30
L_r1c_4_60:
v_max3_f32 v2, v60, v61, v62
v_max3_f32 v2, v2, v63, v76
v_max3_f32 v2, v2, v77, v78
v_max_f32 v2, v2, v79
v_mov_b32 v3, v2
s_nop 1
v_permlane16_swap_b32 v2, v3
s_nop 1
v_max_f32 v2, v2, v3
v_mov_b32 v3, v2
s_nop 1
v_permlane32_swap_b32 v2, v3
s_nop 1
v_max_f32 v2, v2, v3
v_max_f32 v2, 0, v2
v_exp_f32 v40, -v2
v_sub_f32 v60, v60, v2
v_sub_f32 v61, v61, v2
v_sub_f32 v62, v62, v2
v_sub_f32 v63, v63, v2
v_sub_f32 v76, v76, v2
v_sub_f32 v77, v77, v2
v_sub_f32 v78, v78, v2
v_sub_f32 v79, v79, v2
v_sub_f32 v232, v232, v2
v_sub_f32 v233, v233, v2
v_sub_f32 v234, v234, v2
v_sub_f32 v235, v235, v2
v_mul_f32 v248, v248, v40
v_mul_f32 v249, v249, v40
v_max3_f32 v2, v64, v65, v66
v_max3_f32 v2, v2, v67, v80
v_max3_f32 v2, v2, v81, v82
v_max_f32 v2, v2, v83
v_mov_b32 v3, v2
s_nop 1
v_permlane16_swap_b32 v2, v3
s_nop 1
v_max_f32 v2, v2, v3
v_mov_b32 v3, v2
s_nop 1
v_permlane32_swap_b32 v2, v3
s_nop 1
v_max_f32 v2, v2, v3
v_max_f32 v2, 0, v2
v_exp_f32 v41, -v2
v_sub_f32 v64, v64, v2
v_sub_f32 v65, v65, v2
v_sub_f32 v66, v66, v2
v_sub_f32 v67, v67, v2
v_sub_f32 v80, v80, v2
v_sub_f32 v81, v81, v2
v_sub_f32 v82, v82, v2
v_sub_f32 v83, v83, v2
v_sub_f32 v236, v236, v2
v_sub_f32 v237, v237, v2
v_sub_f32 v238, v238, v2
v_sub_f32 v239, v239, v2
v_mul_f32 v250, v250, v41
v_mul_f32 v251, v251, v41
v_max3_f32 v2, v68, v69, v70
v_max3_f32 v2, v2, v71, v84
v_max3_f32 v2, v2, v85, v86
v_max_f32 v2, v2, v87
v_mov_b32 v3, v2
s_nop 1
v_permlane16_swap_b32 v2, v3
s_nop 1
v_max_f32 v2, v2, v3
v_mov_b32 v3, v2
s_nop 1
v_permlane32_swap_b32 v2, v3
s_nop 1
v_max_f32 v2, v2, v3
v_max_f32 v2, 0, v2
v_exp_f32 v42, -v2
v_sub_f32 v68, v68, v2
v_sub_f32 v69, v69, v2
v_sub_f32 v70, v70, v2
v_sub_f32 v71, v71, v2
v_sub_f32 v84, v84, v2
v_sub_f32 v85, v85, v2
v_sub_f32 v86, v86, v2
v_sub_f32 v87, v87, v2
v_sub_f32 v240, v240, v2
v_sub_f32 v241, v241, v2
v_sub_f32 v242, v242, v2
v_sub_f32 v243, v243, v2
v_mul_f32 v252, v252, v42
v_mul_f32 v253, v253, v42
v_max3_f32 v2, v72, v73, v74
v_max3_f32 v2, v2, v75, v88
v_max3_f32 v2, v2, v89, v90
v_max_f32 v2, v2, v91
v_mov_b32 v3, v2
s_nop 1
v_permlane16_swap_b32 v2, v3
s_nop 1
v_max_f32 v2, v2, v3
v_mov_b32 v3, v2
s_nop 1
v_permlane32_swap_b32 v2, v3
s_nop 1
v_max_f32 v2, v2, v3
v_max_f32 v2, 0, v2
v_exp_f32 v43, -v2
v_sub_f32 v72, v72, v2
v_sub_f32 v73, v73, v2
v_sub_f32 v74, v74, v2
v_sub_f32 v75, v75, v2
v_sub_f32 v88, v88, v2
v_sub_f32 v89, v89, v2
v_sub_f32 v90, v90, v2
v_sub_f32 v91, v91, v2
v_sub_f32 v244, v244, v2
v_sub_f32 v245, v245, v2
v_sub_f32 v246, v246, v2
v_sub_f32 v247, v247, v2
v_mul_f32 v254, v254, v43
v_mul_f32 v255, v255, v43
s_mov_b32 s82, 1
s_cmp_eq_u32 s44, 0
s_cbranch_scc1 L_b1_10
s_cmp_eq_u32 s44, 1
s_cbranch_scc1 L_b1_18
s_branch L_b1_26
L_r1c_3_92:
v_max3_f32 v2, v92, v93, v94
v_max3_f32 v2, v2, v95, v108
v_max3_f32 v2, v2, v109, v110
v_max_f32 v2, v2, v111
v_mov_b32 v3, v2
s_nop 1
v_permlane16_swap_b32 v2, v3
s_nop 1
v_max_f32 v2, v2, v3
v_mov_b32 v3, v2
s_nop 1
v_permlane32_swap_b32 v2, v3
s_nop 1
v_max_f32 v2, v2, v3
v_max_f32 v2, 0, v2
v_exp_f32 v40, -v2
v_sub_f32 v92, v92, v2
v_sub_f32 v93, v93, v2
v_sub_f32 v94, v94, v2
v_sub_f32 v95, v95, v2
v_sub_f32 v108, v108, v2
v_sub_f32 v109, v109, v2
v_sub_f32 v110, v110, v2
v_sub_f32 v111, v111, v2
v_sub_f32 v232, v232, v2
v_sub_f32 v233, v233, v2
v_sub_f32 v234, v234, v2
v_sub_f32 v235, v235, v2
v_mul_f32 v248, v248, v40
v_mul_f32 v249, v249, v40
v_max3_f32 v2, v96, v97, v98
v_max3_f32 v2, v2, v99, v112
v_max3_f32 v2, v2, v113, v114
v_max_f32 v2, v2, v115
v_mov_b32 v3, v2
s_nop 1
v_permlane16_swap_b32 v2, v3
s_nop 1
v_max_f32 v2, v2, v3
v_mov_b32 v3, v2
s_nop 1
v_permlane32_swap_b32 v2, v3
s_nop 1
v_max_f32 v2, v2, v3
v_max_f32 v2, 0, v2
v_exp_f32 v41, -v2
v_sub_f32 v96, v96, v2
v_sub_f32 v97, v97, v2
v_sub_f32 v98, v98, v2
v_sub_f32 v99, v99, v2
v_sub_f32 v112, v112, v2
v_sub_f32 v113, v113, v2
v_sub_f32 v114, v114, v2
v_sub_f32 v115, v115, v2
v_sub_f32 v236, v236, v2
v_sub_f32 v237, v237, v2
v_sub_f32 v238, v238, v2
v_sub_f32 v239, v239, v2
v_mul_f32 v250, v250, v41
v_mul_f32 v251, v251, v41
v_max3_f32 v2, v100, v101, v102
v_max3_f32 v2, v2, v103, v116
v_max3_f32 v2, v2, v117, v118
v_max_f32 v2, v2, v119
v_mov_b32 v3, v2
s_nop 1
v_permlane16_swap_b32 v2, v3
s_nop 1
v_max_f32 v2, v2, v3
v_mov_b32 v3, v2
s_nop 1
v_permlane32_swap_b32 v2, v3
s_nop 1
v_max_f32 v2, v2, v3
v_max_f32 v2, 0, v2
v_exp_f32 v42, -v2
v_sub_f32 v100, v100, v2
v_sub_f32 v101, v101, v2
v_sub_f32 v102, v102, v2
v_sub_f32 v103, v103, v2
v_sub_f32 v116, v116, v2
v_sub_f32 v117, v117, v2
v_sub_f32 v118, v118, v2
v_sub_f32 v119, v119, v2
v_sub_f32 v240, v240, v2
v_sub_f32 v241, v241, v2
v_sub_f32 v242, v242, v2
v_sub_f32 v243, v243, v2
v_mul_f32 v252, v252, v42
v_mul_f32 v253, v253, v42
s_mov_b32 s82, 1
s_cmp_eq_u32 s44, 0
s_cbranch_scc1 L_b1_36
s_cmp_eq_u32 s44, 1
s_cbranch_scc1 L_b1_44
s_cmp_eq_u32 s44, 2
s_cbranch_scc1 L_b1_52
s_branch L_b1_60
L_r1c_3_60:
v_max3_f32 v2, v60, v61, v62
v_max3_f32 v2, v2, v63, v76
v_max3_f32 v2, v2, v77, v78
v_max_f32 v2, v2, v79
v_mov_b32 v3, v2
s_nop 1
v_permlane16_swap_b32 v2, v3
s_nop 1
v_max_f32 v2, v2, v3
v_mov_b32 v3, v2
s_nop 1
v_permlane32_swap_b32 v2, v3
s_nop 1
v_max_f32 v2, v2, v3
v_max_f32 v2, 0, v2
v_exp_f32 v40, -v2
v_sub_f32 v60, v60, v2
v_sub_f32 v61, v61, v2
v_sub_f32 v62, v62, v2
v_sub_f32 v63, v63, v2
v_sub_f32 v76, v76, v2
v_sub_f32 v77, v77, v2
v_sub_f32 v78, v78, v2
v_sub_f32 v79, v79, v2
v_sub_f32 v232, v232, v2
v_sub_f32 v233, v233, v2
v_sub_f32 v234, v234, v2
v_sub_f32 v235, v235, v2
v_mul_f32 v248, v248, v40
v_mul_f32 v249, v249, v40
v_max3_f32 v2, v64, v65, v66
v_max3_f32 v2, v2, v67, v80
v_max3_f32 v2, v2, v81, v82
v_max_f32 v2, v2, v83
v_mov_b32 v3, v2
s_nop 1
v_permlane16_swap_b32 v2, v3
s_nop 1
v_max_f32 v2, v2, v3
v_mov_b32 v3, v2
s_nop 1
v_permlane32_swap_b32 v2, v3
s_nop 1
v_max_f32 v2, v2, v3
v_max_f32 v2, 0, v2
v_exp_f32 v41, -v2
v_sub_f32 v64, v64, v2
v_sub_f32 v65, v65, v2
v_sub_f32 v66, v66, v2
v_sub_f32 v67, v67, v2
v_sub_f32 v80, v80, v2
v_sub_f32 v81, v81, v2
v_sub_f32 v82, v82, v2
v_sub_f32 v83, v83, v2
v_sub_f32 v236, v236, v2
v_sub_f32 v237, v237, v2
v_sub_f32 v238, v238, v2
v_sub_f32 v239, v239, v2
v_mul_f32 v250, v250, v41
v_mul_f32 v251, v251, v41
v_max3_f32 v2, v68, v69, v70
v_max3_f32 v2, v2, v71, v84
v_max3_f32 v2, v2, v85, v86
v_max_f32 v2, v2, v87
v_mov_b32 v3, v2
s_nop 1
v_permlane16_swap_b32 v2, v3
s_nop 1
v_max_f32 v2, v2, v3
v_mov_b32 v3, v2
s_nop 1
v_permlane32_swap_b32 v2, v3
s_nop 1
v_max_f32 v2, v2, v3
v_max_f32 v2, 0, v2
v_exp_f32 v42, -v2
v_sub_f32 v68, v68, v2
v_sub_f32 v69, v69, v2
v_sub_f32 v70, v70, v2
v_sub_f32 v71, v71, v2
v_sub_f32 v84, v84, v2
v_sub_f32 v85, v85, v2
v_sub_f32 v86, v86, v2
v_sub_f32 v87, v87, v2
v_sub_f32 v240, v240, v2
v_sub_f32 v241, v241, v2
v_sub_f32 v242, v242, v2
v_sub_f32 v243, v243, v2
v_mul_f32 v252, v252, v42
v_mul_f32 v253, v253, v42
s_mov_b32 s82, 1
s_cmp_eq_u32 s44, 0
s_cbranch_scc1 L_b1_40
s_cmp_eq_u32 s44, 1
s_cbranch_scc1 L_b1_48
s_branch L_b1_56
L_r2c_4:
s_nop 7
v_accvgpr_read_b32 v2, a0
v_accvgpr_read_b32 v3, a1
v_accvgpr_read_b32 v4, a2
v_accvgpr_read_b32 v5, a3
v_mul_f32 v2, v2, v40
v_mul_f32 v3, v3, v40
v_mul_f32 v4, v4, v40
v_mul_f32 v5, v5, v40
v_accvgpr_write_b32 a0, v2
v_accvgpr_write_b32 a1, v3
v_accvgpr_write_b32 a2, v4
v_accvgpr_write_b32 a3, v5
v_accvgpr_read_b32 v2, a4
v_accvgpr_read_b32 v3, a5
v_accvgpr_read_b32 v4, a6
v_accvgpr_read_b32 v5, a7
v_mul_f32 v2, v2, v41
v_mul_f32 v3, v3, v41
v_mul_f32 v4, v4, v41
v_mul_f32 v5, v5, v41
v_accvgpr_write_b32 a4, v2
v_accvgpr_write_b32 a5, v3
v_accvgpr_write_b32 a6, v4
v_accvgpr_write_b32 a7, v5
v_accvgpr_read_b32 v2, a8
v_accvgpr_read_b32 v3, a9
v_accvgpr_read_b32 v4, a10
v_accvgpr_read_b32 v5, a11
v_mul_f32 v2, v2, v42
v_mul_f32 v3, v3, v42
v_mul_f32 v4, v4, v42
v_mul_f32 v5, v5, v42
v_accvgpr_write_b32 a8, v2
v_accvgpr_write_b32 a9, v3
v_accvgpr_write_b32 a10, v4
v_accvgpr_write_b32 a11, v5
v_accvgpr_read_b32 v2, a12
v_accvgpr_read_b32 v3, a13
v_accvgpr_read_b32 v4, a14
v_accvgpr_read_b32 v5, a15
v_mul_f32 v2, v2, v43
v_mul_f32 v3, v3, v43
v_mul_f32 v4, v4, v43
v_mul_f32 v5, v5, v43
v_accvgpr_write_b32 a12, v2
v_accvgpr_write_b32 a13, v3
v_accvgpr_write_b32 a14, v4
v_accvgpr_write_b32 a15, v5
v_accvgpr_read_b32 v2, a16
v_accvgpr_read_b32 v3, a17
v_accvgpr_read_b32 v4, a18
v_accvgpr_read_b32 v5, a19
v_mul_f32 v2, v2, v40
v_mul_f32 v3, v3, v40
v_mul_f32 v4, v4, v40
v_mul_f32 v5, v5, v40
v_accvgpr_write_b32 a16, v2
v_accvgpr_write_b32 a17, v3
v_accvgpr_write_b32 a18, v4
v_accvgpr_write_b32 a19, v5
v_accvgpr_read_b32 v2, a20
v_accvgpr_read_b32 v3, a21
v_accvgpr_read_b32 v4, a22
v_accvgpr_read_b32 v5, a23
v_mul_f32 v2, v2, v41
v_mul_f32 v3, v3, v41
v_mul_f32 v4, v4, v41
v_mul_f32 v5, v5, v41
v_accvgpr_write_b32 a20, v2
v_accvgpr_write_b32 a21, v3
v_accvgpr_write_b32 a22, v4
v_accvgpr_write_b32 a23, v5
v_accvgpr_read_b32 v2, a24
v_accvgpr_read_b32 v3, a25
v_accvgpr_read_b32 v4, a26
v_accvgpr_read_b32 v5, a27
v_mul_f32 v2, v2, v42
v_mul_f32 v3, v3, v42
v_mul_f32 v4, v4, v42
v_mul_f32 v5, v5, v42
v_accvgpr_write_b32 a24, v2
v_accvgpr_write_b32 a25, v3
v_accvgpr_write_b32 a26, v4
v_accvgpr_write_b32 a27, v5
v_accvgpr_read_b32 v2, a28
v_accvgpr_read_b32 v3, a29
v_accvgpr_read_b32 v4, a30
v_accvgpr_read_b32 v5, a31
v_mul_f32 v2, v2, v43
v_mul_f32 v3, v3, v43
v_mul_f32 v4, v4, v43
v_mul_f32 v5, v5, v43
v_accvgpr_write_b32 a28, v2
v_accvgpr_write_b32 a29, v3
v_accvgpr_write_b32 a30, v4
v_accvgpr_write_b32 a31, v5
v_accvgpr_read_b32 v2, a32
v_accvgpr_read_b32 v3, a33
v_accvgpr_read_b32 v4, a34
v_accvgpr_read_b32 v5, a35
v_mul_f32 v2, v2, v40
v_mul_f32 v3, v3, v40
v_mul_f32 v4, v4, v40
v_mul_f32 v5, v5, v40
v_accvgpr_write_b32 a32, v2
v_accvgpr_write_b32 a33, v3
v_accvgpr_write_b32 a34, v4
v_accvgpr_write_b32 a35, v5
v_accvgpr_read_b32 v2, a36
v_accvgpr_read_b32 v3, a37
v_accvgpr_read_b32 v4, a38
v_accvgpr_read_b32 v5, a39
v_mul_f32 v2, v2, v41
v_mul_f32 v3, v3, v41
v_mul_f32 v4, v4, v41
v_mul_f32 v5, v5, v41
v_accvgpr_write_b32 a36, v2
v_accvgpr_write_b32 a37, v3
v_accvgpr_write_b32 a38, v4
v_accvgpr_write_b32 a39, v5
v_accvgpr_read_b32 v2, a40
v_accvgpr_read_b32 v3, a41
v_accvgpr_read_b32 v4, a42
v_accvgpr_read_b32 v5, a43
v_mul_f32 v2, v2, v42
v_mul_f32 v3, v3, v42
v_mul_f32 v4, v4, v42
v_mul_f32 v5, v5, v42
v_accvgpr_write_b32 a40, v2
v_accvgpr_write_b32 a41, v3
v_accvgpr_write_b32 a42, v4
v_accvgpr_write_b32 a43, v5
v_accvgpr_read_b32 v2, a44
v_accvgpr_read_b32 v3, a45
v_accvgpr_read_b32 v4, a46
v_accvgpr_read_b32 v5, a47
v_mul_f32 v2, v2, v43
v_mul_f32 v3, v3, v43
v_mul_f32 v4, v4, v43
v_mul_f32 v5, v5, v43
v_accvgpr_write_b32 a44, v2
v_accvgpr_write_b32 a45, v3
v_accvgpr_write_b32 a46, v4
v_accvgpr_write_b32 a47, v5
v_accvgpr_read_b32 v2, a48
v_accvgpr_read_b32 v3, a49
v_accvgpr_read_b32 v4, a50
v_accvgpr_read_b32 v5, a51
v_mul_f32 v2, v2, v40
v_mul_f32 v3, v3, v40
v_mul_f32 v4, v4, v40
v_mul_f32 v5, v5, v40
v_accvgpr_write_b32 a48, v2
v_accvgpr_write_b32 a49, v3
v_accvgpr_write_b32 a50, v4
v_accvgpr_write_b32 a51, v5
v_accvgpr_read_b32 v2, a52
v_accvgpr_read_b32 v3, a53
v_accvgpr_read_b32 v4, a54
v_accvgpr_read_b32 v5, a55
v_mul_f32 v2, v2, v41
v_mul_f32 v3, v3, v41
v_mul_f32 v4, v4, v41
v_mul_f32 v5, v5, v41
v_accvgpr_write_b32 a52, v2
v_accvgpr_write_b32 a53, v3
v_accvgpr_write_b32 a54, v4
v_accvgpr_write_b32 a55, v5
v_accvgpr_read_b32 v2, a56
v_accvgpr_read_b32 v3, a57
v_accvgpr_read_b32 v4, a58
v_accvgpr_read_b32 v5, a59
v_mul_f32 v2, v2, v42
v_mul_f32 v3, v3, v42
v_mul_f32 v4, v4, v42
v_mul_f32 v5, v5, v42
v_accvgpr_write_b32 a56, v2
v_accvgpr_write_b32 a57, v3
v_accvgpr_write_b32 a58, v4
v_accvgpr_write_b32 a59, v5
v_accvgpr_read_b32 v2, a60
v_accvgpr_read_b32 v3, a61
v_accvgpr_read_b32 v4, a62
v_accvgpr_read_b32 v5, a63
v_mul_f32 v2, v2, v43
v_mul_f32 v3, v3, v43
v_mul_f32 v4, v4, v43
v_mul_f32 v5, v5, v43
v_accvgpr_write_b32 a60, v2
v_accvgpr_write_b32 a61, v3
v_accvgpr_write_b32 a62, v4
v_accvgpr_write_b32 a63, v5
v_accvgpr_read_b32 v2, a64
v_accvgpr_read_b32 v3, a65
v_accvgpr_read_b32 v4, a66
v_accvgpr_read_b32 v5, a67
v_mul_f32 v2, v2, v40
v_mul_f32 v3, v3, v40
v_mul_f32 v4, v4, v40
v_mul_f32 v5, v5, v40
v_accvgpr_write_b32 a64, v2
v_accvgpr_write_b32 a65, v3
v_accvgpr_write_b32 a66, v4
v_accvgpr_write_b32 a67, v5
v_accvgpr_read_b32 v2, a68
v_accvgpr_read_b32 v3, a69
v_accvgpr_read_b32 v4, a70
v_accvgpr_read_b32 v5, a71
v_mul_f32 v2, v2, v41
v_mul_f32 v3, v3, v41
v_mul_f32 v4, v4, v41
v_mul_f32 v5, v5, v41
v_accvgpr_write_b32 a68, v2
v_accvgpr_write_b32 a69, v3
v_accvgpr_write_b32 a70, v4
v_accvgpr_write_b32 a71, v5
v_accvgpr_read_b32 v2, a72
v_accvgpr_read_b32 v3, a73
v_accvgpr_read_b32 v4, a74
v_accvgpr_read_b32 v5, a75
v_mul_f32 v2, v2, v42
v_mul_f32 v3, v3, v42
v_mul_f32 v4, v4, v42
v_mul_f32 v5, v5, v42
v_accvgpr_write_b32 a72, v2
v_accvgpr_write_b32 a73, v3
v_accvgpr_write_b32 a74, v4
v_accvgpr_write_b32 a75, v5
v_accvgpr_read_b32 v2, a76
v_accvgpr_read_b32 v3, a77
v_accvgpr_read_b32 v4, a78
v_accvgpr_read_b32 v5, a79
v_mul_f32 v2, v2, v43
v_mul_f32 v3, v3, v43
v_mul_f32 v4, v4, v43
v_mul_f32 v5, v5, v43
v_accvgpr_write_b32 a76, v2
v_accvgpr_write_b32 a77, v3
v_accvgpr_write_b32 a78, v4
v_accvgpr_write_b32 a79, v5
v_accvgpr_read_b32 v2, a80
v_accvgpr_read_b32 v3, a81
v_accvgpr_read_b32 v4, a82
v_accvgpr_read_b32 v5, a83
v_mul_f32 v2, v2, v40
v_mul_f32 v3, v3, v40
v_mul_f32 v4, v4, v40
v_mul_f32 v5, v5, v40
v_accvgpr_write_b32 a80, v2
v_accvgpr_write_b32 a81, v3
v_accvgpr_write_b32 a82, v4
v_accvgpr_write_b32 a83, v5
v_accvgpr_read_b32 v2, a84
v_accvgpr_read_b32 v3, a85
v_accvgpr_read_b32 v4, a86
v_accvgpr_read_b32 v5, a87
v_mul_f32 v2, v2, v41
v_mul_f32 v3, v3, v41
v_mul_f32 v4, v4, v41
v_mul_f32 v5, v5, v41
v_accvgpr_write_b32 a84, v2
v_accvgpr_write_b32 a85, v3
v_accvgpr_write_b32 a86, v4
v_accvgpr_write_b32 a87, v5
v_accvgpr_read_b32 v2, a88
v_accvgpr_read_b32 v3, a89
v_accvgpr_read_b32 v4, a90
v_accvgpr_read_b32 v5, a91
v_mul_f32 v2, v2, v42
v_mul_f32 v3, v3, v42
v_mul_f32 v4, v4, v42
v_mul_f32 v5, v5, v42
v_accvgpr_write_b32 a88, v2
v_accvgpr_write_b32 a89, v3
v_accvgpr_write_b32 a90, v4
v_accvgpr_write_b32 a91, v5
v_accvgpr_read_b32 v2, a92
v_accvgpr_read_b32 v3, a93
v_accvgpr_read_b32 v4, a94
v_accvgpr_read_b32 v5, a95
v_mul_f32 v2, v2, v43
v_mul_f32 v3, v3, v43
v_mul_f32 v4, v4, v43
v_mul_f32 v5, v5, v43
v_accvgpr_write_b32 a92, v2
v_accvgpr_write_b32 a93, v3
v_accvgpr_write_b32 a94, v4
v_accvgpr_write_b32 a95, v5
v_accvgpr_read_b32 v2, a96
v_accvgpr_read_b32 v3, a97
v_accvgpr_read_b32 v4, a98
v_accvgpr_read_b32 v5, a99
v_mul_f32 v2, v2, v40
v_mul_f32 v3, v3, v40
v_mul_f32 v4, v4, v40
v_mul_f32 v5, v5, v40
v_accvgpr_write_b32 a96, v2
v_accvgpr_write_b32 a97, v3
v_accvgpr_write_b32 a98, v4
v_accvgpr_write_b32 a99, v5
v_accvgpr_read_b32 v2, a100
v_accvgpr_read_b32 v3, a101
v_accvgpr_read_b32 v4, a102
v_accvgpr_read_b32 v5, a103
v_mul_f32 v2, v2, v41
v_mul_f32 v3, v3, v41
v_mul_f32 v4, v4, v41
v_mul_f32 v5, v5, v41
v_accvgpr_write_b32 a100, v2
v_accvgpr_write_b32 a101, v3
v_accvgpr_write_b32 a102, v4
v_accvgpr_write_b32 a103, v5
v_accvgpr_read_b32 v2, a104
v_accvgpr_read_b32 v3, a105
v_accvgpr_read_b32 v4, a106
v_accvgpr_read_b32 v5, a107
v_mul_f32 v2, v2, v42
v_mul_f32 v3, v3, v42
v_mul_f32 v4, v4, v42
v_mul_f32 v5, v5, v42
v_accvgpr_write_b32 a104, v2
v_accvgpr_write_b32 a105, v3
v_accvgpr_write_b32 a106, v4
v_accvgpr_write_b32 a107, v5
v_accvgpr_read_b32 v2, a108
v_accvgpr_read_b32 v3, a109
v_accvgpr_read_b32 v4, a110
v_accvgpr_read_b32 v5, a111
v_mul_f32 v2, v2, v43
v_mul_f32 v3, v3, v43
v_mul_f32 v4, v4, v43
v_mul_f32 v5, v5, v43
v_accvgpr_write_b32 a108, v2
v_accvgpr_write_b32 a109, v3
v_accvgpr_write_b32 a110, v4
v_accvgpr_write_b32 a111, v5
v_accvgpr_read_b32 v2, a112
v_accvgpr_read_b32 v3, a113
v_accvgpr_read_b32 v4, a114
v_accvgpr_read_b32 v5, a115
v_mul_f32 v2, v2, v40
v_mul_f32 v3, v3, v40
v_mul_f32 v4, v4, v40
v_mul_f32 v5, v5, v40
v_accvgpr_write_b32 a112, v2
v_accvgpr_write_b32 a113, v3
v_accvgpr_write_b32 a114, v4
v_accvgpr_write_b32 a115, v5
v_accvgpr_read_b32 v2, a116
v_accvgpr_read_b32 v3, a117
v_accvgpr_read_b32 v4, a118
v_accvgpr_read_b32 v5, a119
v_mul_f32 v2, v2, v41
v_mul_f32 v3, v3, v41
v_mul_f32 v4, v4, v41
v_mul_f32 v5, v5, v41
v_accvgpr_write_b32 a116, v2
v_accvgpr_write_b32 a117, v3
v_accvgpr_write_b32 a118, v4
v_accvgpr_write_b32 a119, v5
v_accvgpr_read_b32 v2, a120
v_accvgpr_read_b32 v3, a121
v_accvgpr_read_b32 v4, a122
v_accvgpr_read_b32 v5, a123
v_mul_f32 v2, v2, v42
v_mul_f32 v3, v3, v42
v_mul_f32 v4, v4, v42
v_mul_f32 v5, v5, v42
v_accvgpr_write_b32 a120, v2
v_accvgpr_write_b32 a121, v3
v_accvgpr_write_b32 a122, v4
v_accvgpr_write_b32 a123, v5
v_accvgpr_read_b32 v2, a124
v_accvgpr_read_b32 v3, a125
v_accvgpr_read_b32 v4, a126
v_accvgpr_read_b32 v5, a127
v_mul_f32 v2, v2, v43
v_mul_f32 v3, v3, v43
v_mul_f32 v4, v4, v43
v_mul_f32 v5, v5, v43
v_accvgpr_write_b32 a124, v2
v_accvgpr_write_b32 a125, v3
v_accvgpr_write_b32 a126, v4
v_accvgpr_write_b32 a127, v5
s_mov_b32 s44, s82
s_mov_b32 s82, 0
s_cmp_eq_u32 s44, 0
s_cbranch_scc1 L_b2_4
s_cmp_eq_u32 s44, 1
s_cbranch_scc1 L_b2_8
s_cmp_eq_u32 s44, 2
s_cbranch_scc1 L_b2_12
s_cmp_eq_u32 s44, 3
s_cbranch_scc1 L_b2_16
s_cmp_eq_u32 s44, 4
s_cbranch_scc1 L_b2_20
s_cmp_eq_u32 s44, 5
s_cbranch_scc1 L_b2_24
s_cmp_eq_u32 s44, 6
s_cbranch_scc1 L_b2_28
s_branch L_b2_32
L_r2c_3:
s_nop 7
v_accvgpr_read_b32 v2, a0
v_accvgpr_read_b32 v3, a1
v_accvgpr_read_b32 v4, a2
v_accvgpr_read_b32 v5, a3
v_mul_f32 v2, v2, v40
v_mul_f32 v3, v3, v40
v_mul_f32 v4, v4, v40
v_mul_f32 v5, v5, v40
v_accvgpr_write_b32 a0, v2
v_accvgpr_write_b32 a1, v3
v_accvgpr_write_b32 a2, v4
v_accvgpr_write_b32 a3, v5
v_accvgpr_read_b32 v2, a4
v_accvgpr_read_b32 v3, a5
v_accvgpr_read_b32 v4, a6
v_accvgpr_read_b32 v5, a7
v_mul_f32 v2, v2, v41
v_mul_f32 v3, v3, v41
v_mul_f32 v4, v4, v41
v_mul_f32 v5, v5, v41
v_accvgpr_write_b32 a4, v2
v_accvgpr_write_b32 a5, v3
v_accvgpr_write_b32 a6, v4
v_accvgpr_write_b32 a7, v5
v_accvgpr_read_b32 v2, a8
v_accvgpr_read_b32 v3, a9
v_accvgpr_read_b32 v4, a10
v_accvgpr_read_b32 v5, a11
v_mul_f32 v2, v2, v42
v_mul_f32 v3, v3, v42
v_mul_f32 v4, v4, v42
v_mul_f32 v5, v5, v42
v_accvgpr_write_b32 a8, v2
v_accvgpr_write_b32 a9, v3
v_accvgpr_write_b32 a10, v4
v_accvgpr_write_b32 a11, v5
v_accvgpr_read_b32 v2, a16
v_accvgpr_read_b32 v3, a17
v_accvgpr_read_b32 v4, a18
v_accvgpr_read_b32 v5, a19
v_mul_f32 v2, v2, v40
v_mul_f32 v3, v3, v40
v_mul_f32 v4, v4, v40
v_mul_f32 v5, v5, v40
v_accvgpr_write_b32 a16, v2
v_accvgpr_write_b32 a17, v3
v_accvgpr_write_b32 a18, v4
v_accvgpr_write_b32 a19, v5
v_accvgpr_read_b32 v2, a20
v_accvgpr_read_b32 v3, a21
v_accvgpr_read_b32 v4, a22
v_accvgpr_read_b32 v5, a23
v_mul_f32 v2, v2, v41
v_mul_f32 v3, v3, v41
v_mul_f32 v4, v4, v41
v_mul_f32 v5, v5, v41
v_accvgpr_write_b32 a20, v2
v_accvgpr_write_b32 a21, v3
v_accvgpr_write_b32 a22, v4
v_accvgpr_write_b32 a23, v5
v_accvgpr_read_b32 v2, a24
v_accvgpr_read_b32 v3, a25
v_accvgpr_read_b32 v4, a26
v_accvgpr_read_b32 v5, a27
v_mul_f32 v2, v2, v42
v_mul_f32 v3, v3, v42
v_mul_f32 v4, v4, v42
v_mul_f32 v5, v5, v42
v_accvgpr_write_b32 a24, v2
v_accvgpr_write_b32 a25, v3
v_accvgpr_write_b32 a26, v4
v_accvgpr_write_b32 a27, v5
v_accvgpr_read_b32 v2, a32
v_accvgpr_read_b32 v3, a33
v_accvgpr_read_b32 v4, a34
v_accvgpr_read_b32 v5, a35
v_mul_f32 v2, v2, v40
v_mul_f32 v3, v3, v40
v_mul_f32 v4, v4, v40
v_mul_f32 v5, v5, v40
v_accvgpr_write_b32 a32, v2
v_accvgpr_write_b32 a33, v3
v_accvgpr_write_b32 a34, v4
v_accvgpr_write_b32 a35, v5
v_accvgpr_read_b32 v2, a36
v_accvgpr_read_b32 v3, a37
v_accvgpr_read_b32 v4, a38
v_accvgpr_read_b32 v5, a39
v_mul_f32 v2, v2, v41
v_mul_f32 v3, v3, v41
v_mul_f32 v4, v4, v41
v_mul_f32 v5, v5, v41
v_accvgpr_write_b32 a36, v2
v_accvgpr_write_b32 a37, v3
v_accvgpr_write_b32 a38, v4
v_accvgpr_write_b32 a39, v5
v_accvgpr_read_b32 v2, a40
v_accvgpr_read_b32 v3, a41
v_accvgpr_read_b32 v4, a42
v_accvgpr_read_b32 v5, a43
v_mul_f32 v2, v2, v42
v_mul_f32 v3, v3, v42
v_mul_f32 v4, v4, v42
v_mul_f32 v5, v5, v42
v_accvgpr_write_b32 a40, v2
v_accvgpr_write_b32 a41, v3
v_accvgpr_write_b32 a42, v4
v_accvgpr_write_b32 a43, v5
v_accvgpr_read_b32 v2, a48
v_accvgpr_read_b32 v3, a49
v_accvgpr_read_b32 v4, a50
v_accvgpr_read_b32 v5, a51
v_mul_f32 v2, v2, v40
v_mul_f32 v3, v3, v40
v_mul_f32 v4, v4, v40
v_mul_f32 v5, v5, v40
v_accvgpr_write_b32 a48, v2
v_accvgpr_write_b32 a49, v3
v_accvgpr_write_b32 a50, v4
v_accvgpr_write_b32 a51, v5
v_accvgpr_read_b32 v2, a52
v_accvgpr_read_b32 v3, a53
v_accvgpr_read_b32 v4, a54
v_accvgpr_read_b32 v5, a55
v_mul_f32 v2, v2, v41
v_mul_f32 v3, v3, v41
v_mul_f32 v4, v4, v41
v_mul_f32 v5, v5, v41
v_accvgpr_write_b32 a52, v2
v_accvgpr_write_b32 a53, v3
v_accvgpr_write_b32 a54, v4
v_accvgpr_write_b32 a55, v5
v_accvgpr_read_b32 v2, a56
v_accvgpr_read_b32 v3, a57
v_accvgpr_read_b32 v4, a58
v_accvgpr_read_b32 v5, a59
v_mul_f32 v2, v2, v42
v_mul_f32 v3, v3, v42
v_mul_f32 v4, v4, v42
v_mul_f32 v5, v5, v42
v_accvgpr_write_b32 a56, v2
v_accvgpr_write_b32 a57, v3
v_accvgpr_write_b32 a58, v4
v_accvgpr_write_b32 a59, v5
v_accvgpr_read_b32 v2, a64
v_accvgpr_read_b32 v3, a65
v_accvgpr_read_b32 v4, a66
v_accvgpr_read_b32 v5, a67
v_mul_f32 v2, v2, v40
v_mul_f32 v3, v3, v40
v_mul_f32 v4, v4, v40
v_mul_f32 v5, v5, v40
v_accvgpr_write_b32 a64, v2
v_accvgpr_write_b32 a65, v3
v_accvgpr_write_b32 a66, v4
v_accvgpr_write_b32 a67, v5
v_accvgpr_read_b32 v2, a68
v_accvgpr_read_b32 v3, a69
v_accvgpr_read_b32 v4, a70
v_accvgpr_read_b32 v5, a71
v_mul_f32 v2, v2, v41
v_mul_f32 v3, v3, v41
v_mul_f32 v4, v4, v41
v_mul_f32 v5, v5, v41
v_accvgpr_write_b32 a68, v2
v_accvgpr_write_b32 a69, v3
v_accvgpr_write_b32 a70, v4
v_accvgpr_write_b32 a71, v5
v_accvgpr_read_b32 v2, a72
v_accvgpr_read_b32 v3, a73
v_accvgpr_read_b32 v4, a74
v_accvgpr_read_b32 v5, a75
v_mul_f32 v2, v2, v42
v_mul_f32 v3, v3, v42
v_mul_f32 v4, v4, v42
v_mul_f32 v5, v5, v42
v_accvgpr_write_b32 a72, v2
v_accvgpr_write_b32 a73, v3
v_accvgpr_write_b32 a74, v4
v_accvgpr_write_b32 a75, v5
v_accvgpr_read_b32 v2, a80
v_accvgpr_read_b32 v3, a81
v_accvgpr_read_b32 v4, a82
v_accvgpr_read_b32 v5, a83
v_mul_f32 v2, v2, v40
v_mul_f32 v3, v3, v40
v_mul_f32 v4, v4, v40
v_mul_f32 v5, v5, v40
v_accvgpr_write_b32 a80, v2
v_accvgpr_write_b32 a81, v3
v_accvgpr_write_b32 a82, v4
v_accvgpr_write_b32 a83, v5
v_accvgpr_read_b32 v2, a84
v_accvgpr_read_b32 v3, a85
v_accvgpr_read_b32 v4, a86
v_accvgpr_read_b32 v5, a87
v_mul_f32 v2, v2, v41
v_mul_f32 v3, v3, v41
v_mul_f32 v4, v4, v41
v_mul_f32 v5, v5, v41
v_accvgpr_write_b32 a84, v2
v_accvgpr_write_b32 a85, v3
v_accvgpr_write_b32 a86, v4
v_accvgpr_write_b32 a87, v5
v_accvgpr_read_b32 v2, a88
v_accvgpr_read_b32 v3, a89
v_accvgpr_read_b32 v4, a90
v_accvgpr_read_b32 v5, a91
v_mul_f32 v2, v2, v42
v_mul_f32 v3, v3, v42
v_mul_f32 v4, v4, v42
v_mul_f32 v5, v5, v42
v_accvgpr_write_b32 a88, v2
v_accvgpr_write_b32 a89, v3
v_accvgpr_write_b32 a90, v4
v_accvgpr_write_b32 a91, v5
v_accvgpr_read_b32 v2, a96
v_accvgpr_read_b32 v3, a97
v_accvgpr_read_b32 v4, a98
v_accvgpr_read_b32 v5, a99
v_mul_f32 v2, v2, v40
v_mul_f32 v3, v3, v40
v_mul_f32 v4, v4, v40
v_mul_f32 v5, v5, v40
v_accvgpr_write_b32 a96, v2
v_accvgpr_write_b32 a97, v3
v_accvgpr_write_b32 a98, v4
v_accvgpr_write_b32 a99, v5
v_accvgpr_read_b32 v2, a100
v_accvgpr_read_b32 v3, a101
v_accvgpr_read_b32 v4, a102
v_accvgpr_read_b32 v5, a103
v_mul_f32 v2, v2, v41
v_mul_f32 v3, v3, v41
v_mul_f32 v4, v4, v41
v_mul_f32 v5, v5, v41
v_accvgpr_write_b32 a100, v2
v_accvgpr_write_b32 a101, v3
v_accvgpr_write_b32 a102, v4
v_accvgpr_write_b32 a103, v5
v_accvgpr_read_b32 v2, a104
v_accvgpr_read_b32 v3, a105
v_accvgpr_read_b32 v4, a106
v_accvgpr_read_b32 v5, a107
v_mul_f32 v2, v2, v42
v_mul_f32 v3, v3, v42
v_mul_f32 v4, v4, v42
v_mul_f32 v5, v5, v42
v_accvgpr_write_b32 a104, v2
v_accvgpr_write_b32 a105, v3
v_accvgpr_write_b32 a106, v4
v_accvgpr_write_b32 a107, v5
v_accvgpr_read_b32 v2, a112
v_accvgpr_read_b32 v3, a113
v_accvgpr_read_b32 v4, a114
v_accvgpr_read_b32 v5, a115
v_mul_f32 v2, v2, v40
v_mul_f32 v3, v3, v40
v_mul_f32 v4, v4, v40
v_mul_f32 v5, v5, v40
v_accvgpr_write_b32 a112, v2
v_accvgpr_write_b32 a113, v3
v_accvgpr_write_b32 a114, v4
v_accvgpr_write_b32 a115, v5
v_accvgpr_read_b32 v2, a116
v_accvgpr_read_b32 v3, a117
v_accvgpr_read_b32 v4, a118
v_accvgpr_read_b32 v5, a119
v_mul_f32 v2, v2, v41
v_mul_f32 v3, v3, v41
v_mul_f32 v4, v4, v41
v_mul_f32 v5, v5, v41
v_accvgpr_write_b32 a116, v2
v_accvgpr_write_b32 a117, v3
v_accvgpr_write_b32 a118, v4
v_accvgpr_write_b32 a119, v5
v_accvgpr_read_b32 v2, a120
v_accvgpr_read_b32 v3, a121
v_accvgpr_read_b32 v4, a122
v_accvgpr_read_b32 v5, a123
v_mul_f32 v2, v2, v42
v_mul_f32 v3, v3, v42
v_mul_f32 v4, v4, v42
v_mul_f32 v5, v5, v42
v_accvgpr_write_b32 a120, v2
v_accvgpr_write_b32 a121, v3
v_accvgpr_write_b32 a122, v4
v_accvgpr_write_b32 a123, v5
s_mov_b32 s44, s82
s_mov_b32 s82, 0
s_cmp_eq_u32 s44, 0
s_cbranch_scc1 L_b2_34
s_cmp_eq_u32 s44, 1
s_cbranch_scc1 L_b2_38
s_cmp_eq_u32 s44, 2
s_cbranch_scc1 L_b2_42
s_cmp_eq_u32 s44, 3
s_cbranch_scc1 L_b2_46
s_cmp_eq_u32 s44, 4
s_cbranch_scc1 L_b2_50
s_cmp_eq_u32 s44, 5
s_cbranch_scc1 L_b2_54
s_cmp_eq_u32 s44, 6
s_cbranch_scc1 L_b2_58
s_branch L_b2_62
.section .rodata,"a"
.p2align 6
.amdhsa_kernel concat_heads__mha_block_cached__gqa_block_cached__near_ridge_kernel
  .amdhsa_next_free_vgpr 504
  .amdhsa_next_free_sgpr 102
  .amdhsa_accum_offset 256
  .amdhsa_group_segment_fixed_size 0
  .amdhsa_kernarg_size 104
  .amdhsa_user_sgpr_count 2
  .amdhsa_user_sgpr_kernarg_segment_ptr 1
  .amdhsa_system_sgpr_workgroup_id_x 1
.end_amdhsa_kernel
```
